```python
import torch

def _softmax(x, axis=-1):
    return torch.softmax(x, dim=axis)
def _gelu(x):
    return torch.nn.functional.gelu(x, approximate="tanh")
def _silu(x):
    return torch.nn.functional.silu(x)
def _sigmoid(x):
    return torch.sigmoid(x)
def _layernorm(x, axis=-1, eps=1e-5):
    m = x.mean(dim=axis, keepdim=True)
    v = x.var(dim=axis, keepdim=True, unbiased=False)
    return (x - m) / torch.sqrt(v + eps)
def _scatter_add(tgt, idx, src, axis=0):
    return tgt.clone().index_add_(axis, idx, src)
def _segment_sum(src, seg, n):
    out = torch.zeros((n,) + src.shape[1:], dtype=src.dtype)
    return out.index_add_(0, seg, src)
def _pad(x, pw):
    flat = tuple(v for pair in reversed(pw) for v in pair)
    return torch.nn.functional.pad(x, flat)

kernel_name = 'standalone__mha_block_cached__near_ridge'

def setup_inputs():

    _w = (lambda a: (lambda t: t.to(torch.bfloat16) if t.is_floating_point() else t)(torch.as_tensor(a)))
    B, Sq, D = 8, 240, 576
    H, Sk, Dh = 32, 2048, 128
    return {
        "x": _w((lambda *s: torch.randn(*s, dtype=torch.bfloat16) * 0.8)(B, Sq, D)),
        "k_cache": _w((lambda *s: torch.randn(*s, dtype=torch.bfloat16) * 0.8)(B, H, Sk, Dh)),
        "v_cache": _w((lambda *s: torch.randn(*s, dtype=torch.bfloat16) * 0.05)(B, H, Sk, Dh)),
        "wq": _w((lambda *s: torch.randn(*s, dtype=torch.bfloat16) * 0.8)(D, H * Dh) * (D ** -0.5)),
        "wo": _w((lambda *s: torch.randn(*s, dtype=torch.bfloat16) * 0.05)(H * Dh, D) * ((H * Dh) ** -0.5)),
    }

def reference(x, k_cache, v_cache, wq, wo):
    B, Sq, D = x.shape
    H, Dh = 32, 128
    q = (lambda x, *d: x.permute(*d))((x @ wq).reshape(B, Sq, H, Dh), 0, 2, 1, 3)
    scores = torch.einsum("bhqd,bhkd->bhqk", q, k_cache) * (Dh ** -0.5)
    p = _softmax(scores, axis=-1)
    o = torch.einsum("bhqk,bhkd->bhqd", p, v_cache)
    return (lambda x, *d: x.permute(*d))(o, 0, 2, 1, 3).reshape(B, Sq, H * Dh) @ wo
```

```asm
; @launch grid=(256,1,1) block=(256,1,1) lds=163840
.amdgcn_target "amdgcn-amd-amdhsa--gfx950"
.text
.globl standalone__mha_block_cached__near_ridge_kernel
.p2align 8
.type standalone__mha_block_cached__near_ridge_kernel,@function
standalone__mha_block_cached__near_ridge_kernel:

    s_cmp_ge_u32 s2, 256
    s_cbranch_scc1 L_done
    s_load_dwordx4 s[68:71], s[0:1], 0
    s_load_dwordx4 s[72:75], s[0:1], 16
    s_load_dwordx4 s[64:67], s[0:1], 48
    s_load_dwordx4 s[76:79], s[0:1], 32
    s_and_b32 s38, s2, 1
    s_lshl_b32 s38, s38, 2
    s_bfe_u32 s25, s2, 0x20003
    s_add_u32 s25, s25, s38
    s_bfe_u32 s38, s2, 0x20001
    s_lshl_b32 s38, s38, 3
    s_lshr_b32 s26, s2, 5
    s_add_u32 s26, s26, s38
    v_lshrrev_b32 v1, 6, v0
    v_and_b32 v227, 63, v0
    v_readfirstlane_b32 s24, v1
    s_nop 3
    s_lshl_b32 s34, s24, 11
    s_lshl_b32 s35, s24, 12
    s_lshl_b32 s36, s24, 13
    s_mov_b32 s37, 0
    s_mov_b32 s60, 0
    v_lshrrev_b32 v228, 4, v227
    v_and_b32 v229, 15, v227
    v_lshlrev_b32 v230, 2, v228
    v_xor_b32 v230, v230, v229
    v_lshlrev_b32 v230, 4, v230
    s_lshl_b32 s38, s24, 17
    v_lshlrev_b32 v230, 1, v228
    v_xor_b32 v230, v230, v229
    v_lshlrev_b32 v230, 4, v230
    v_lshl_add_u32 v136, v228, 13, v230
    v_add_u32 v136, s38, v136
    v_add_u32 v137, 32768, v136
    v_xor_b32 v138, 128, v136
    v_add_u32 v138, 65536, v138
    v_add_u32 v139, 32768, v138
    v_lshrrev_b32 v231, 3, v227
    v_and_b32 v232, 7, v227
    s_lshl_b32 s38, s24, 6
    v_add_u32 v231, s38, v231
    s_movk_i32 s39, 1152
    v_xor_b32 v233, v228, v232
    v_lshlrev_b32 v233, 4, v233
    v_mad_u32_u24 v128, v231, s39, v233
    v_xor_b32 v233, 64, v233
    v_mad_u32_u24 v234, v231, s39, v233
    v_add_u32 v129, 8192, v234
    v_add_u32 v130, 16384, v128
    v_add_u32 v131, 24576, v234
    v_add_u32 v132, 36864, v128
    v_add_u32 v133, 45056, v234
    v_add_u32 v134, 53248, v128
    v_add_u32 v135, 61440, v234
    s_waitcnt lgkmcnt(0)
    s_mul_i32 s38, s25, 276480
    s_add_u32 s68, s68, s38
    s_addc_u32 s69, s69, 0
    s_mov_b32 s4, s68
    s_mov_b32 s5, s69
    s_mov_b32 s6, 276480
    s_mov_b32 s7, 0x20000
    s_lshl_b32 s38, s26, 8
    s_add_u32 s74, s74, s38
    s_addc_u32 s75, s75, 0
    s_sub_u32 s39, 4718592, s38
    s_mov_b32 s8, s74
    s_mov_b32 s9, s75
    s_mov_b32 s10, s39
    s_mov_b32 s11, 0x20000
    s_mov_b32 s32, 0
    s_mov_b32 s33, 0
    buffer_load_dwordx4 a[112:115], v136, s[8:11], s33 offen
    buffer_load_dwordx4 a[116:119], v137, s[8:11], s33 offen
    buffer_load_dwordx4 a[120:123], v138, s[8:11], s33 offen
    buffer_load_dwordx4 a[124:127], v139, s[8:11], s33 offen
    s_add_u32 s33, s33, 0x80000
    s_add_u32 m0, s36, 0
    s_nop 0
    buffer_load_dwordx4 v128, s[4:7], s32 offen offset:0 lds
    buffer_load_dwordx4 v129, s[4:7], s32 offen offset:1024 lds
    buffer_load_dwordx4 v130, s[4:7], s32 offen offset:2048 lds
    buffer_load_dwordx4 v131, s[4:7], s32 offen offset:3072 lds
    s_add_u32 m0, s36, 4096
    s_nop 0
    buffer_load_dwordx4 v132, s[4:7], s32 offen offset:0 lds
    buffer_load_dwordx4 v133, s[4:7], s32 offen offset:1024 lds
    buffer_load_dwordx4 v134, s[4:7], s32 offen offset:2048 lds
    buffer_load_dwordx4 v135, s[4:7], s32 offen offset:3072 lds
    s_add_u32 s32, s32, 128
    buffer_load_dwordx4 a[128:131], v136, s[8:11], s33 offen
    buffer_load_dwordx4 a[132:135], v137, s[8:11], s33 offen
    buffer_load_dwordx4 a[136:139], v138, s[8:11], s33 offen
    buffer_load_dwordx4 a[140:143], v139, s[8:11], s33 offen
    s_add_u32 s33, s33, 0x80000
    s_add_u32 m0, s36, 32768
    s_nop 0
    buffer_load_dwordx4 v128, s[4:7], s32 offen offset:0 lds
    buffer_load_dwordx4 v129, s[4:7], s32 offen offset:1024 lds
    buffer_load_dwordx4 v130, s[4:7], s32 offen offset:2048 lds
    buffer_load_dwordx4 v131, s[4:7], s32 offen offset:3072 lds
    s_add_u32 m0, s36, 36864
    s_nop 0
    buffer_load_dwordx4 v132, s[4:7], s32 offen offset:0 lds
    buffer_load_dwordx4 v133, s[4:7], s32 offen offset:1024 lds
    buffer_load_dwordx4 v134, s[4:7], s32 offen offset:2048 lds
    buffer_load_dwordx4 v135, s[4:7], s32 offen offset:3072 lds
    s_add_u32 s32, s32, 128
    v_lshrrev_b32 v228, 4, v227
    v_and_b32 v229, 15, v227
    s_lshl_b32 s38, s24, 3
    v_add_u32 v230, 0, v228
    v_add_u32 v231, s38, v230
    v_and_b32 v231, 15, v231
    v_xor_b32 v231, v231, v229
    v_lshlrev_b32 v231, 4, v231
    v_lshl_add_u32 v196, v228, 8, v231
    v_lshlrev_b32 v230, 1, v230
    v_xor_b32 v230, v230, v229
    v_lshlrev_b32 v230, 4, v230
    v_lshl_add_u32 v198, v228, 8, v230
    v_add_u32 v230, 4, v228
    v_add_u32 v231, s38, v230
    v_and_b32 v231, 15, v231
    v_xor_b32 v231, v231, v229
    v_lshlrev_b32 v231, 4, v231
    v_lshl_add_u32 v197, v228, 8, v231
    v_lshlrev_b32 v230, 1, v230
    v_xor_b32 v230, v230, v229
    v_lshlrev_b32 v230, 4, v230
    v_lshl_add_u32 v199, v228, 8, v230
    v_lshrrev_b32 v231, 3, v229
    v_lshlrev_b32 v231, 12, v231
    v_bfe_u32 v232, v229, 2, 1
    v_lshl_add_u32 v231, v232, 10, v231
    v_and_b32 v232, 3, v229
    v_lshl_add_u32 v231, v232, 8, v231
    v_add_u32 v230, 0, v228
    v_xor_b32 v230, v230, v229
    v_lshl_add_u32 v172, v230, 4, v231
    v_add_u32 v176, 65536, v172
    v_add_u32 v230, 4, v228
    v_xor_b32 v230, v230, v229
    v_lshl_add_u32 v173, v230, 4, v231
    v_add_u32 v177, 65536, v173
    v_add_u32 v230, 8, v228
    v_xor_b32 v230, v230, v229
    v_lshl_add_u32 v174, v230, 4, v231
    v_add_u32 v178, 65536, v174
    v_add_u32 v230, 12, v228
    v_xor_b32 v230, v230, v229
    v_lshl_add_u32 v175, v230, 4, v231
    v_add_u32 v179, 65536, v175
    v_bfe_u32 v233, v227, 2, 2
    v_and_b32 v234, 3, v227
    v_lshl_add_u32 v236, v228, 2, v233
    v_and_b32 v237, 7, v236
    v_lshrrev_b32 v236, 1, v228
    v_lshlrev_b32 v236, 12, v236
    v_and_b32 v238, 1, v228
    v_lshl_add_u32 v236, v238, 10, v236
    v_lshl_add_u32 v236, v233, 8, v236
    v_lshl_add_u32 v236, v234, 3, v236
    v_add_u32 v236, 2048, v236
    v_xor_b32 v238, 0, v237
    v_lshl_add_u32 v180, v238, 5, v236
    v_add_u32 v188, 65536, v180
    v_xor_b32 v238, 1, v237
    v_lshl_add_u32 v181, v238, 5, v236
    v_add_u32 v189, 65536, v181
    v_xor_b32 v238, 2, v237
    v_lshl_add_u32 v182, v238, 5, v236
    v_add_u32 v190, 65536, v182
    v_xor_b32 v238, 3, v237
    v_lshl_add_u32 v183, v238, 5, v236
    v_add_u32 v191, 65536, v183
    v_xor_b32 v238, 4, v237
    v_lshl_add_u32 v184, v238, 5, v236
    v_add_u32 v192, 65536, v184
    v_xor_b32 v238, 5, v237
    v_lshl_add_u32 v185, v238, 5, v236
    v_add_u32 v193, 65536, v185
    v_xor_b32 v238, 6, v237
    v_lshl_add_u32 v186, v238, 5, v236
    v_add_u32 v194, 65536, v186
    v_xor_b32 v238, 7, v237
    v_lshl_add_u32 v187, v238, 5, v236
    v_add_u32 v195, 65536, v187
    v_bfe_u32 v235, v229, 1, 3
    v_add_u32 v236, 0, v228
    v_xor_b32 v236, v236, v235
    v_lshlrev_b32 v236, 4, v236
    v_lshl_add_u32 v236, v229, 7, v236
    v_add_u32 v140, s36, v236
    v_add_u32 v142, 65536, v140
    v_add_u32 v236, 4, v228
    v_xor_b32 v236, v236, v235
    v_lshlrev_b32 v236, 4, v236
    v_lshl_add_u32 v236, v229, 7, v236
    v_add_u32 v141, s36, v236
    v_add_u32 v143, 65536, v141
    v_lshl_add_u32 v236, v228, 3, v233
    v_lshlrev_b32 v236, 8, v236
    v_lshl_add_u32 v236, v234, 3, v236
    v_add_u32 v236, 131072, v236
    v_and_b32 v237, 1, v228
    v_lshl_add_u32 v237, v237, 2, v233
    v_xor_b32 v238, 0, v237
    v_lshl_add_u32 v153, v238, 5, v236
    v_xor_b32 v238, 1, v237
    v_lshl_add_u32 v154, v238, 5, v236
    v_xor_b32 v238, 2, v237
    v_lshl_add_u32 v155, v238, 5, v236
    v_xor_b32 v238, 3, v237
    v_lshl_add_u32 v156, v238, 5, v236
    v_xor_b32 v238, 4, v237
    v_lshl_add_u32 v157, v238, 5, v236
    v_xor_b32 v238, 5, v237
    v_lshl_add_u32 v158, v238, 5, v236
    v_xor_b32 v238, 6, v237
    v_lshl_add_u32 v159, v238, 5, v236
    v_xor_b32 v238, 7, v237
    v_lshl_add_u32 v160, v238, 5, v236
    s_lshl_b32 s38, s25, 5
    s_add_u32 s38, s38, s26
    s_lshr_b32 s39, s38, 13
    s_lshl_b32 s38, s38, 19
    s_add_u32 s70, s70, s38
    s_addc_u32 s71, s71, s39
    s_mov_b32 s12, s70
    s_mov_b32 s13, s71
    s_mov_b32 s14, 524288
    s_mov_b32 s15, 0x20000
    s_add_u32 s72, s72, s38
    s_addc_u32 s73, s73, s39
    s_sub_u32 s72, s72, 2048
    s_subb_u32 s73, s73, 0
    s_mov_b32 s16, s72
    s_mov_b32 s17, s73
    s_mov_b32 s18, 526336
    s_mov_b32 s19, 0x20000
    s_lshl_b32 s38, s25, 21
    s_lshl_b32 s39, s26, 12
    s_add_u32 s38, s38, s39
    s_add_u32 s62, s66, s38
    s_addc_u32 s63, s67, 0
    s_mov_b32 s20, s62
    s_mov_b32 s21, s63
    s_mov_b32 s22, 0x200000
    s_mov_b32 s23, 0x20000
    v_lshlrev_b32 v152, 4, v227
    v_add_u32 v152, s35, v152
    v_add_u32 v152, 131072, v152
    s_and_b32 s47, s2, 7
    s_lshr_b32 s48, s2, 3
    s_min_u32 s38, s48, 26
    s_mul_i32 s39, s38, 29
    s_lshr_b32 s39, s39, 8
    s_mul_i32 s44, s39, 80
    s_mul_i32 s39, s39, 9
    s_sub_u32 s39, s38, s39
    s_lshl_b32 s45, s39, 6
    s_movk_i32 s39, 1152
    v_lshrrev_b32 v232, 3, v227
    v_and_b32 v233, 7, v227
    v_bfe_u32 v234, v227, 4, 2
    v_lshlrev_b32 v234, 1, v234
    v_xor_b32 v233, v233, v234
    v_lshlrev_b32 v233, 4, v233
    s_lshl_b32 s38, s45, 1
    v_add_u32 v233, s38, v233
    v_add_u32 v234, 0, v232
    v_mad_u32_u24 v250, v234, s39, v233
    v_add_u32 v234, 8, v232
    v_mad_u32_u24 v251, v234, s39, v233
    v_subrev_u32 v251, 1024, v251
    v_add_u32 v234, 16, v232
    v_mad_u32_u24 v252, v234, s39, v233
    v_subrev_u32 v252, 2048, v252
    v_add_u32 v234, 24, v232
    v_mad_u32_u24 v253, v234, s39, v233
    v_subrev_u32 v253, 3072, v253
    s_lshl_b32 s38, s25, 7
    s_lshl_b32 s39, s26, 2
    s_add_u32 s38, s38, s39
    s_add_u32 s51, s38, 0x2000000
    s_cmp_lg_u32 s24, 0
    s_cbranch_scc1 L_noclr
    v_mov_b32 v232, s51
    v_mov_b32 v233, 0
    s_mov_b64 s[62:63], exec
    s_mov_b64 exec, 1
    global_store_dword v232, v233, s[66:67] sc1
    s_mov_b64 exec, s[62:63]
L_noclr:
    s_add_u32 s27, s34, s60
    buffer_load_dwordx4 a[144:147], v136, s[8:11], s33 offen
    buffer_load_dwordx4 a[148:151], v137, s[8:11], s33 offen
    buffer_load_dwordx4 a[152:155], v138, s[8:11], s33 offen
    buffer_load_dwordx4 a[156:159], v139, s[8:11], s33 offen
    s_add_u32 s33, s33, 0x80000
    s_waitcnt vmcnt(24)
    ds_write_b128 v152, a[112:115] offset:0
    ds_write_b128 v152, a[116:119] offset:1024
    ds_write_b128 v152, a[120:123] offset:2048
    ds_write_b128 v152, a[124:127] offset:3072
    s_waitcnt vmcnt(16) lgkmcnt(0)
    s_barrier
    ds_read_b128 a[96:99], v140 offset:0
    ds_read_b128 a[100:103], v140 offset:2048
    ds_read_b128 a[104:107], v140 offset:4096
    ds_read_b128 a[108:111], v140 offset:6144
    ds_read_b64_tr_b16 a[64:65], v153 offset:0
    ds_read_b64_tr_b16 a[66:67], v153 offset:1024
    ds_read_b64_tr_b16 a[68:69], v154 offset:0
    ds_read_b64_tr_b16 a[70:71], v154 offset:1024
    ds_read_b64_tr_b16 a[72:73], v155 offset:0
    ds_read_b64_tr_b16 a[74:75], v155 offset:1024
    ds_read_b64_tr_b16 a[76:77], v156 offset:0
    ds_read_b64_tr_b16 a[78:79], v156 offset:1024
    ds_read_b64_tr_b16 a[80:81], v157 offset:0
    ds_read_b64_tr_b16 a[82:83], v157 offset:1024
    ds_read_b64_tr_b16 a[84:85], v158 offset:0
    ds_read_b64_tr_b16 a[86:87], v158 offset:1024
    ds_read_b64_tr_b16 a[88:89], v159 offset:0
    ds_read_b64_tr_b16 a[90:91], v159 offset:1024
    ds_read_b64_tr_b16 a[92:93], v160 offset:0
    ds_read_b64_tr_b16 a[94:95], v160 offset:1024
    s_waitcnt lgkmcnt(0)
    s_waitcnt vmcnt(12)
    v_mfma_f32_16x16x32_bf16 v[0:3], a[64:67], a[96:99], 0
    ds_read_b128 a[32:35], v141 offset:0
    s_add_u32 m0, s36, 65536
    s_nop 0
    buffer_load_dwordx4 v128, s[4:7], s32 offen offset:0 lds
    v_mfma_f32_16x16x32_bf16 v[4:7], a[64:67], a[100:103], 0
    ds_read_b128 a[36:39], v141 offset:2048
    v_mfma_f32_16x16x32_bf16 v[8:11], a[64:67], a[104:107], 0
    ds_read_b128 a[40:43], v141 offset:4096
    buffer_load_dwordx4 v129, s[4:7], s32 offen offset:1024 lds
    v_mfma_f32_16x16x32_bf16 v[12:15], a[64:67], a[108:111], 0
    ds_read_b128 a[44:47], v141 offset:6144
    v_mfma_f32_16x16x32_bf16 v[16:19], a[68:71], a[96:99], 0
    ds_read_b64_tr_b16 a[0:1], v153 offset:8192
    buffer_load_dwordx4 v130, s[4:7], s32 offen offset:2048 lds
    v_mfma_f32_16x16x32_bf16 v[20:23], a[68:71], a[100:103], 0
    ds_read_b64_tr_b16 a[2:3], v153 offset:9216
    v_mfma_f32_16x16x32_bf16 v[24:27], a[68:71], a[104:107], 0
    ds_read_b64_tr_b16 a[4:5], v154 offset:8192
    buffer_load_dwordx4 v131, s[4:7], s32 offen offset:3072 lds
    v_mfma_f32_16x16x32_bf16 v[28:31], a[68:71], a[108:111], 0
    ds_read_b64_tr_b16 a[6:7], v154 offset:9216
    v_mfma_f32_16x16x32_bf16 v[32:35], a[72:75], a[96:99], 0
    ds_read_b64_tr_b16 a[8:9], v155 offset:8192
    s_add_u32 m0, s36, 69632
    s_nop 0
    buffer_load_dwordx4 v132, s[4:7], s32 offen offset:0 lds
    v_mfma_f32_16x16x32_bf16 v[36:39], a[72:75], a[100:103], 0
    ds_read_b64_tr_b16 a[10:11], v155 offset:9216
    v_mfma_f32_16x16x32_bf16 v[40:43], a[72:75], a[104:107], 0
    ds_read_b64_tr_b16 a[12:13], v156 offset:8192
    buffer_load_dwordx4 v133, s[4:7], s32 offen offset:1024 lds
    v_mfma_f32_16x16x32_bf16 v[44:47], a[72:75], a[108:111], 0
    ds_read_b64_tr_b16 a[14:15], v156 offset:9216
    v_mfma_f32_16x16x32_bf16 v[48:51], a[76:79], a[96:99], 0
    ds_read_b64_tr_b16 a[16:17], v157 offset:8192
    buffer_load_dwordx4 v134, s[4:7], s32 offen offset:2048 lds
    v_mfma_f32_16x16x32_bf16 v[52:55], a[76:79], a[100:103], 0
    ds_read_b64_tr_b16 a[18:19], v157 offset:9216
    v_mfma_f32_16x16x32_bf16 v[56:59], a[76:79], a[104:107], 0
    ds_read_b64_tr_b16 a[20:21], v158 offset:8192
    v_mfma_f32_16x16x32_bf16 v[60:63], a[76:79], a[108:111], 0
    ds_read_b64_tr_b16 a[22:23], v158 offset:9216
    v_mfma_f32_16x16x32_bf16 v[64:67], a[80:83], a[96:99], 0
    ds_read_b64_tr_b16 a[24:25], v159 offset:8192
    buffer_load_dwordx4 v135, s[4:7], s32 offen offset:3072 lds
    s_add_u32 s32, s32, 128
    v_mfma_f32_16x16x32_bf16 v[68:71], a[80:83], a[100:103], 0
    ds_read_b64_tr_b16 a[26:27], v159 offset:9216
    v_mfma_f32_16x16x32_bf16 v[72:75], a[80:83], a[104:107], 0
    ds_read_b64_tr_b16 a[28:29], v160 offset:8192
    buffer_load_dwordx4 a[160:163], v136, s[8:11], s33 offen
    v_mfma_f32_16x16x32_bf16 v[76:79], a[80:83], a[108:111], 0
    ds_read_b64_tr_b16 a[30:31], v160 offset:9216
    v_mfma_f32_16x16x32_bf16 v[80:83], a[84:87], a[96:99], 0
    v_mfma_f32_16x16x32_bf16 v[84:87], a[84:87], a[100:103], 0
    ds_write_b128 v152, a[128:131] offset:16384
    v_mfma_f32_16x16x32_bf16 v[88:91], a[84:87], a[104:107], 0
    buffer_load_dwordx4 a[164:167], v137, s[8:11], s33 offen
    v_mfma_f32_16x16x32_bf16 v[92:95], a[84:87], a[108:111], 0
    ds_write_b128 v152, a[132:135] offset:17408
    v_mfma_f32_16x16x32_bf16 v[96:99], a[88:91], a[96:99], 0
    buffer_load_dwordx4 a[168:171], v138, s[8:11], s33 offen
    v_mfma_f32_16x16x32_bf16 v[100:103], a[88:91], a[100:103], 0
    ds_write_b128 v152, a[136:139] offset:18432
    v_mfma_f32_16x16x32_bf16 v[104:107], a[88:91], a[104:107], 0
    v_mfma_f32_16x16x32_bf16 v[108:111], a[88:91], a[108:111], 0
    ds_write_b128 v152, a[140:143] offset:19456
    v_mfma_f32_16x16x32_bf16 v[112:115], a[92:95], a[96:99], 0
    buffer_load_dwordx4 a[172:175], v139, s[8:11], s33 offen
    s_add_u32 s33, s33, 0x80000
    v_mfma_f32_16x16x32_bf16 v[116:119], a[92:95], a[100:103], 0
    v_mfma_f32_16x16x32_bf16 v[120:123], a[92:95], a[104:107], 0
    v_mfma_f32_16x16x32_bf16 v[124:127], a[92:95], a[108:111], 0
    s_waitcnt lgkmcnt(4)
    v_mfma_f32_16x16x32_bf16 v[0:3], a[0:3], a[32:35], v[0:3]
    v_mfma_f32_16x16x32_bf16 v[4:7], a[0:3], a[36:39], v[4:7]
    s_waitcnt vmcnt(16) lgkmcnt(0)
    s_barrier
    ds_read_b128 a[96:99], v140 offset:32768
    v_mfma_f32_16x16x32_bf16 v[8:11], a[0:3], a[40:43], v[8:11]
    ds_read_b128 a[100:103], v140 offset:34816
    v_mfma_f32_16x16x32_bf16 v[12:15], a[0:3], a[44:47], v[12:15]
    ds_read_b128 a[104:107], v140 offset:36864
    v_mfma_f32_16x16x32_bf16 v[16:19], a[4:7], a[32:35], v[16:19]
    ds_read_b128 a[108:111], v140 offset:38912
    s_add_u32 m0, s36, 0
    s_nop 0
    buffer_load_dwordx4 v128, s[4:7], s32 offen offset:0 lds
    v_mfma_f32_16x16x32_bf16 v[20:23], a[4:7], a[36:39], v[20:23]
    ds_read_b64_tr_b16 a[64:65], v153 offset:16384
    v_mfma_f32_16x16x32_bf16 v[24:27], a[4:7], a[40:43], v[24:27]
    ds_read_b64_tr_b16 a[66:67], v153 offset:17408
    v_mfma_f32_16x16x32_bf16 v[28:31], a[4:7], a[44:47], v[28:31]
    ds_read_b64_tr_b16 a[68:69], v154 offset:16384
    v_mfma_f32_16x16x32_bf16 v[32:35], a[8:11], a[32:35], v[32:35]
    ds_read_b64_tr_b16 a[70:71], v154 offset:17408
    buffer_load_dwordx4 v129, s[4:7], s32 offen offset:1024 lds
    v_mfma_f32_16x16x32_bf16 v[36:39], a[8:11], a[36:39], v[36:39]
    ds_read_b64_tr_b16 a[72:73], v155 offset:16384
    v_mfma_f32_16x16x32_bf16 v[40:43], a[8:11], a[40:43], v[40:43]
    ds_read_b64_tr_b16 a[74:75], v155 offset:17408
    v_mfma_f32_16x16x32_bf16 v[44:47], a[8:11], a[44:47], v[44:47]
    ds_read_b64_tr_b16 a[76:77], v156 offset:16384
    v_mfma_f32_16x16x32_bf16 v[48:51], a[12:15], a[32:35], v[48:51]
    ds_read_b64_tr_b16 a[78:79], v156 offset:17408
    buffer_load_dwordx4 v130, s[4:7], s32 offen offset:2048 lds
    v_mfma_f32_16x16x32_bf16 v[52:55], a[12:15], a[36:39], v[52:55]
    ds_read_b64_tr_b16 a[80:81], v157 offset:16384
    v_mfma_f32_16x16x32_bf16 v[56:59], a[12:15], a[40:43], v[56:59]
    ds_read_b64_tr_b16 a[82:83], v157 offset:17408
    v_mfma_f32_16x16x32_bf16 v[60:63], a[12:15], a[44:47], v[60:63]
    ds_read_b64_tr_b16 a[84:85], v158 offset:16384
    v_mfma_f32_16x16x32_bf16 v[64:67], a[16:19], a[32:35], v[64:67]
    ds_read_b64_tr_b16 a[86:87], v158 offset:17408
    buffer_load_dwordx4 v131, s[4:7], s32 offen offset:3072 lds
    v_mfma_f32_16x16x32_bf16 v[68:71], a[16:19], a[36:39], v[68:71]
    ds_read_b64_tr_b16 a[88:89], v159 offset:16384
    v_mfma_f32_16x16x32_bf16 v[72:75], a[16:19], a[40:43], v[72:75]
    ds_read_b64_tr_b16 a[90:91], v159 offset:17408
    v_mfma_f32_16x16x32_bf16 v[76:79], a[16:19], a[44:47], v[76:79]
    ds_read_b64_tr_b16 a[92:93], v160 offset:16384
    v_mfma_f32_16x16x32_bf16 v[80:83], a[20:23], a[32:35], v[80:83]
    ds_read_b64_tr_b16 a[94:95], v160 offset:17408
    s_add_u32 m0, s36, 4096
    s_nop 0
    buffer_load_dwordx4 v132, s[4:7], s32 offen offset:0 lds
    v_mfma_f32_16x16x32_bf16 v[84:87], a[20:23], a[36:39], v[84:87]
    v_mfma_f32_16x16x32_bf16 v[88:91], a[20:23], a[40:43], v[88:91]
    v_mfma_f32_16x16x32_bf16 v[92:95], a[20:23], a[44:47], v[92:95]
    v_mfma_f32_16x16x32_bf16 v[96:99], a[24:27], a[32:35], v[96:99]
    buffer_load_dwordx4 v133, s[4:7], s32 offen offset:1024 lds
    v_mfma_f32_16x16x32_bf16 v[100:103], a[24:27], a[36:39], v[100:103]
    v_mfma_f32_16x16x32_bf16 v[104:107], a[24:27], a[40:43], v[104:107]
    v_mfma_f32_16x16x32_bf16 v[108:111], a[24:27], a[44:47], v[108:111]
    v_mfma_f32_16x16x32_bf16 v[112:115], a[28:31], a[32:35], v[112:115]
    buffer_load_dwordx4 v134, s[4:7], s32 offen offset:2048 lds
    v_mfma_f32_16x16x32_bf16 v[116:119], a[28:31], a[36:39], v[116:119]
    v_mfma_f32_16x16x32_bf16 v[120:123], a[28:31], a[40:43], v[120:123]
    v_mfma_f32_16x16x32_bf16 v[124:127], a[28:31], a[44:47], v[124:127]
    s_waitcnt lgkmcnt(0)
    s_waitcnt vmcnt(19)
    v_mfma_f32_16x16x32_bf16 v[0:3], a[64:67], a[96:99], v[0:3]
    ds_read_b128 a[32:35], v141 offset:32768
    buffer_load_dwordx4 v135, s[4:7], s32 offen offset:3072 lds
    s_add_u32 s32, s32, 128
    v_mfma_f32_16x16x32_bf16 v[4:7], a[64:67], a[100:103], v[4:7]
    ds_read_b128 a[36:39], v141 offset:34816
    v_mfma_f32_16x16x32_bf16 v[8:11], a[64:67], a[104:107], v[8:11]
    ds_read_b128 a[40:43], v141 offset:36864
    v_mfma_f32_16x16x32_bf16 v[12:15], a[64:67], a[108:111], v[12:15]
    ds_read_b128 a[44:47], v141 offset:38912
    v_mfma_f32_16x16x32_bf16 v[16:19], a[68:71], a[96:99], v[16:19]
    ds_read_b64_tr_b16 a[0:1], v153 offset:24576
    buffer_load_dwordx4 a[176:179], v136, s[8:11], s33 offen
    v_mfma_f32_16x16x32_bf16 v[20:23], a[68:71], a[100:103], v[20:23]
    ds_read_b64_tr_b16 a[2:3], v153 offset:25600
    v_mfma_f32_16x16x32_bf16 v[24:27], a[68:71], a[104:107], v[24:27]
    ds_read_b64_tr_b16 a[4:5], v154 offset:24576
    v_mfma_f32_16x16x32_bf16 v[28:31], a[68:71], a[108:111], v[28:31]
    ds_read_b64_tr_b16 a[6:7], v154 offset:25600
    v_mfma_f32_16x16x32_bf16 v[32:35], a[72:75], a[96:99], v[32:35]
    ds_read_b64_tr_b16 a[8:9], v155 offset:24576
    buffer_load_dwordx4 a[180:183], v137, s[8:11], s33 offen
    v_mfma_f32_16x16x32_bf16 v[36:39], a[72:75], a[100:103], v[36:39]
    ds_read_b64_tr_b16 a[10:11], v155 offset:25600
    v_mfma_f32_16x16x32_bf16 v[40:43], a[72:75], a[104:107], v[40:43]
    ds_read_b64_tr_b16 a[12:13], v156 offset:24576
    v_mfma_f32_16x16x32_bf16 v[44:47], a[72:75], a[108:111], v[44:47]
    ds_read_b64_tr_b16 a[14:15], v156 offset:25600
    v_mfma_f32_16x16x32_bf16 v[48:51], a[76:79], a[96:99], v[48:51]
    ds_read_b64_tr_b16 a[16:17], v157 offset:24576
    buffer_load_dwordx4 a[184:187], v138, s[8:11], s33 offen
    v_mfma_f32_16x16x32_bf16 v[52:55], a[76:79], a[100:103], v[52:55]
    ds_read_b64_tr_b16 a[18:19], v157 offset:25600
    v_mfma_f32_16x16x32_bf16 v[56:59], a[76:79], a[104:107], v[56:59]
    ds_read_b64_tr_b16 a[20:21], v158 offset:24576
    v_mfma_f32_16x16x32_bf16 v[60:63], a[76:79], a[108:111], v[60:63]
    ds_read_b64_tr_b16 a[22:23], v158 offset:25600
    v_mfma_f32_16x16x32_bf16 v[64:67], a[80:83], a[96:99], v[64:67]
    ds_read_b64_tr_b16 a[24:25], v159 offset:24576
    buffer_load_dwordx4 a[188:191], v139, s[8:11], s33 offen
    s_add_u32 s33, s33, 0x80000
    v_mfma_f32_16x16x32_bf16 v[68:71], a[80:83], a[100:103], v[68:71]
    ds_read_b64_tr_b16 a[26:27], v159 offset:25600
    v_mfma_f32_16x16x32_bf16 v[72:75], a[80:83], a[104:107], v[72:75]
    ds_read_b64_tr_b16 a[28:29], v160 offset:24576
    v_mfma_f32_16x16x32_bf16 v[76:79], a[80:83], a[108:111], v[76:79]
    ds_read_b64_tr_b16 a[30:31], v160 offset:25600
    v_mfma_f32_16x16x32_bf16 v[80:83], a[84:87], a[96:99], v[80:83]
    v_mfma_f32_16x16x32_bf16 v[84:87], a[84:87], a[100:103], v[84:87]
    ds_write_b128 v152, a[144:147] offset:0
    v_mfma_f32_16x16x32_bf16 v[88:91], a[84:87], a[104:107], v[88:91]
    v_mfma_f32_16x16x32_bf16 v[92:95], a[84:87], a[108:111], v[92:95]
    ds_write_b128 v152, a[148:151] offset:1024
    v_mfma_f32_16x16x32_bf16 v[96:99], a[88:91], a[96:99], v[96:99]
    v_mfma_f32_16x16x32_bf16 v[100:103], a[88:91], a[100:103], v[100:103]
    ds_write_b128 v152, a[152:155] offset:2048
    v_mfma_f32_16x16x32_bf16 v[104:107], a[88:91], a[104:107], v[104:107]
    v_mfma_f32_16x16x32_bf16 v[108:111], a[88:91], a[108:111], v[108:111]
    ds_write_b128 v152, a[156:159] offset:3072
    v_mfma_f32_16x16x32_bf16 v[112:115], a[92:95], a[96:99], v[112:115]
    v_mfma_f32_16x16x32_bf16 v[116:119], a[92:95], a[100:103], v[116:119]
    v_mfma_f32_16x16x32_bf16 v[120:123], a[92:95], a[104:107], v[120:123]
    v_mfma_f32_16x16x32_bf16 v[124:127], a[92:95], a[108:111], v[124:127]
    s_waitcnt lgkmcnt(4)
    v_mfma_f32_16x16x32_bf16 v[0:3], a[0:3], a[32:35], v[0:3]
    v_mfma_f32_16x16x32_bf16 v[4:7], a[0:3], a[36:39], v[4:7]
    s_waitcnt vmcnt(16) lgkmcnt(0)
    s_barrier
    ds_read_b128 a[96:99], v142 offset:0
    v_mfma_f32_16x16x32_bf16 v[8:11], a[0:3], a[40:43], v[8:11]
    ds_read_b128 a[100:103], v142 offset:2048
    v_mfma_f32_16x16x32_bf16 v[12:15], a[0:3], a[44:47], v[12:15]
    ds_read_b128 a[104:107], v142 offset:4096
    s_add_u32 m0, s36, 32768
    s_nop 0
    buffer_load_dwordx4 v128, s[4:7], s32 offen offset:0 lds
    v_mfma_f32_16x16x32_bf16 v[16:19], a[4:7], a[32:35], v[16:19]
    ds_read_b128 a[108:111], v142 offset:6144
    v_mfma_f32_16x16x32_bf16 v[20:23], a[4:7], a[36:39], v[20:23]
    ds_read_b64_tr_b16 a[64:65], v153 offset:0
    v_mfma_f32_16x16x32_bf16 v[24:27], a[4:7], a[40:43], v[24:27]
    ds_read_b64_tr_b16 a[66:67], v153 offset:1024
    buffer_load_dwordx4 v129, s[4:7], s32 offen offset:1024 lds
    v_mfma_f32_16x16x32_bf16 v[28:31], a[4:7], a[44:47], v[28:31]
    ds_read_b64_tr_b16 a[68:69], v154 offset:0
    v_mfma_f32_16x16x32_bf16 v[32:35], a[8:11], a[32:35], v[32:35]
    ds_read_b64_tr_b16 a[70:71], v154 offset:1024
    v_mfma_f32_16x16x32_bf16 v[36:39], a[8:11], a[36:39], v[36:39]
    ds_read_b64_tr_b16 a[72:73], v155 offset:0
    buffer_load_dwordx4 v130, s[4:7], s32 offen offset:2048 lds
    v_mfma_f32_16x16x32_bf16 v[40:43], a[8:11], a[40:43], v[40:43]
    ds_read_b64_tr_b16 a[74:75], v155 offset:1024
    v_mfma_f32_16x16x32_bf16 v[44:47], a[8:11], a[44:47], v[44:47]
    ds_read_b64_tr_b16 a[76:77], v156 offset:0
    v_mfma_f32_16x16x32_bf16 v[48:51], a[12:15], a[32:35], v[48:51]
    ds_read_b64_tr_b16 a[78:79], v156 offset:1024
    buffer_load_dwordx4 v131, s[4:7], s32 offen offset:3072 lds
    v_mfma_f32_16x16x32_bf16 v[52:55], a[12:15], a[36:39], v[52:55]
    ds_read_b64_tr_b16 a[80:81], v157 offset:0
    v_mfma_f32_16x16x32_bf16 v[56:59], a[12:15], a[40:43], v[56:59]
    ds_read_b64_tr_b16 a[82:83], v157 offset:1024
    v_mfma_f32_16x16x32_bf16 v[60:63], a[12:15], a[44:47], v[60:63]
    ds_read_b64_tr_b16 a[84:85], v158 offset:0
    v_mfma_f32_16x16x32_bf16 v[64:67], a[16:19], a[32:35], v[64:67]
    ds_read_b64_tr_b16 a[86:87], v158 offset:1024
    v_mfma_f32_16x16x32_bf16 v[68:71], a[16:19], a[36:39], v[68:71]
    ds_read_b64_tr_b16 a[88:89], v159 offset:0
    v_mfma_f32_16x16x32_bf16 v[72:75], a[16:19], a[40:43], v[72:75]
    ds_read_b64_tr_b16 a[90:91], v159 offset:1024
    s_add_u32 m0, s36, 36864
    s_nop 0
    buffer_load_dwordx4 v132, s[4:7], s32 offen offset:0 lds
    v_mfma_f32_16x16x32_bf16 v[76:79], a[16:19], a[44:47], v[76:79]
    ds_read_b64_tr_b16 a[92:93], v160 offset:0
    v_mfma_f32_16x16x32_bf16 v[80:83], a[20:23], a[32:35], v[80:83]
    ds_read_b64_tr_b16 a[94:95], v160 offset:1024
    v_mfma_f32_16x16x32_bf16 v[84:87], a[20:23], a[36:39], v[84:87]
    buffer_load_dwordx4 v133, s[4:7], s32 offen offset:1024 lds
    v_mfma_f32_16x16x32_bf16 v[88:91], a[20:23], a[40:43], v[88:91]
    v_mfma_f32_16x16x32_bf16 v[92:95], a[20:23], a[44:47], v[92:95]
    v_mfma_f32_16x16x32_bf16 v[96:99], a[24:27], a[32:35], v[96:99]
    buffer_load_dwordx4 v134, s[4:7], s32 offen offset:2048 lds
    v_mfma_f32_16x16x32_bf16 v[100:103], a[24:27], a[36:39], v[100:103]
    v_mfma_f32_16x16x32_bf16 v[104:107], a[24:27], a[40:43], v[104:107]
    v_mfma_f32_16x16x32_bf16 v[108:111], a[24:27], a[44:47], v[108:111]
    v_mfma_f32_16x16x32_bf16 v[112:115], a[28:31], a[32:35], v[112:115]
    v_mfma_f32_16x16x32_bf16 v[116:119], a[28:31], a[36:39], v[116:119]
    v_mfma_f32_16x16x32_bf16 v[120:123], a[28:31], a[40:43], v[120:123]
    buffer_load_dwordx4 v135, s[4:7], s32 offen offset:3072 lds
    s_add_u32 s32, s32, 128
    v_mfma_f32_16x16x32_bf16 v[124:127], a[28:31], a[44:47], v[124:127]
    s_waitcnt lgkmcnt(0)
    s_waitcnt vmcnt(20)
    v_mfma_f32_16x16x32_bf16 v[0:3], a[64:67], a[96:99], v[0:3]
    ds_read_b128 a[32:35], v143 offset:0
    buffer_load_dwordx4 a[192:195], v136, s[8:11], s33 offen
    v_mfma_f32_16x16x32_bf16 v[4:7], a[64:67], a[100:103], v[4:7]
    ds_read_b128 a[36:39], v143 offset:2048
    v_mfma_f32_16x16x32_bf16 v[8:11], a[64:67], a[104:107], v[8:11]
    ds_read_b128 a[40:43], v143 offset:4096
    v_mfma_f32_16x16x32_bf16 v[12:15], a[64:67], a[108:111], v[12:15]
    ds_read_b128 a[44:47], v143 offset:6144
    buffer_load_dwordx4 a[196:199], v137, s[8:11], s33 offen
    v_mfma_f32_16x16x32_bf16 v[16:19], a[68:71], a[96:99], v[16:19]
    ds_read_b64_tr_b16 a[0:1], v153 offset:8192
    buffer_load_dwordx4 a[200:203], v138, s[8:11], s33 offen
    v_mfma_f32_16x16x32_bf16 v[20:23], a[68:71], a[100:103], v[20:23]
    ds_read_b64_tr_b16 a[2:3], v153 offset:9216
    v_mfma_f32_16x16x32_bf16 v[24:27], a[68:71], a[104:107], v[24:27]
    ds_read_b64_tr_b16 a[4:5], v154 offset:8192
    v_mfma_f32_16x16x32_bf16 v[28:31], a[68:71], a[108:111], v[28:31]
    ds_read_b64_tr_b16 a[6:7], v154 offset:9216
    v_mfma_f32_16x16x32_bf16 v[32:35], a[72:75], a[96:99], v[32:35]
    ds_read_b64_tr_b16 a[8:9], v155 offset:8192
    buffer_load_dwordx4 a[204:207], v139, s[8:11], s33 offen
    s_add_u32 s33, s33, 0x80000
    v_mfma_f32_16x16x32_bf16 v[36:39], a[72:75], a[100:103], v[36:39]
    ds_read_b64_tr_b16 a[10:11], v155 offset:9216
    v_mfma_f32_16x16x32_bf16 v[40:43], a[72:75], a[104:107], v[40:43]
    ds_read_b64_tr_b16 a[12:13], v156 offset:8192
    v_mfma_f32_16x16x32_bf16 v[44:47], a[72:75], a[108:111], v[44:47]
    ds_read_b64_tr_b16 a[14:15], v156 offset:9216
    v_mfma_f32_16x16x32_bf16 v[48:51], a[76:79], a[96:99], v[48:51]
    ds_read_b64_tr_b16 a[16:17], v157 offset:8192
    s_add_u32 m0, s35, 98304
    s_nop 0
    buffer_load_dwordx4 v196, s[12:15], s27 offen nt lds
    v_mfma_f32_16x16x32_bf16 v[52:55], a[76:79], a[100:103], v[52:55]
    ds_read_b64_tr_b16 a[18:19], v157 offset:9216
    v_mfma_f32_16x16x32_bf16 v[56:59], a[76:79], a[104:107], v[56:59]
    ds_read_b64_tr_b16 a[20:21], v158 offset:8192
    v_mfma_f32_16x16x32_bf16 v[60:63], a[76:79], a[108:111], v[60:63]
    ds_read_b64_tr_b16 a[22:23], v158 offset:9216
    v_mfma_f32_16x16x32_bf16 v[64:67], a[80:83], a[96:99], v[64:67]
    ds_read_b64_tr_b16 a[24:25], v159 offset:8192
    buffer_load_dwordx4 v197, s[12:15], s27 offen offset:1024 nt lds
    v_mfma_f32_16x16x32_bf16 v[68:71], a[80:83], a[100:103], v[68:71]
    ds_read_b64_tr_b16 a[26:27], v159 offset:9216
    v_mfma_f32_16x16x32_bf16 v[72:75], a[80:83], a[104:107], v[72:75]
    ds_read_b64_tr_b16 a[28:29], v160 offset:8192
    v_mfma_f32_16x16x32_bf16 v[76:79], a[80:83], a[108:111], v[76:79]
    ds_read_b64_tr_b16 a[30:31], v160 offset:9216
    v_mfma_f32_16x16x32_bf16 v[80:83], a[84:87], a[96:99], v[80:83]
    buffer_load_dwordx4 v198, s[16:19], s27 offen offset:2048 nt lds
    v_mfma_f32_16x16x32_bf16 v[84:87], a[84:87], a[100:103], v[84:87]
    ds_write_b128 v152, a[160:163] offset:16384
    v_mfma_f32_16x16x32_bf16 v[88:91], a[84:87], a[104:107], v[88:91]
    v_mfma_f32_16x16x32_bf16 v[92:95], a[84:87], a[108:111], v[92:95]
    ds_write_b128 v152, a[164:167] offset:17408
    v_mfma_f32_16x16x32_bf16 v[96:99], a[88:91], a[96:99], v[96:99]
    buffer_load_dwordx4 v199, s[16:19], s27 offen offset:3072 nt lds
    s_add_u32 s27, s27, 8192
    v_mfma_f32_16x16x32_bf16 v[100:103], a[88:91], a[100:103], v[100:103]
    ds_write_b128 v152, a[168:171] offset:18432
    v_mfma_f32_16x16x32_bf16 v[104:107], a[88:91], a[104:107], v[104:107]
    v_mfma_f32_16x16x32_bf16 v[108:111], a[88:91], a[108:111], v[108:111]
    ds_write_b128 v152, a[172:175] offset:19456
    v_mfma_f32_16x16x32_bf16 v[112:115], a[92:95], a[96:99], v[112:115]
    v_mfma_f32_16x16x32_bf16 v[116:119], a[92:95], a[100:103], v[116:119]
    v_mfma_f32_16x16x32_bf16 v[120:123], a[92:95], a[104:107], v[120:123]
    v_mfma_f32_16x16x32_bf16 v[124:127], a[92:95], a[108:111], v[124:127]
    s_waitcnt lgkmcnt(4)
    v_mfma_f32_16x16x32_bf16 v[0:3], a[0:3], a[32:35], v[0:3]
    v_mfma_f32_16x16x32_bf16 v[4:7], a[0:3], a[36:39], v[4:7]
    s_waitcnt vmcnt(20) lgkmcnt(0)
    s_barrier
    ds_read_b128 a[96:99], v140 offset:0
    v_mfma_f32_16x16x32_bf16 v[8:11], a[0:3], a[40:43], v[8:11]
    ds_read_b128 a[100:103], v140 offset:2048
    v_mfma_f32_16x16x32_bf16 v[12:15], a[0:3], a[44:47], v[12:15]
    ds_read_b128 a[104:107], v140 offset:4096
    s_add_u32 m0, s36, 65536
    s_nop 0
    buffer_load_dwordx4 v128, s[4:7], s32 offen offset:0 lds
    v_mfma_f32_16x16x32_bf16 v[16:19], a[4:7], a[32:35], v[16:19]
    ds_read_b128 a[108:111], v140 offset:6144
    v_mfma_f32_16x16x32_bf16 v[20:23], a[4:7], a[36:39], v[20:23]
    ds_read_b64_tr_b16 a[64:65], v153 offset:16384
    v_mfma_f32_16x16x32_bf16 v[24:27], a[4:7], a[40:43], v[24:27]
    ds_read_b64_tr_b16 a[66:67], v153 offset:17408
    buffer_load_dwordx4 v129, s[4:7], s32 offen offset:1024 lds
    v_mfma_f32_16x16x32_bf16 v[28:31], a[4:7], a[44:47], v[28:31]
    ds_read_b64_tr_b16 a[68:69], v154 offset:16384
    v_mfma_f32_16x16x32_bf16 v[32:35], a[8:11], a[32:35], v[32:35]
    ds_read_b64_tr_b16 a[70:71], v154 offset:17408
    v_mfma_f32_16x16x32_bf16 v[36:39], a[8:11], a[36:39], v[36:39]
    ds_read_b64_tr_b16 a[72:73], v155 offset:16384
    buffer_load_dwordx4 v130, s[4:7], s32 offen offset:2048 lds
    v_mfma_f32_16x16x32_bf16 v[40:43], a[8:11], a[40:43], v[40:43]
    ds_read_b64_tr_b16 a[74:75], v155 offset:17408
    v_mfma_f32_16x16x32_bf16 v[44:47], a[8:11], a[44:47], v[44:47]
    ds_read_b64_tr_b16 a[76:77], v156 offset:16384
    v_mfma_f32_16x16x32_bf16 v[48:51], a[12:15], a[32:35], v[48:51]
    ds_read_b64_tr_b16 a[78:79], v156 offset:17408
    buffer_load_dwordx4 v131, s[4:7], s32 offen offset:3072 lds
    v_mfma_f32_16x16x32_bf16 v[52:55], a[12:15], a[36:39], v[52:55]
    ds_read_b64_tr_b16 a[80:81], v157 offset:16384
    v_mfma_f32_16x16x32_bf16 v[56:59], a[12:15], a[40:43], v[56:59]
    ds_read_b64_tr_b16 a[82:83], v157 offset:17408
    v_mfma_f32_16x16x32_bf16 v[60:63], a[12:15], a[44:47], v[60:63]
    ds_read_b64_tr_b16 a[84:85], v158 offset:16384
    v_mfma_f32_16x16x32_bf16 v[64:67], a[16:19], a[32:35], v[64:67]
    ds_read_b64_tr_b16 a[86:87], v158 offset:17408
    v_mfma_f32_16x16x32_bf16 v[68:71], a[16:19], a[36:39], v[68:71]
    ds_read_b64_tr_b16 a[88:89], v159 offset:16384
    v_mfma_f32_16x16x32_bf16 v[72:75], a[16:19], a[40:43], v[72:75]
    ds_read_b64_tr_b16 a[90:91], v159 offset:17408
    s_add_u32 m0, s36, 69632
    s_nop 0
    buffer_load_dwordx4 v132, s[4:7], s32 offen offset:0 lds
    v_mfma_f32_16x16x32_bf16 v[76:79], a[16:19], a[44:47], v[76:79]
    ds_read_b64_tr_b16 a[92:93], v160 offset:16384
    v_mfma_f32_16x16x32_bf16 v[80:83], a[20:23], a[32:35], v[80:83]
    ds_read_b64_tr_b16 a[94:95], v160 offset:17408
    v_mfma_f32_16x16x32_bf16 v[84:87], a[20:23], a[36:39], v[84:87]
    buffer_load_dwordx4 v133, s[4:7], s32 offen offset:1024 lds
    v_mfma_f32_16x16x32_bf16 v[88:91], a[20:23], a[40:43], v[88:91]
    v_mfma_f32_16x16x32_bf16 v[92:95], a[20:23], a[44:47], v[92:95]
    v_mfma_f32_16x16x32_bf16 v[96:99], a[24:27], a[32:35], v[96:99]
    buffer_load_dwordx4 v134, s[4:7], s32 offen offset:2048 lds
    v_mfma_f32_16x16x32_bf16 v[100:103], a[24:27], a[36:39], v[100:103]
    v_mfma_f32_16x16x32_bf16 v[104:107], a[24:27], a[40:43], v[104:107]
    v_mfma_f32_16x16x32_bf16 v[108:111], a[24:27], a[44:47], v[108:111]
    v_mfma_f32_16x16x32_bf16 v[112:115], a[28:31], a[32:35], v[112:115]
    v_mfma_f32_16x16x32_bf16 v[116:119], a[28:31], a[36:39], v[116:119]
    v_mfma_f32_16x16x32_bf16 v[120:123], a[28:31], a[40:43], v[120:123]
    buffer_load_dwordx4 v135, s[4:7], s32 offen offset:3072 lds
    s_add_u32 s32, s32, 128
    v_mfma_f32_16x16x32_bf16 v[124:127], a[28:31], a[44:47], v[124:127]
    s_waitcnt lgkmcnt(0)
    s_waitcnt vmcnt(24)
    v_mfma_f32_16x16x32_bf16 v[0:3], a[64:67], a[96:99], v[0:3]
    ds_read_b128 a[32:35], v141 offset:0
    buffer_load_dwordx4 a[208:211], v136, s[8:11], s33 offen
    v_mfma_f32_16x16x32_bf16 v[4:7], a[64:67], a[100:103], v[4:7]
    ds_read_b128 a[36:39], v141 offset:2048
    v_mfma_f32_16x16x32_bf16 v[8:11], a[64:67], a[104:107], v[8:11]
    ds_read_b128 a[40:43], v141 offset:4096
    v_mfma_f32_16x16x32_bf16 v[12:15], a[64:67], a[108:111], v[12:15]
    ds_read_b128 a[44:47], v141 offset:6144
    buffer_load_dwordx4 a[212:215], v137, s[8:11], s33 offen
    v_mfma_f32_16x16x32_bf16 v[16:19], a[68:71], a[96:99], v[16:19]
    ds_read_b64_tr_b16 a[0:1], v153 offset:24576
    buffer_load_dwordx4 a[216:219], v138, s[8:11], s33 offen
    v_mfma_f32_16x16x32_bf16 v[20:23], a[68:71], a[100:103], v[20:23]
    ds_read_b64_tr_b16 a[2:3], v153 offset:25600
    v_mfma_f32_16x16x32_bf16 v[24:27], a[68:71], a[104:107], v[24:27]
    ds_read_b64_tr_b16 a[4:5], v154 offset:24576
    v_mfma_f32_16x16x32_bf16 v[28:31], a[68:71], a[108:111], v[28:31]
    ds_read_b64_tr_b16 a[6:7], v154 offset:25600
    v_mfma_f32_16x16x32_bf16 v[32:35], a[72:75], a[96:99], v[32:35]
    ds_read_b64_tr_b16 a[8:9], v155 offset:24576
    buffer_load_dwordx4 a[220:223], v139, s[8:11], s33 offen
    s_add_u32 s33, s33, 0x80000
    v_mfma_f32_16x16x32_bf16 v[36:39], a[72:75], a[100:103], v[36:39]
    ds_read_b64_tr_b16 a[10:11], v155 offset:25600
    v_mfma_f32_16x16x32_bf16 v[40:43], a[72:75], a[104:107], v[40:43]
    ds_read_b64_tr_b16 a[12:13], v156 offset:24576
    v_mfma_f32_16x16x32_bf16 v[44:47], a[72:75], a[108:111], v[44:47]
    ds_read_b64_tr_b16 a[14:15], v156 offset:25600
    v_mfma_f32_16x16x32_bf16 v[48:51], a[76:79], a[96:99], v[48:51]
    ds_read_b64_tr_b16 a[16:17], v157 offset:24576
    s_add_u32 m0, s35, 114688
    s_nop 0
    buffer_load_dwordx4 v196, s[12:15], s27 offen nt lds
    v_mfma_f32_16x16x32_bf16 v[52:55], a[76:79], a[100:103], v[52:55]
    ds_read_b64_tr_b16 a[18:19], v157 offset:25600
    v_mfma_f32_16x16x32_bf16 v[56:59], a[76:79], a[104:107], v[56:59]
    ds_read_b64_tr_b16 a[20:21], v158 offset:24576
    v_mfma_f32_16x16x32_bf16 v[60:63], a[76:79], a[108:111], v[60:63]
    ds_read_b64_tr_b16 a[22:23], v158 offset:25600
    v_mfma_f32_16x16x32_bf16 v[64:67], a[80:83], a[96:99], v[64:67]
    ds_read_b64_tr_b16 a[24:25], v159 offset:24576
    buffer_load_dwordx4 v197, s[12:15], s27 offen offset:1024 nt lds
    v_mfma_f32_16x16x32_bf16 v[68:71], a[80:83], a[100:103], v[68:71]
    ds_read_b64_tr_b16 a[26:27], v159 offset:25600
    v_mfma_f32_16x16x32_bf16 v[72:75], a[80:83], a[104:107], v[72:75]
    ds_read_b64_tr_b16 a[28:29], v160 offset:24576
    v_mfma_f32_16x16x32_bf16 v[76:79], a[80:83], a[108:111], v[76:79]
    ds_read_b64_tr_b16 a[30:31], v160 offset:25600
    v_mfma_f32_16x16x32_bf16 v[80:83], a[84:87], a[96:99], v[80:83]
    buffer_load_dwordx4 v198, s[16:19], s27 offen offset:2048 nt lds
    v_mfma_f32_16x16x32_bf16 v[84:87], a[84:87], a[100:103], v[84:87]
    ds_write_b128 v152, a[176:179] offset:0
    v_mfma_f32_16x16x32_bf16 v[88:91], a[84:87], a[104:107], v[88:91]
    v_mfma_f32_16x16x32_bf16 v[92:95], a[84:87], a[108:111], v[92:95]
    ds_write_b128 v152, a[180:183] offset:1024
    v_mfma_f32_16x16x32_bf16 v[96:99], a[88:91], a[96:99], v[96:99]
    buffer_load_dwordx4 v199, s[16:19], s27 offen offset:3072 nt lds
    s_add_u32 s27, s27, 8192
    v_mfma_f32_16x16x32_bf16 v[100:103], a[88:91], a[100:103], v[100:103]
    ds_write_b128 v152, a[184:187] offset:2048
    v_mfma_f32_16x16x32_bf16 v[104:107], a[88:91], a[104:107], v[104:107]
    v_mfma_f32_16x16x32_bf16 v[108:111], a[88:91], a[108:111], v[108:111]
    ds_write_b128 v152, a[188:191] offset:3072
    v_mfma_f32_16x16x32_bf16 v[112:115], a[92:95], a[96:99], v[112:115]
    v_mfma_f32_16x16x32_bf16 v[116:119], a[92:95], a[100:103], v[116:119]
    v_mfma_f32_16x16x32_bf16 v[120:123], a[92:95], a[104:107], v[120:123]
    v_mfma_f32_16x16x32_bf16 v[124:127], a[92:95], a[108:111], v[124:127]
    s_waitcnt lgkmcnt(4)
    v_mfma_f32_16x16x32_bf16 v[0:3], a[0:3], a[32:35], v[0:3]
    v_mfma_f32_16x16x32_bf16 v[4:7], a[0:3], a[36:39], v[4:7]
    s_waitcnt vmcnt(24) lgkmcnt(0)
    s_barrier
    ds_read_b128 a[96:99], v140 offset:32768
    v_mfma_f32_16x16x32_bf16 v[8:11], a[0:3], a[40:43], v[8:11]
    ds_read_b128 a[100:103], v140 offset:34816
    v_mfma_f32_16x16x32_bf16 v[12:15], a[0:3], a[44:47], v[12:15]
    ds_read_b128 a[104:107], v140 offset:36864
    v_mfma_f32_16x16x32_bf16 v[16:19], a[4:7], a[32:35], v[16:19]
    ds_read_b128 a[108:111], v140 offset:38912
    s_add_u32 m0, s36, 0
    s_nop 0
    buffer_load_dwordx4 v128, s[4:7], s32 offen offset:0 lds
    v_mfma_f32_16x16x32_bf16 v[20:23], a[4:7], a[36:39], v[20:23]
    ds_read_b64_tr_b16 a[64:65], v153 offset:0
    v_mfma_f32_16x16x32_bf16 v[24:27], a[4:7], a[40:43], v[24:27]
    ds_read_b64_tr_b16 a[66:67], v153 offset:1024
    v_mfma_f32_16x16x32_bf16 v[28:31], a[4:7], a[44:47], v[28:31]
    ds_read_b64_tr_b16 a[68:69], v154 offset:0
    v_mfma_f32_16x16x32_bf16 v[32:35], a[8:11], a[32:35], v[32:35]
    ds_read_b64_tr_b16 a[70:71], v154 offset:1024
    buffer_load_dwordx4 v129, s[4:7], s32 offen offset:1024 lds
    v_mfma_f32_16x16x32_bf16 v[36:39], a[8:11], a[36:39], v[36:39]
    ds_read_b64_tr_b16 a[72:73], v155 offset:0
    v_mfma_f32_16x16x32_bf16 v[40:43], a[8:11], a[40:43], v[40:43]
    ds_read_b64_tr_b16 a[74:75], v155 offset:1024
    v_mfma_f32_16x16x32_bf16 v[44:47], a[8:11], a[44:47], v[44:47]
    ds_read_b64_tr_b16 a[76:77], v156 offset:0
    v_mfma_f32_16x16x32_bf16 v[48:51], a[12:15], a[32:35], v[48:51]
    ds_read_b64_tr_b16 a[78:79], v156 offset:1024
    buffer_load_dwordx4 v130, s[4:7], s32 offen offset:2048 lds
    v_mfma_f32_16x16x32_bf16 v[52:55], a[12:15], a[36:39], v[52:55]
    ds_read_b64_tr_b16 a[80:81], v157 offset:0
    v_mfma_f32_16x16x32_bf16 v[56:59], a[12:15], a[40:43], v[56:59]
    ds_read_b64_tr_b16 a[82:83], v157 offset:1024
    v_mfma_f32_16x16x32_bf16 v[60:63], a[12:15], a[44:47], v[60:63]
    ds_read_b64_tr_b16 a[84:85], v158 offset:0
    v_mfma_f32_16x16x32_bf16 v[64:67], a[16:19], a[32:35], v[64:67]
    ds_read_b64_tr_b16 a[86:87], v158 offset:1024
    buffer_load_dwordx4 v131, s[4:7], s32 offen offset:3072 lds
    v_mfma_f32_16x16x32_bf16 v[68:71], a[16:19], a[36:39], v[68:71]
    ds_read_b64_tr_b16 a[88:89], v159 offset:0
    v_mfma_f32_16x16x32_bf16 v[72:75], a[16:19], a[40:43], v[72:75]
    ds_read_b64_tr_b16 a[90:91], v159 offset:1024
    v_mfma_f32_16x16x32_bf16 v[76:79], a[16:19], a[44:47], v[76:79]
    ds_read_b64_tr_b16 a[92:93], v160 offset:0
    v_mfma_f32_16x16x32_bf16 v[80:83], a[20:23], a[32:35], v[80:83]
    ds_read_b64_tr_b16 a[94:95], v160 offset:1024
    s_add_u32 m0, s36, 4096
    s_nop 0
    buffer_load_dwordx4 v132, s[4:7], s32 offen offset:0 lds
    v_mfma_f32_16x16x32_bf16 v[84:87], a[20:23], a[36:39], v[84:87]
    v_mfma_f32_16x16x32_bf16 v[88:91], a[20:23], a[40:43], v[88:91]
    v_mfma_f32_16x16x32_bf16 v[92:95], a[20:23], a[44:47], v[92:95]
    v_mfma_f32_16x16x32_bf16 v[96:99], a[24:27], a[32:35], v[96:99]
    buffer_load_dwordx4 v133, s[4:7], s32 offen offset:1024 lds
    v_mfma_f32_16x16x32_bf16 v[100:103], a[24:27], a[36:39], v[100:103]
    v_mfma_f32_16x16x32_bf16 v[104:107], a[24:27], a[40:43], v[104:107]
    v_mfma_f32_16x16x32_bf16 v[108:111], a[24:27], a[44:47], v[108:111]
    v_mfma_f32_16x16x32_bf16 v[112:115], a[28:31], a[32:35], v[112:115]
    buffer_load_dwordx4 v134, s[4:7], s32 offen offset:2048 lds
    v_mfma_f32_16x16x32_bf16 v[116:119], a[28:31], a[36:39], v[116:119]
    v_mfma_f32_16x16x32_bf16 v[120:123], a[28:31], a[40:43], v[120:123]
    v_mfma_f32_16x16x32_bf16 v[124:127], a[28:31], a[44:47], v[124:127]
    s_waitcnt lgkmcnt(0)
    s_waitcnt vmcnt(27)
    v_mfma_f32_16x16x32_bf16 v[0:3], a[64:67], a[96:99], v[0:3]
    ds_read_b128 a[32:35], v141 offset:32768
    buffer_load_dwordx4 v135, s[4:7], s32 offen offset:3072 lds
    s_add_u32 s32, s32, 128
    v_mfma_f32_16x16x32_bf16 v[4:7], a[64:67], a[100:103], v[4:7]
    ds_read_b128 a[36:39], v141 offset:34816
    v_mfma_f32_16x16x32_bf16 v[8:11], a[64:67], a[104:107], v[8:11]
    ds_read_b128 a[40:43], v141 offset:36864
    v_mfma_f32_16x16x32_bf16 v[12:15], a[64:67], a[108:111], v[12:15]
    ds_read_b128 a[44:47], v141 offset:38912
    v_mfma_f32_16x16x32_bf16 v[16:19], a[68:71], a[96:99], v[16:19]
    ds_read_b64_tr_b16 a[0:1], v153 offset:8192
    buffer_load_dwordx4 a[224:227], v136, s[8:11], s33 offen
    v_mfma_f32_16x16x32_bf16 v[20:23], a[68:71], a[100:103], v[20:23]
    ds_read_b64_tr_b16 a[2:3], v153 offset:9216
    v_mfma_f32_16x16x32_bf16 v[24:27], a[68:71], a[104:107], v[24:27]
    ds_read_b64_tr_b16 a[4:5], v154 offset:8192
    v_mfma_f32_16x16x32_bf16 v[28:31], a[68:71], a[108:111], v[28:31]
    ds_read_b64_tr_b16 a[6:7], v154 offset:9216
    v_mfma_f32_16x16x32_bf16 v[32:35], a[72:75], a[96:99], v[32:35]
    ds_read_b64_tr_b16 a[8:9], v155 offset:8192
    buffer_load_dwordx4 a[228:231], v137, s[8:11], s33 offen
    v_mfma_f32_16x16x32_bf16 v[36:39], a[72:75], a[100:103], v[36:39]
    ds_read_b64_tr_b16 a[10:11], v155 offset:9216
    v_mfma_f32_16x16x32_bf16 v[40:43], a[72:75], a[104:107], v[40:43]
    ds_read_b64_tr_b16 a[12:13], v156 offset:8192
    v_mfma_f32_16x16x32_bf16 v[44:47], a[72:75], a[108:111], v[44:47]
    ds_read_b64_tr_b16 a[14:15], v156 offset:9216
    v_mfma_f32_16x16x32_bf16 v[48:51], a[76:79], a[96:99], v[48:51]
    ds_read_b64_tr_b16 a[16:17], v157 offset:8192
    buffer_load_dwordx4 a[232:235], v138, s[8:11], s33 offen
    v_mfma_f32_16x16x32_bf16 v[52:55], a[76:79], a[100:103], v[52:55]
    ds_read_b64_tr_b16 a[18:19], v157 offset:9216
    v_mfma_f32_16x16x32_bf16 v[56:59], a[76:79], a[104:107], v[56:59]
    ds_read_b64_tr_b16 a[20:21], v158 offset:8192
    v_mfma_f32_16x16x32_bf16 v[60:63], a[76:79], a[108:111], v[60:63]
    ds_read_b64_tr_b16 a[22:23], v158 offset:9216
    v_mfma_f32_16x16x32_bf16 v[64:67], a[80:83], a[96:99], v[64:67]
    ds_read_b64_tr_b16 a[24:25], v159 offset:8192
    buffer_load_dwordx4 a[236:239], v139, s[8:11], s33 offen
    s_add_u32 s33, s33, 0x80000
    v_mfma_f32_16x16x32_bf16 v[68:71], a[80:83], a[100:103], v[68:71]
    ds_read_b64_tr_b16 a[26:27], v159 offset:9216
    v_mfma_f32_16x16x32_bf16 v[72:75], a[80:83], a[104:107], v[72:75]
    ds_read_b64_tr_b16 a[28:29], v160 offset:8192
    v_mfma_f32_16x16x32_bf16 v[76:79], a[80:83], a[108:111], v[76:79]
    ds_read_b64_tr_b16 a[30:31], v160 offset:9216
    v_mfma_f32_16x16x32_bf16 v[80:83], a[84:87], a[96:99], v[80:83]
    v_mfma_f32_16x16x32_bf16 v[84:87], a[84:87], a[100:103], v[84:87]
    ds_write_b128 v152, a[192:195] offset:16384
    v_mfma_f32_16x16x32_bf16 v[88:91], a[84:87], a[104:107], v[88:91]
    v_mfma_f32_16x16x32_bf16 v[92:95], a[84:87], a[108:111], v[92:95]
    ds_write_b128 v152, a[196:199] offset:17408
    v_mfma_f32_16x16x32_bf16 v[96:99], a[88:91], a[96:99], v[96:99]
    v_mfma_f32_16x16x32_bf16 v[100:103], a[88:91], a[100:103], v[100:103]
    ds_write_b128 v152, a[200:203] offset:18432
    v_mfma_f32_16x16x32_bf16 v[104:107], a[88:91], a[104:107], v[104:107]
    v_mfma_f32_16x16x32_bf16 v[108:111], a[88:91], a[108:111], v[108:111]
    ds_write_b128 v152, a[204:207] offset:19456
    v_mfma_f32_16x16x32_bf16 v[112:115], a[92:95], a[96:99], v[112:115]
    v_mfma_f32_16x16x32_bf16 v[116:119], a[92:95], a[100:103], v[116:119]
    v_mfma_f32_16x16x32_bf16 v[120:123], a[92:95], a[104:107], v[120:123]
    v_mfma_f32_16x16x32_bf16 v[124:127], a[92:95], a[108:111], v[124:127]
    s_waitcnt lgkmcnt(4)
    v_mfma_f32_16x16x32_bf16 v[0:3], a[0:3], a[32:35], v[0:3]
    v_mfma_f32_16x16x32_bf16 v[4:7], a[0:3], a[36:39], v[4:7]
    s_waitcnt vmcnt(20) lgkmcnt(0)
    s_barrier
    ds_read_b128 a[96:99], v142 offset:0
    v_mfma_f32_16x16x32_bf16 v[8:11], a[0:3], a[40:43], v[8:11]
    ds_read_b128 a[100:103], v142 offset:2048
    v_mfma_f32_16x16x32_bf16 v[12:15], a[0:3], a[44:47], v[12:15]
    ds_read_b128 a[104:107], v142 offset:4096
    v_mfma_f32_16x16x32_bf16 v[16:19], a[4:7], a[32:35], v[16:19]
    ds_read_b128 a[108:111], v142 offset:6144
    s_add_u32 m0, s36, 32768
    s_nop 0
    buffer_load_dwordx4 v128, s[4:7], s32 offen offset:0 lds
    v_mfma_f32_16x16x32_bf16 v[20:23], a[4:7], a[36:39], v[20:23]
    ds_read_b64_tr_b16 a[64:65], v153 offset:16384
    v_mfma_f32_16x16x32_bf16 v[24:27], a[4:7], a[40:43], v[24:27]
    ds_read_b64_tr_b16 a[66:67], v153 offset:17408
    v_mfma_f32_16x16x32_bf16 v[28:31], a[4:7], a[44:47], v[28:31]
    ds_read_b64_tr_b16 a[68:69], v154 offset:16384
    v_mfma_f32_16x16x32_bf16 v[32:35], a[8:11], a[32:35], v[32:35]
    ds_read_b64_tr_b16 a[70:71], v154 offset:17408
    buffer_load_dwordx4 v129, s[4:7], s32 offen offset:1024 lds
    v_mfma_f32_16x16x32_bf16 v[36:39], a[8:11], a[36:39], v[36:39]
    ds_read_b64_tr_b16 a[72:73], v155 offset:16384
    v_mfma_f32_16x16x32_bf16 v[40:43], a[8:11], a[40:43], v[40:43]
    ds_read_b64_tr_b16 a[74:75], v155 offset:17408
    v_mfma_f32_16x16x32_bf16 v[44:47], a[8:11], a[44:47], v[44:47]
    ds_read_b64_tr_b16 a[76:77], v156 offset:16384
    v_mfma_f32_16x16x32_bf16 v[48:51], a[12:15], a[32:35], v[48:51]
    ds_read_b64_tr_b16 a[78:79], v156 offset:17408
    buffer_load_dwordx4 v130, s[4:7], s32 offen offset:2048 lds
    v_mfma_f32_16x16x32_bf16 v[52:55], a[12:15], a[36:39], v[52:55]
    ds_read_b64_tr_b16 a[80:81], v157 offset:16384
    v_mfma_f32_16x16x32_bf16 v[56:59], a[12:15], a[40:43], v[56:59]
    ds_read_b64_tr_b16 a[82:83], v157 offset:17408
    v_mfma_f32_16x16x32_bf16 v[60:63], a[12:15], a[44:47], v[60:63]
    ds_read_b64_tr_b16 a[84:85], v158 offset:16384
    v_mfma_f32_16x16x32_bf16 v[64:67], a[16:19], a[32:35], v[64:67]
    ds_read_b64_tr_b16 a[86:87], v158 offset:17408
    buffer_load_dwordx4 v131, s[4:7], s32 offen offset:3072 lds
    v_mfma_f32_16x16x32_bf16 v[68:71], a[16:19], a[36:39], v[68:71]
    ds_read_b64_tr_b16 a[88:89], v159 offset:16384
    v_mfma_f32_16x16x32_bf16 v[72:75], a[16:19], a[40:43], v[72:75]
    ds_read_b64_tr_b16 a[90:91], v159 offset:17408
    v_mfma_f32_16x16x32_bf16 v[76:79], a[16:19], a[44:47], v[76:79]
    ds_read_b64_tr_b16 a[92:93], v160 offset:16384
    v_mfma_f32_16x16x32_bf16 v[80:83], a[20:23], a[32:35], v[80:83]
    ds_read_b64_tr_b16 a[94:95], v160 offset:17408
    s_add_u32 m0, s36, 36864
    s_nop 0
    buffer_load_dwordx4 v132, s[4:7], s32 offen offset:0 lds
    v_mfma_f32_16x16x32_bf16 v[84:87], a[20:23], a[36:39], v[84:87]
    v_mfma_f32_16x16x32_bf16 v[88:91], a[20:23], a[40:43], v[88:91]
    v_mfma_f32_16x16x32_bf16 v[92:95], a[20:23], a[44:47], v[92:95]
    v_mfma_f32_16x16x32_bf16 v[96:99], a[24:27], a[32:35], v[96:99]
    buffer_load_dwordx4 v133, s[4:7], s32 offen offset:1024 lds
    v_mfma_f32_16x16x32_bf16 v[100:103], a[24:27], a[36:39], v[100:103]
    v_mfma_f32_16x16x32_bf16 v[104:107], a[24:27], a[40:43], v[104:107]
    v_mfma_f32_16x16x32_bf16 v[108:111], a[24:27], a[44:47], v[108:111]
    v_mfma_f32_16x16x32_bf16 v[112:115], a[28:31], a[32:35], v[112:115]
    buffer_load_dwordx4 v134, s[4:7], s32 offen offset:2048 lds
    v_mfma_f32_16x16x32_bf16 v[116:119], a[28:31], a[36:39], v[116:119]
    v_mfma_f32_16x16x32_bf16 v[120:123], a[28:31], a[40:43], v[120:123]
    v_mfma_f32_16x16x32_bf16 v[124:127], a[28:31], a[44:47], v[124:127]
    s_waitcnt lgkmcnt(0)
    s_waitcnt vmcnt(23)
    v_mfma_f32_16x16x32_bf16 v[0:3], a[64:67], a[96:99], v[0:3]
    ds_read_b128 a[32:35], v143 offset:0
    buffer_load_dwordx4 v135, s[4:7], s32 offen offset:3072 lds
    s_add_u32 s32, s32, 128
    v_mfma_f32_16x16x32_bf16 v[4:7], a[64:67], a[100:103], v[4:7]
    ds_read_b128 a[36:39], v143 offset:2048
    v_mfma_f32_16x16x32_bf16 v[8:11], a[64:67], a[104:107], v[8:11]
    ds_read_b128 a[40:43], v143 offset:4096
    v_mfma_f32_16x16x32_bf16 v[12:15], a[64:67], a[108:111], v[12:15]
    ds_read_b128 a[44:47], v143 offset:6144
    v_mfma_f32_16x16x32_bf16 v[16:19], a[68:71], a[96:99], v[16:19]
    ds_read_b64_tr_b16 a[0:1], v153 offset:24576
    buffer_load_dwordx4 a[240:243], v136, s[8:11], s33 offen
    v_mfma_f32_16x16x32_bf16 v[20:23], a[68:71], a[100:103], v[20:23]
    ds_read_b64_tr_b16 a[2:3], v153 offset:25600
    v_mfma_f32_16x16x32_bf16 v[24:27], a[68:71], a[104:107], v[24:27]
    ds_read_b64_tr_b16 a[4:5], v154 offset:24576
    v_mfma_f32_16x16x32_bf16 v[28:31], a[68:71], a[108:111], v[28:31]
    ds_read_b64_tr_b16 a[6:7], v154 offset:25600
    v_mfma_f32_16x16x32_bf16 v[32:35], a[72:75], a[96:99], v[32:35]
    ds_read_b64_tr_b16 a[8:9], v155 offset:24576
    buffer_load_dwordx4 a[244:247], v137, s[8:11], s33 offen
    v_mfma_f32_16x16x32_bf16 v[36:39], a[72:75], a[100:103], v[36:39]
    ds_read_b64_tr_b16 a[10:11], v155 offset:25600
    v_mfma_f32_16x16x32_bf16 v[40:43], a[72:75], a[104:107], v[40:43]
    ds_read_b64_tr_b16 a[12:13], v156 offset:24576
    v_mfma_f32_16x16x32_bf16 v[44:47], a[72:75], a[108:111], v[44:47]
    ds_read_b64_tr_b16 a[14:15], v156 offset:25600
    v_mfma_f32_16x16x32_bf16 v[48:51], a[76:79], a[96:99], v[48:51]
    ds_read_b64_tr_b16 a[16:17], v157 offset:24576
    buffer_load_dwordx4 a[248:251], v138, s[8:11], s33 offen
    v_mfma_f32_16x16x32_bf16 v[52:55], a[76:79], a[100:103], v[52:55]
    ds_read_b64_tr_b16 a[18:19], v157 offset:25600
    v_mfma_f32_16x16x32_bf16 v[56:59], a[76:79], a[104:107], v[56:59]
    ds_read_b64_tr_b16 a[20:21], v158 offset:24576
    v_mfma_f32_16x16x32_bf16 v[60:63], a[76:79], a[108:111], v[60:63]
    ds_read_b64_tr_b16 a[22:23], v158 offset:25600
    v_mfma_f32_16x16x32_bf16 v[64:67], a[80:83], a[96:99], v[64:67]
    ds_read_b64_tr_b16 a[24:25], v159 offset:24576
    buffer_load_dwordx4 a[252:255], v139, s[8:11], s33 offen
    s_add_u32 s33, s33, 0x80000
    v_mfma_f32_16x16x32_bf16 v[68:71], a[80:83], a[100:103], v[68:71]
    ds_read_b64_tr_b16 a[26:27], v159 offset:25600
    v_mfma_f32_16x16x32_bf16 v[72:75], a[80:83], a[104:107], v[72:75]
    ds_read_b64_tr_b16 a[28:29], v160 offset:24576
    v_mfma_f32_16x16x32_bf16 v[76:79], a[80:83], a[108:111], v[76:79]
    ds_read_b64_tr_b16 a[30:31], v160 offset:25600
    v_mfma_f32_16x16x32_bf16 v[80:83], a[84:87], a[96:99], v[80:83]
    v_mfma_f32_16x16x32_bf16 v[84:87], a[84:87], a[100:103], v[84:87]
    ds_write_b128 v152, a[208:211] offset:0
    v_mfma_f32_16x16x32_bf16 v[88:91], a[84:87], a[104:107], v[88:91]
    v_mfma_f32_16x16x32_bf16 v[92:95], a[84:87], a[108:111], v[92:95]
    ds_write_b128 v152, a[212:215] offset:1024
    v_mfma_f32_16x16x32_bf16 v[96:99], a[88:91], a[96:99], v[96:99]
    v_mfma_f32_16x16x32_bf16 v[100:103], a[88:91], a[100:103], v[100:103]
    ds_write_b128 v152, a[216:219] offset:2048
    v_mfma_f32_16x16x32_bf16 v[104:107], a[88:91], a[104:107], v[104:107]
    v_mfma_f32_16x16x32_bf16 v[108:111], a[88:91], a[108:111], v[108:111]
    ds_write_b128 v152, a[220:223] offset:3072
    v_mfma_f32_16x16x32_bf16 v[112:115], a[92:95], a[96:99], v[112:115]
    v_mfma_f32_16x16x32_bf16 v[116:119], a[92:95], a[100:103], v[116:119]
    v_mfma_f32_16x16x32_bf16 v[120:123], a[92:95], a[104:107], v[120:123]
    v_mfma_f32_16x16x32_bf16 v[124:127], a[92:95], a[108:111], v[124:127]
    s_waitcnt lgkmcnt(4)
    v_mfma_f32_16x16x32_bf16 v[0:3], a[0:3], a[32:35], v[0:3]
    v_mfma_f32_16x16x32_bf16 v[4:7], a[0:3], a[36:39], v[4:7]
    s_waitcnt vmcnt(16) lgkmcnt(0)
    s_barrier
    ds_read_b128 a[96:99], v140 offset:0
    v_mfma_f32_16x16x32_bf16 v[8:11], a[0:3], a[40:43], v[8:11]
    ds_read_b128 a[100:103], v140 offset:2048
    v_mfma_f32_16x16x32_bf16 v[12:15], a[0:3], a[44:47], v[12:15]
    ds_read_b128 a[104:107], v140 offset:4096
    v_mfma_f32_16x16x32_bf16 v[16:19], a[4:7], a[32:35], v[16:19]
    ds_read_b128 a[108:111], v140 offset:6144
    s_add_u32 m0, s36, 65536
    s_nop 0
    buffer_load_dwordx4 v128, s[4:7], s32 offen offset:0 lds
    v_mfma_f32_16x16x32_bf16 v[20:23], a[4:7], a[36:39], v[20:23]
    ds_read_b64_tr_b16 a[64:65], v153 offset:0
    v_mfma_f32_16x16x32_bf16 v[24:27], a[4:7], a[40:43], v[24:27]
    ds_read_b64_tr_b16 a[66:67], v153 offset:1024
    v_mfma_f32_16x16x32_bf16 v[28:31], a[4:7], a[44:47], v[28:31]
    ds_read_b64_tr_b16 a[68:69], v154 offset:0
    v_mfma_f32_16x16x32_bf16 v[32:35], a[8:11], a[32:35], v[32:35]
    ds_read_b64_tr_b16 a[70:71], v154 offset:1024
    buffer_load_dwordx4 v129, s[4:7], s32 offen offset:1024 lds
    v_mfma_f32_16x16x32_bf16 v[36:39], a[8:11], a[36:39], v[36:39]
    ds_read_b64_tr_b16 a[72:73], v155 offset:0
    v_mfma_f32_16x16x32_bf16 v[40:43], a[8:11], a[40:43], v[40:43]
    ds_read_b64_tr_b16 a[74:75], v155 offset:1024
    v_mfma_f32_16x16x32_bf16 v[44:47], a[8:11], a[44:47], v[44:47]
    ds_read_b64_tr_b16 a[76:77], v156 offset:0
    v_mfma_f32_16x16x32_bf16 v[48:51], a[12:15], a[32:35], v[48:51]
    ds_read_b64_tr_b16 a[78:79], v156 offset:1024
    buffer_load_dwordx4 v130, s[4:7], s32 offen offset:2048 lds
    v_mfma_f32_16x16x32_bf16 v[52:55], a[12:15], a[36:39], v[52:55]
    ds_read_b64_tr_b16 a[80:81], v157 offset:0
    v_mfma_f32_16x16x32_bf16 v[56:59], a[12:15], a[40:43], v[56:59]
    ds_read_b64_tr_b16 a[82:83], v157 offset:1024
    v_mfma_f32_16x16x32_bf16 v[60:63], a[12:15], a[44:47], v[60:63]
    ds_read_b64_tr_b16 a[84:85], v158 offset:0
    v_mfma_f32_16x16x32_bf16 v[64:67], a[16:19], a[32:35], v[64:67]
    ds_read_b64_tr_b16 a[86:87], v158 offset:1024
    buffer_load_dwordx4 v131, s[4:7], s32 offen offset:3072 lds
    v_mfma_f32_16x16x32_bf16 v[68:71], a[16:19], a[36:39], v[68:71]
    ds_read_b64_tr_b16 a[88:89], v159 offset:0
    v_mfma_f32_16x16x32_bf16 v[72:75], a[16:19], a[40:43], v[72:75]
    ds_read_b64_tr_b16 a[90:91], v159 offset:1024
    v_mfma_f32_16x16x32_bf16 v[76:79], a[16:19], a[44:47], v[76:79]
    ds_read_b64_tr_b16 a[92:93], v160 offset:0
    v_mfma_f32_16x16x32_bf16 v[80:83], a[20:23], a[32:35], v[80:83]
    ds_read_b64_tr_b16 a[94:95], v160 offset:1024
    s_add_u32 m0, s36, 69632
    s_nop 0
    buffer_load_dwordx4 v132, s[4:7], s32 offen offset:0 lds
    v_mfma_f32_16x16x32_bf16 v[84:87], a[20:23], a[36:39], v[84:87]
    v_mfma_f32_16x16x32_bf16 v[88:91], a[20:23], a[40:43], v[88:91]
    v_mfma_f32_16x16x32_bf16 v[92:95], a[20:23], a[44:47], v[92:95]
    v_mfma_f32_16x16x32_bf16 v[96:99], a[24:27], a[32:35], v[96:99]
    buffer_load_dwordx4 v133, s[4:7], s32 offen offset:1024 lds
    v_mfma_f32_16x16x32_bf16 v[100:103], a[24:27], a[36:39], v[100:103]
    v_mfma_f32_16x16x32_bf16 v[104:107], a[24:27], a[40:43], v[104:107]
    v_mfma_f32_16x16x32_bf16 v[108:111], a[24:27], a[44:47], v[108:111]
    v_mfma_f32_16x16x32_bf16 v[112:115], a[28:31], a[32:35], v[112:115]
    buffer_load_dwordx4 v134, s[4:7], s32 offen offset:2048 lds
    v_mfma_f32_16x16x32_bf16 v[116:119], a[28:31], a[36:39], v[116:119]
    v_mfma_f32_16x16x32_bf16 v[120:123], a[28:31], a[40:43], v[120:123]
    v_mfma_f32_16x16x32_bf16 v[124:127], a[28:31], a[44:47], v[124:127]
    s_waitcnt lgkmcnt(0)
    s_waitcnt vmcnt(19)
    v_mfma_f32_16x16x32_bf16 v[0:3], a[64:67], a[96:99], v[0:3]
    ds_read_b128 a[32:35], v141 offset:0
    buffer_load_dwordx4 v135, s[4:7], s32 offen offset:3072 lds
    s_add_u32 s32, s32, 128
    v_mfma_f32_16x16x32_bf16 v[4:7], a[64:67], a[100:103], v[4:7]
    ds_read_b128 a[36:39], v141 offset:2048
    v_mfma_f32_16x16x32_bf16 v[8:11], a[64:67], a[104:107], v[8:11]
    ds_read_b128 a[40:43], v141 offset:4096
    v_mfma_f32_16x16x32_bf16 v[12:15], a[64:67], a[108:111], v[12:15]
    ds_read_b128 a[44:47], v141 offset:6144
    v_mfma_f32_16x16x32_bf16 v[16:19], a[68:71], a[96:99], v[16:19]
    ds_read_b64_tr_b16 a[0:1], v153 offset:8192
    v_mfma_f32_16x16x32_bf16 v[20:23], a[68:71], a[100:103], v[20:23]
    ds_read_b64_tr_b16 a[2:3], v153 offset:9216
    v_mfma_f32_16x16x32_bf16 v[24:27], a[68:71], a[104:107], v[24:27]
    ds_read_b64_tr_b16 a[4:5], v154 offset:8192
    v_mfma_f32_16x16x32_bf16 v[28:31], a[68:71], a[108:111], v[28:31]
    ds_read_b64_tr_b16 a[6:7], v154 offset:9216
    v_mfma_f32_16x16x32_bf16 v[32:35], a[72:75], a[96:99], v[32:35]
    ds_read_b64_tr_b16 a[8:9], v155 offset:8192
    v_mfma_f32_16x16x32_bf16 v[36:39], a[72:75], a[100:103], v[36:39]
    ds_read_b64_tr_b16 a[10:11], v155 offset:9216
    v_mfma_f32_16x16x32_bf16 v[40:43], a[72:75], a[104:107], v[40:43]
    ds_read_b64_tr_b16 a[12:13], v156 offset:8192
    v_mfma_f32_16x16x32_bf16 v[44:47], a[72:75], a[108:111], v[44:47]
    ds_read_b64_tr_b16 a[14:15], v156 offset:9216
    v_mfma_f32_16x16x32_bf16 v[48:51], a[76:79], a[96:99], v[48:51]
    ds_read_b64_tr_b16 a[16:17], v157 offset:8192
    v_mfma_f32_16x16x32_bf16 v[52:55], a[76:79], a[100:103], v[52:55]
    ds_read_b64_tr_b16 a[18:19], v157 offset:9216
    v_mfma_f32_16x16x32_bf16 v[56:59], a[76:79], a[104:107], v[56:59]
    ds_read_b64_tr_b16 a[20:21], v158 offset:8192
    v_mfma_f32_16x16x32_bf16 v[60:63], a[76:79], a[108:111], v[60:63]
    ds_read_b64_tr_b16 a[22:23], v158 offset:9216
    v_mfma_f32_16x16x32_bf16 v[64:67], a[80:83], a[96:99], v[64:67]
    ds_read_b64_tr_b16 a[24:25], v159 offset:8192
    v_mfma_f32_16x16x32_bf16 v[68:71], a[80:83], a[100:103], v[68:71]
    ds_read_b64_tr_b16 a[26:27], v159 offset:9216
    v_mfma_f32_16x16x32_bf16 v[72:75], a[80:83], a[104:107], v[72:75]
    ds_read_b64_tr_b16 a[28:29], v160 offset:8192
    v_mfma_f32_16x16x32_bf16 v[76:79], a[80:83], a[108:111], v[76:79]
    ds_read_b64_tr_b16 a[30:31], v160 offset:9216
    v_mfma_f32_16x16x32_bf16 v[80:83], a[84:87], a[96:99], v[80:83]
    v_mfma_f32_16x16x32_bf16 v[84:87], a[84:87], a[100:103], v[84:87]
    ds_write_b128 v152, a[224:227] offset:16384
    v_mfma_f32_16x16x32_bf16 v[88:91], a[84:87], a[104:107], v[88:91]
    v_mfma_f32_16x16x32_bf16 v[92:95], a[84:87], a[108:111], v[92:95]
    ds_write_b128 v152, a[228:231] offset:17408
    v_mfma_f32_16x16x32_bf16 v[96:99], a[88:91], a[96:99], v[96:99]
    v_mfma_f32_16x16x32_bf16 v[100:103], a[88:91], a[100:103], v[100:103]
    ds_write_b128 v152, a[232:235] offset:18432
    v_mfma_f32_16x16x32_bf16 v[104:107], a[88:91], a[104:107], v[104:107]
    v_mfma_f32_16x16x32_bf16 v[108:111], a[88:91], a[108:111], v[108:111]
    ds_write_b128 v152, a[236:239] offset:19456
    v_mfma_f32_16x16x32_bf16 v[112:115], a[92:95], a[96:99], v[112:115]
    v_mfma_f32_16x16x32_bf16 v[116:119], a[92:95], a[100:103], v[116:119]
    v_mfma_f32_16x16x32_bf16 v[120:123], a[92:95], a[104:107], v[120:123]
    v_mfma_f32_16x16x32_bf16 v[124:127], a[92:95], a[108:111], v[124:127]
    s_waitcnt lgkmcnt(4)
    v_mfma_f32_16x16x32_bf16 v[0:3], a[0:3], a[32:35], v[0:3]
    v_mfma_f32_16x16x32_bf16 v[4:7], a[0:3], a[36:39], v[4:7]
    s_waitcnt vmcnt(12) lgkmcnt(0)
    s_barrier
    ds_read_b128 a[96:99], v140 offset:32768
    v_mfma_f32_16x16x32_bf16 v[8:11], a[0:3], a[40:43], v[8:11]
    ds_read_b128 a[100:103], v140 offset:34816
    v_mfma_f32_16x16x32_bf16 v[12:15], a[0:3], a[44:47], v[12:15]
    ds_read_b128 a[104:107], v140 offset:36864
    v_mfma_f32_16x16x32_bf16 v[16:19], a[4:7], a[32:35], v[16:19]
    ds_read_b128 a[108:111], v140 offset:38912
    s_add_u32 m0, s35, 0
    s_nop 0
    buffer_load_dwordx4 v196, s[12:15], s27 offen nt lds
    v_mfma_f32_16x16x32_bf16 v[20:23], a[4:7], a[36:39], v[20:23]
    ds_read_b64_tr_b16 a[64:65], v153 offset:16384
    v_mfma_f32_16x16x32_bf16 v[24:27], a[4:7], a[40:43], v[24:27]
    ds_read_b64_tr_b16 a[66:67], v153 offset:17408
    v_mfma_f32_16x16x32_bf16 v[28:31], a[4:7], a[44:47], v[28:31]
    ds_read_b64_tr_b16 a[68:69], v154 offset:16384
    v_mfma_f32_16x16x32_bf16 v[32:35], a[8:11], a[32:35], v[32:35]
    ds_read_b64_tr_b16 a[70:71], v154 offset:17408
    buffer_load_dwordx4 v197, s[12:15], s27 offen offset:1024 nt lds
    v_mfma_f32_16x16x32_bf16 v[36:39], a[8:11], a[36:39], v[36:39]
    ds_read_b64_tr_b16 a[72:73], v155 offset:16384
    v_mfma_f32_16x16x32_bf16 v[40:43], a[8:11], a[40:43], v[40:43]
    ds_read_b64_tr_b16 a[74:75], v155 offset:17408
    v_mfma_f32_16x16x32_bf16 v[44:47], a[8:11], a[44:47], v[44:47]
    ds_read_b64_tr_b16 a[76:77], v156 offset:16384
    v_mfma_f32_16x16x32_bf16 v[48:51], a[12:15], a[32:35], v[48:51]
    ds_read_b64_tr_b16 a[78:79], v156 offset:17408
    buffer_load_dwordx4 v198, s[16:19], s27 offen offset:2048 nt lds
    v_mfma_f32_16x16x32_bf16 v[52:55], a[12:15], a[36:39], v[52:55]
    ds_read_b64_tr_b16 a[80:81], v157 offset:16384
    v_mfma_f32_16x16x32_bf16 v[56:59], a[12:15], a[40:43], v[56:59]
    ds_read_b64_tr_b16 a[82:83], v157 offset:17408
    v_mfma_f32_16x16x32_bf16 v[60:63], a[12:15], a[44:47], v[60:63]
    ds_read_b64_tr_b16 a[84:85], v158 offset:16384
    v_mfma_f32_16x16x32_bf16 v[64:67], a[16:19], a[32:35], v[64:67]
    ds_read_b64_tr_b16 a[86:87], v158 offset:17408
    buffer_load_dwordx4 v199, s[16:19], s27 offen offset:3072 nt lds
    s_add_u32 s27, s27, 8192
    v_mfma_f32_16x16x32_bf16 v[68:71], a[16:19], a[36:39], v[68:71]
    ds_read_b64_tr_b16 a[88:89], v159 offset:16384
    v_mfma_f32_16x16x32_bf16 v[72:75], a[16:19], a[40:43], v[72:75]
    ds_read_b64_tr_b16 a[90:91], v159 offset:17408
    v_mfma_f32_16x16x32_bf16 v[76:79], a[16:19], a[44:47], v[76:79]
    ds_read_b64_tr_b16 a[92:93], v160 offset:16384
    v_mfma_f32_16x16x32_bf16 v[80:83], a[20:23], a[32:35], v[80:83]
    ds_read_b64_tr_b16 a[94:95], v160 offset:17408
    s_add_u32 m0, s35, 16384
    s_nop 0
    buffer_load_dwordx4 v196, s[12:15], s27 offen nt lds
    v_mfma_f32_16x16x32_bf16 v[84:87], a[20:23], a[36:39], v[84:87]
    v_mfma_f32_16x16x32_bf16 v[88:91], a[20:23], a[40:43], v[88:91]
    v_mfma_f32_16x16x32_bf16 v[92:95], a[20:23], a[44:47], v[92:95]
    v_mfma_f32_16x16x32_bf16 v[96:99], a[24:27], a[32:35], v[96:99]
    buffer_load_dwordx4 v197, s[12:15], s27 offen offset:1024 nt lds
    v_mfma_f32_16x16x32_bf16 v[100:103], a[24:27], a[36:39], v[100:103]
    v_mfma_f32_16x16x32_bf16 v[104:107], a[24:27], a[40:43], v[104:107]
    v_mfma_f32_16x16x32_bf16 v[108:111], a[24:27], a[44:47], v[108:111]
    v_mfma_f32_16x16x32_bf16 v[112:115], a[28:31], a[32:35], v[112:115]
    buffer_load_dwordx4 v198, s[16:19], s27 offen offset:2048 nt lds
    v_mfma_f32_16x16x32_bf16 v[116:119], a[28:31], a[36:39], v[116:119]
    v_mfma_f32_16x16x32_bf16 v[120:123], a[28:31], a[40:43], v[120:123]
    v_mfma_f32_16x16x32_bf16 v[124:127], a[28:31], a[44:47], v[124:127]
    s_waitcnt lgkmcnt(0)
    s_waitcnt vmcnt(15)
    v_mfma_f32_16x16x32_bf16 v[0:3], a[64:67], a[96:99], v[0:3]
    ds_read_b128 a[32:35], v141 offset:32768
    buffer_load_dwordx4 v199, s[16:19], s27 offen offset:3072 nt lds
    s_add_u32 s27, s27, 8192
    v_mfma_f32_16x16x32_bf16 v[4:7], a[64:67], a[100:103], v[4:7]
    ds_read_b128 a[36:39], v141 offset:34816
    v_mfma_f32_16x16x32_bf16 v[8:11], a[64:67], a[104:107], v[8:11]
    ds_read_b128 a[40:43], v141 offset:36864
    v_mfma_f32_16x16x32_bf16 v[12:15], a[64:67], a[108:111], v[12:15]
    ds_read_b128 a[44:47], v141 offset:38912
    v_mfma_f32_16x16x32_bf16 v[16:19], a[68:71], a[96:99], v[16:19]
    ds_read_b64_tr_b16 a[0:1], v153 offset:24576
    v_mfma_f32_16x16x32_bf16 v[20:23], a[68:71], a[100:103], v[20:23]
    ds_read_b64_tr_b16 a[2:3], v153 offset:25600
    v_mfma_f32_16x16x32_bf16 v[24:27], a[68:71], a[104:107], v[24:27]
    ds_read_b64_tr_b16 a[4:5], v154 offset:24576
    v_mfma_f32_16x16x32_bf16 v[28:31], a[68:71], a[108:111], v[28:31]
    ds_read_b64_tr_b16 a[6:7], v154 offset:25600
    v_mfma_f32_16x16x32_bf16 v[32:35], a[72:75], a[96:99], v[32:35]
    ds_read_b64_tr_b16 a[8:9], v155 offset:24576
    v_mfma_f32_16x16x32_bf16 v[36:39], a[72:75], a[100:103], v[36:39]
    ds_read_b64_tr_b16 a[10:11], v155 offset:25600
    v_mfma_f32_16x16x32_bf16 v[40:43], a[72:75], a[104:107], v[40:43]
    ds_read_b64_tr_b16 a[12:13], v156 offset:24576
    v_mfma_f32_16x16x32_bf16 v[44:47], a[72:75], a[108:111], v[44:47]
    ds_read_b64_tr_b16 a[14:15], v156 offset:25600
    v_mfma_f32_16x16x32_bf16 v[48:51], a[76:79], a[96:99], v[48:51]
    ds_read_b64_tr_b16 a[16:17], v157 offset:24576
    v_mfma_f32_16x16x32_bf16 v[52:55], a[76:79], a[100:103], v[52:55]
    ds_read_b64_tr_b16 a[18:19], v157 offset:25600
    v_mfma_f32_16x16x32_bf16 v[56:59], a[76:79], a[104:107], v[56:59]
    ds_read_b64_tr_b16 a[20:21], v158 offset:24576
    v_mfma_f32_16x16x32_bf16 v[60:63], a[76:79], a[108:111], v[60:63]
    ds_read_b64_tr_b16 a[22:23], v158 offset:25600
    v_mfma_f32_16x16x32_bf16 v[64:67], a[80:83], a[96:99], v[64:67]
    ds_read_b64_tr_b16 a[24:25], v159 offset:24576
    v_mfma_f32_16x16x32_bf16 v[68:71], a[80:83], a[100:103], v[68:71]
    ds_read_b64_tr_b16 a[26:27], v159 offset:25600
    v_mfma_f32_16x16x32_bf16 v[72:75], a[80:83], a[104:107], v[72:75]
    ds_read_b64_tr_b16 a[28:29], v160 offset:24576
    v_mfma_f32_16x16x32_bf16 v[76:79], a[80:83], a[108:111], v[76:79]
    ds_read_b64_tr_b16 a[30:31], v160 offset:25600
    v_mfma_f32_16x16x32_bf16 v[80:83], a[84:87], a[96:99], v[80:83]
    v_mfma_f32_16x16x32_bf16 v[84:87], a[84:87], a[100:103], v[84:87]
    ds_write_b128 v152, a[240:243] offset:0
    v_mfma_f32_16x16x32_bf16 v[88:91], a[84:87], a[104:107], v[88:91]
    v_mfma_f32_16x16x32_bf16 v[92:95], a[84:87], a[108:111], v[92:95]
    ds_write_b128 v152, a[244:247] offset:1024
    v_mfma_f32_16x16x32_bf16 v[96:99], a[88:91], a[96:99], v[96:99]
    v_mfma_f32_16x16x32_bf16 v[100:103], a[88:91], a[100:103], v[100:103]
    ds_write_b128 v152, a[248:251] offset:2048
    v_mfma_f32_16x16x32_bf16 v[104:107], a[88:91], a[104:107], v[104:107]
    v_mfma_f32_16x16x32_bf16 v[108:111], a[88:91], a[108:111], v[108:111]
    ds_write_b128 v152, a[252:255] offset:3072
    v_mfma_f32_16x16x32_bf16 v[112:115], a[92:95], a[96:99], v[112:115]
    v_mfma_f32_16x16x32_bf16 v[116:119], a[92:95], a[100:103], v[116:119]
    v_mfma_f32_16x16x32_bf16 v[120:123], a[92:95], a[104:107], v[120:123]
    v_mfma_f32_16x16x32_bf16 v[124:127], a[92:95], a[108:111], v[124:127]
    s_waitcnt lgkmcnt(4)
    v_mfma_f32_16x16x32_bf16 v[0:3], a[0:3], a[32:35], v[0:3]
    v_mfma_f32_16x16x32_bf16 v[4:7], a[0:3], a[36:39], v[4:7]
    s_waitcnt vmcnt(8) lgkmcnt(0)
    s_barrier
    ds_read_b128 a[96:99], v142 offset:0
    v_mfma_f32_16x16x32_bf16 v[8:11], a[0:3], a[40:43], v[8:11]
    ds_read_b128 a[100:103], v142 offset:2048
    v_mfma_f32_16x16x32_bf16 v[12:15], a[0:3], a[44:47], v[12:15]
    ds_read_b128 a[104:107], v142 offset:4096
    v_mfma_f32_16x16x32_bf16 v[16:19], a[4:7], a[32:35], v[16:19]
    ds_read_b128 a[108:111], v142 offset:6144
    s_add_u32 m0, s35, 32768
    s_nop 0
    buffer_load_dwordx4 v196, s[12:15], s27 offen nt lds
    v_mfma_f32_16x16x32_bf16 v[20:23], a[4:7], a[36:39], v[20:23]
    ds_read_b64_tr_b16 a[64:65], v153 offset:0
    v_mfma_f32_16x16x32_bf16 v[24:27], a[4:7], a[40:43], v[24:27]
    ds_read_b64_tr_b16 a[66:67], v153 offset:1024
    v_mfma_f32_16x16x32_bf16 v[28:31], a[4:7], a[44:47], v[28:31]
    ds_read_b64_tr_b16 a[68:69], v154 offset:0
    v_mfma_f32_16x16x32_bf16 v[32:35], a[8:11], a[32:35], v[32:35]
    ds_read_b64_tr_b16 a[70:71], v154 offset:1024
    buffer_load_dwordx4 v197, s[12:15], s27 offen offset:1024 nt lds
    v_mfma_f32_16x16x32_bf16 v[36:39], a[8:11], a[36:39], v[36:39]
    ds_read_b64_tr_b16 a[72:73], v155 offset:0
    v_mfma_f32_16x16x32_bf16 v[40:43], a[8:11], a[40:43], v[40:43]
    ds_read_b64_tr_b16 a[74:75], v155 offset:1024
    v_mfma_f32_16x16x32_bf16 v[44:47], a[8:11], a[44:47], v[44:47]
    ds_read_b64_tr_b16 a[76:77], v156 offset:0
    v_mfma_f32_16x16x32_bf16 v[48:51], a[12:15], a[32:35], v[48:51]
    ds_read_b64_tr_b16 a[78:79], v156 offset:1024
    buffer_load_dwordx4 v198, s[16:19], s27 offen offset:2048 nt lds
    v_mfma_f32_16x16x32_bf16 v[52:55], a[12:15], a[36:39], v[52:55]
    ds_read_b64_tr_b16 a[80:81], v157 offset:0
    v_mfma_f32_16x16x32_bf16 v[56:59], a[12:15], a[40:43], v[56:59]
    ds_read_b64_tr_b16 a[82:83], v157 offset:1024
    v_mfma_f32_16x16x32_bf16 v[60:63], a[12:15], a[44:47], v[60:63]
    ds_read_b64_tr_b16 a[84:85], v158 offset:0
    v_mfma_f32_16x16x32_bf16 v[64:67], a[16:19], a[32:35], v[64:67]
    ds_read_b64_tr_b16 a[86:87], v158 offset:1024
    buffer_load_dwordx4 v199, s[16:19], s27 offen offset:3072 nt lds
    s_add_u32 s27, s27, 8192
    v_mfma_f32_16x16x32_bf16 v[68:71], a[16:19], a[36:39], v[68:71]
    ds_read_b64_tr_b16 a[88:89], v159 offset:0
    v_mfma_f32_16x16x32_bf16 v[72:75], a[16:19], a[40:43], v[72:75]
    ds_read_b64_tr_b16 a[90:91], v159 offset:1024
    v_mfma_f32_16x16x32_bf16 v[76:79], a[16:19], a[44:47], v[76:79]
    ds_read_b64_tr_b16 a[92:93], v160 offset:0
    v_mfma_f32_16x16x32_bf16 v[80:83], a[20:23], a[32:35], v[80:83]
    ds_read_b64_tr_b16 a[94:95], v160 offset:1024
    s_add_u32 m0, s35, 49152
    s_nop 0
    buffer_load_dwordx4 v196, s[12:15], s27 offen nt lds
    v_mfma_f32_16x16x32_bf16 v[84:87], a[20:23], a[36:39], v[84:87]
    v_mfma_f32_16x16x32_bf16 v[88:91], a[20:23], a[40:43], v[88:91]
    v_mfma_f32_16x16x32_bf16 v[92:95], a[20:23], a[44:47], v[92:95]
    v_mfma_f32_16x16x32_bf16 v[96:99], a[24:27], a[32:35], v[96:99]
    buffer_load_dwordx4 v197, s[12:15], s27 offen offset:1024 nt lds
    v_mfma_f32_16x16x32_bf16 v[100:103], a[24:27], a[36:39], v[100:103]
    v_mfma_f32_16x16x32_bf16 v[104:107], a[24:27], a[40:43], v[104:107]
    v_mfma_f32_16x16x32_bf16 v[108:111], a[24:27], a[44:47], v[108:111]
    v_mfma_f32_16x16x32_bf16 v[112:115], a[28:31], a[32:35], v[112:115]
    buffer_load_dwordx4 v198, s[16:19], s27 offen offset:2048 nt lds
    v_mfma_f32_16x16x32_bf16 v[116:119], a[28:31], a[36:39], v[116:119]
    v_mfma_f32_16x16x32_bf16 v[120:123], a[28:31], a[40:43], v[120:123]
    v_mfma_f32_16x16x32_bf16 v[124:127], a[28:31], a[44:47], v[124:127]
    s_waitcnt lgkmcnt(0)
    v_mfma_f32_16x16x32_bf16 v[0:3], a[64:67], a[96:99], v[0:3]
    ds_read_b128 a[32:35], v143 offset:0
    buffer_load_dwordx4 v199, s[16:19], s27 offen offset:3072 nt lds
    s_add_u32 s27, s27, 8192
    v_mfma_f32_16x16x32_bf16 v[4:7], a[64:67], a[100:103], v[4:7]
    ds_read_b128 a[36:39], v143 offset:2048
    v_mfma_f32_16x16x32_bf16 v[8:11], a[64:67], a[104:107], v[8:11]
    ds_read_b128 a[40:43], v143 offset:4096
    v_mfma_f32_16x16x32_bf16 v[12:15], a[64:67], a[108:111], v[12:15]
    ds_read_b128 a[44:47], v143 offset:6144
    v_mfma_f32_16x16x32_bf16 v[16:19], a[68:71], a[96:99], v[16:19]
    ds_read_b64_tr_b16 a[0:1], v153 offset:8192
    v_mfma_f32_16x16x32_bf16 v[20:23], a[68:71], a[100:103], v[20:23]
    ds_read_b64_tr_b16 a[2:3], v153 offset:9216
    v_mfma_f32_16x16x32_bf16 v[24:27], a[68:71], a[104:107], v[24:27]
    ds_read_b64_tr_b16 a[4:5], v154 offset:8192
    v_mfma_f32_16x16x32_bf16 v[28:31], a[68:71], a[108:111], v[28:31]
    ds_read_b64_tr_b16 a[6:7], v154 offset:9216
    v_mfma_f32_16x16x32_bf16 v[32:35], a[72:75], a[96:99], v[32:35]
    ds_read_b64_tr_b16 a[8:9], v155 offset:8192
    v_mfma_f32_16x16x32_bf16 v[36:39], a[72:75], a[100:103], v[36:39]
    ds_read_b64_tr_b16 a[10:11], v155 offset:9216
    v_mfma_f32_16x16x32_bf16 v[40:43], a[72:75], a[104:107], v[40:43]
    ds_read_b64_tr_b16 a[12:13], v156 offset:8192
    v_mfma_f32_16x16x32_bf16 v[44:47], a[72:75], a[108:111], v[44:47]
    ds_read_b64_tr_b16 a[14:15], v156 offset:9216
    v_mfma_f32_16x16x32_bf16 v[48:51], a[76:79], a[96:99], v[48:51]
    ds_read_b64_tr_b16 a[16:17], v157 offset:8192
    v_mfma_f32_16x16x32_bf16 v[52:55], a[76:79], a[100:103], v[52:55]
    ds_read_b64_tr_b16 a[18:19], v157 offset:9216
    v_mfma_f32_16x16x32_bf16 v[56:59], a[76:79], a[104:107], v[56:59]
    ds_read_b64_tr_b16 a[20:21], v158 offset:8192
    v_mfma_f32_16x16x32_bf16 v[60:63], a[76:79], a[108:111], v[60:63]
    ds_read_b64_tr_b16 a[22:23], v158 offset:9216
    v_mfma_f32_16x16x32_bf16 v[64:67], a[80:83], a[96:99], v[64:67]
    ds_read_b64_tr_b16 a[24:25], v159 offset:8192
    v_mfma_f32_16x16x32_bf16 v[68:71], a[80:83], a[100:103], v[68:71]
    ds_read_b64_tr_b16 a[26:27], v159 offset:9216
    v_mfma_f32_16x16x32_bf16 v[72:75], a[80:83], a[104:107], v[72:75]
    ds_read_b64_tr_b16 a[28:29], v160 offset:8192
    v_mfma_f32_16x16x32_bf16 v[76:79], a[80:83], a[108:111], v[76:79]
    ds_read_b64_tr_b16 a[30:31], v160 offset:9216
    v_mfma_f32_16x16x32_bf16 v[80:83], a[84:87], a[96:99], v[80:83]
    v_mfma_f32_16x16x32_bf16 v[84:87], a[84:87], a[100:103], v[84:87]
    v_mfma_f32_16x16x32_bf16 v[88:91], a[84:87], a[104:107], v[88:91]
    v_mfma_f32_16x16x32_bf16 v[92:95], a[84:87], a[108:111], v[92:95]
    v_mfma_f32_16x16x32_bf16 v[96:99], a[88:91], a[96:99], v[96:99]
    v_mfma_f32_16x16x32_bf16 v[100:103], a[88:91], a[100:103], v[100:103]
    v_mfma_f32_16x16x32_bf16 v[104:107], a[88:91], a[104:107], v[104:107]
    v_mfma_f32_16x16x32_bf16 v[108:111], a[88:91], a[108:111], v[108:111]
    v_mfma_f32_16x16x32_bf16 v[112:115], a[92:95], a[96:99], v[112:115]
    v_mfma_f32_16x16x32_bf16 v[116:119], a[92:95], a[100:103], v[116:119]
    v_mfma_f32_16x16x32_bf16 v[120:123], a[92:95], a[104:107], v[120:123]
    v_mfma_f32_16x16x32_bf16 v[124:127], a[92:95], a[108:111], v[124:127]
    s_waitcnt lgkmcnt(0)
    v_mfma_f32_16x16x32_bf16 v[0:3], a[0:3], a[32:35], v[0:3]
    v_mfma_f32_16x16x32_bf16 v[4:7], a[0:3], a[36:39], v[4:7]
    v_mfma_f32_16x16x32_bf16 v[8:11], a[0:3], a[40:43], v[8:11]
    v_mfma_f32_16x16x32_bf16 v[12:15], a[0:3], a[44:47], v[12:15]
    v_mfma_f32_16x16x32_bf16 v[16:19], a[4:7], a[32:35], v[16:19]
    v_mfma_f32_16x16x32_bf16 v[20:23], a[4:7], a[36:39], v[20:23]
    v_mfma_f32_16x16x32_bf16 v[24:27], a[4:7], a[40:43], v[24:27]
    v_mfma_f32_16x16x32_bf16 v[28:31], a[4:7], a[44:47], v[28:31]
    v_mfma_f32_16x16x32_bf16 v[32:35], a[8:11], a[32:35], v[32:35]
    v_mfma_f32_16x16x32_bf16 v[36:39], a[8:11], a[36:39], v[36:39]
    v_mfma_f32_16x16x32_bf16 v[40:43], a[8:11], a[40:43], v[40:43]
    v_mfma_f32_16x16x32_bf16 v[44:47], a[8:11], a[44:47], v[44:47]
    v_mfma_f32_16x16x32_bf16 v[48:51], a[12:15], a[32:35], v[48:51]
    v_mfma_f32_16x16x32_bf16 v[52:55], a[12:15], a[36:39], v[52:55]
    v_mfma_f32_16x16x32_bf16 v[56:59], a[12:15], a[40:43], v[56:59]
    v_mfma_f32_16x16x32_bf16 v[60:63], a[12:15], a[44:47], v[60:63]
    v_mfma_f32_16x16x32_bf16 v[64:67], a[16:19], a[32:35], v[64:67]
    v_mfma_f32_16x16x32_bf16 v[68:71], a[16:19], a[36:39], v[68:71]
    v_mfma_f32_16x16x32_bf16 v[72:75], a[16:19], a[40:43], v[72:75]
    v_mfma_f32_16x16x32_bf16 v[76:79], a[16:19], a[44:47], v[76:79]
    v_mfma_f32_16x16x32_bf16 v[80:83], a[20:23], a[32:35], v[80:83]
    v_mfma_f32_16x16x32_bf16 v[84:87], a[20:23], a[36:39], v[84:87]
    v_mfma_f32_16x16x32_bf16 v[88:91], a[20:23], a[40:43], v[88:91]
    v_mfma_f32_16x16x32_bf16 v[92:95], a[20:23], a[44:47], v[92:95]
    v_mfma_f32_16x16x32_bf16 v[96:99], a[24:27], a[32:35], v[96:99]
    v_mfma_f32_16x16x32_bf16 v[100:103], a[24:27], a[36:39], v[100:103]
    v_mfma_f32_16x16x32_bf16 v[104:107], a[24:27], a[40:43], v[104:107]
    v_mfma_f32_16x16x32_bf16 v[108:111], a[24:27], a[44:47], v[108:111]
    v_mfma_f32_16x16x32_bf16 v[112:115], a[28:31], a[32:35], v[112:115]
    v_mfma_f32_16x16x32_bf16 v[116:119], a[28:31], a[36:39], v[116:119]
    v_mfma_f32_16x16x32_bf16 v[120:123], a[28:31], a[40:43], v[120:123]
    v_mfma_f32_16x16x32_bf16 v[124:127], a[28:31], a[44:47], v[124:127]
    s_mov_b32 s4, s76
    s_mov_b32 s5, s77
    s_mov_b32 s6, 4718592
    s_mov_b32 s7, 0x20000
    s_lshl_b32 s38, s47, 21
    s_add_u32 s62, s66, s38
    s_addc_u32 s63, s67, 0
    s_mov_b32 s8, s62
    s_mov_b32 s9, s63
    s_mov_b32 s10, 0x200000
    s_mov_b32 s11, 0x20000
    s_mul_i32 s38, s47, 276480
    s_add_u32 s62, s78, s38
    s_addc_u32 s63, s79, 0
    s_mov_b32 s40, s62
    s_mov_b32 s41, s63
    s_mov_b32 s42, 276480
    s_mov_b32 s43, 0x20000
    s_barrier
    ds_read_b128 a[64:67], v176 offset:32768
    ds_read_b128 a[68:71], v177 offset:32768
    ds_read_b128 a[72:75], v178 offset:32768
    ds_read_b128 a[76:79], v179 offset:32768
    ds_read_b128 a[80:83], v176 offset:40960
    ds_read_b128 a[84:87], v177 offset:40960
    ds_read_b128 a[88:91], v178 offset:40960
    ds_read_b128 a[92:95], v179 offset:40960
    v_mov_b32 v144, 0
    v_mov_b32 v145, 0
    v_mov_b32 v146, 0
    v_mov_b32 v147, 0
    s_mov_b32 s38, 0x3e0293ee
    s_nop 3
    v_mul_f32 v0, s38, v0
    v_mul_f32 v1, s38, v1
    v_mul_f32 v2, s38, v2
    v_mul_f32 v3, s38, v3
    v_mul_f32 v16, s38, v16
    v_mul_f32 v17, s38, v17
    v_mul_f32 v18, s38, v18
    v_mul_f32 v19, s38, v19
    v_cvt_pk_bf16_f32 v228, v0, v1
    v_cvt_pk_bf16_f32 v229, v2, v3
    v_cvt_pk_bf16_f32 v230, v16, v17
    v_cvt_pk_bf16_f32 v231, v18, v19
    s_nop 1
    v_permlane32_swap_b32 v228, v230
    v_permlane32_swap_b32 v229, v231
    s_nop 0
    v_permlane16_swap_b32 v228, v230
    v_permlane16_swap_b32 v229, v231
    v_accvgpr_write_b32 a0, v228
    v_accvgpr_write_b32 a1, v229
    v_accvgpr_write_b32 a2, v230
    v_accvgpr_write_b32 a3, v231
    v_mul_f32 v32, s38, v32
    v_mul_f32 v33, s38, v33
    v_mul_f32 v34, s38, v34
    v_mul_f32 v35, s38, v35
    v_mfma_f32_16x16x32_bf16 v[0:3], v[144:147], v[144:147], 0
    v_mul_f32 v48, s38, v48
    v_mul_f32 v49, s38, v49
    v_mul_f32 v50, s38, v50
    v_mul_f32 v51, s38, v51
    v_mfma_f32_16x16x32_bf16 v[16:19], v[144:147], v[144:147], 0
    v_cvt_pk_bf16_f32 v232, v32, v33
    v_cvt_pk_bf16_f32 v233, v34, v35
    v_cvt_pk_bf16_f32 v234, v48, v49
    v_cvt_pk_bf16_f32 v235, v50, v51
    s_nop 1
    v_permlane32_swap_b32 v232, v234
    v_permlane32_swap_b32 v233, v235
    s_nop 0
    v_permlane16_swap_b32 v232, v234
    v_permlane16_swap_b32 v233, v235
    v_accvgpr_write_b32 a4, v232
    v_accvgpr_write_b32 a5, v233
    v_accvgpr_write_b32 a6, v234
    v_accvgpr_write_b32 a7, v235
    s_add_u32 m0, s35, 65536
    s_nop 0
    buffer_load_dwordx4 v196, s[12:15], s27 offen nt lds
    v_mul_f32 v64, s38, v64
    v_mul_f32 v65, s38, v65
    v_mul_f32 v66, s38, v66
    v_mul_f32 v67, s38, v67
    v_mfma_f32_16x16x32_bf16 v[32:35], v[144:147], v[144:147], 0
    v_mul_f32 v80, s38, v80
    v_mul_f32 v81, s38, v81
    v_mul_f32 v82, s38, v82
    v_mul_f32 v83, s38, v83
    v_mfma_f32_16x16x32_bf16 v[48:51], v[144:147], v[144:147], 0
    v_cvt_pk_bf16_f32 v228, v64, v65
    v_cvt_pk_bf16_f32 v229, v66, v67
    v_cvt_pk_bf16_f32 v230, v80, v81
    v_cvt_pk_bf16_f32 v231, v82, v83
    s_nop 1
    v_permlane32_swap_b32 v228, v230
    v_permlane32_swap_b32 v229, v231
    s_nop 0
    v_permlane16_swap_b32 v228, v230
    v_permlane16_swap_b32 v229, v231
    v_accvgpr_write_b32 a8, v228
    v_accvgpr_write_b32 a9, v229
    v_accvgpr_write_b32 a10, v230
    v_accvgpr_write_b32 a11, v231
    v_mul_f32 v96, s38, v96
    v_mul_f32 v97, s38, v97
    v_mul_f32 v98, s38, v98
    v_mul_f32 v99, s38, v99
    v_mfma_f32_16x16x32_bf16 v[64:67], v[144:147], v[144:147], 0
    v_mul_f32 v112, s38, v112
    v_mul_f32 v113, s38, v113
    v_mul_f32 v114, s38, v114
    v_mul_f32 v115, s38, v115
    v_mfma_f32_16x16x32_bf16 v[80:83], v[144:147], v[144:147], 0
    v_cvt_pk_bf16_f32 v232, v96, v97
    v_cvt_pk_bf16_f32 v233, v98, v99
    v_cvt_pk_bf16_f32 v234, v112, v113
    v_cvt_pk_bf16_f32 v235, v114, v115
    s_nop 1
    v_permlane32_swap_b32 v232, v234
    v_permlane32_swap_b32 v233, v235
    s_nop 0
    v_permlane16_swap_b32 v232, v234
    v_permlane16_swap_b32 v233, v235
    v_accvgpr_write_b32 a12, v232
    v_accvgpr_write_b32 a13, v233
    v_accvgpr_write_b32 a14, v234
    v_accvgpr_write_b32 a15, v235
    buffer_load_dwordx4 v197, s[12:15], s27 offen offset:1024 nt lds
    s_waitcnt lgkmcnt(0)
    v_mul_f32 v4, s38, v4
    v_mul_f32 v5, s38, v5
    v_mul_f32 v6, s38, v6
    v_mul_f32 v7, s38, v7
    v_mfma_f32_16x16x32_bf16 v[96:99], v[144:147], v[144:147], 0
    v_mul_f32 v20, s38, v20
    v_mul_f32 v21, s38, v21
    v_mul_f32 v22, s38, v22
    v_mul_f32 v23, s38, v23
    v_mfma_f32_16x16x32_bf16 v[112:115], v[144:147], v[144:147], 0
    v_cvt_pk_bf16_f32 v228, v4, v5
    v_cvt_pk_bf16_f32 v229, v6, v7
    v_cvt_pk_bf16_f32 v230, v20, v21
    v_cvt_pk_bf16_f32 v231, v22, v23
    s_nop 1
    v_permlane32_swap_b32 v228, v230
    v_permlane32_swap_b32 v229, v231
    s_nop 0
    v_permlane16_swap_b32 v228, v230
    v_permlane16_swap_b32 v229, v231
    v_accvgpr_write_b32 a16, v228
    v_accvgpr_write_b32 a17, v229
    v_mfma_f32_16x16x32_bf16 v[128:131], a[64:67], a[0:3], 0
    v_accvgpr_write_b32 a18, v230
    v_accvgpr_write_b32 a19, v231
    v_mul_f32 v36, s38, v36
    v_mul_f32 v37, s38, v37
    v_mul_f32 v38, s38, v38
    v_mul_f32 v39, s38, v39
    v_mfma_f32_16x16x32_bf16 v[128:131], a[68:71], a[4:7], v[128:131]
    v_mul_f32 v52, s38, v52
    v_mul_f32 v53, s38, v53
    v_mul_f32 v54, s38, v54
    v_mul_f32 v55, s38, v55
    v_mfma_f32_16x16x32_bf16 v[128:131], a[72:75], a[8:11], v[128:131]
    v_cvt_pk_bf16_f32 v232, v36, v37
    v_cvt_pk_bf16_f32 v233, v38, v39
    v_cvt_pk_bf16_f32 v234, v52, v53
    v_cvt_pk_bf16_f32 v235, v54, v55
    s_nop 1
    v_permlane32_swap_b32 v232, v234
    v_permlane32_swap_b32 v233, v235
    s_nop 0
    v_permlane16_swap_b32 v232, v234
    v_permlane16_swap_b32 v233, v235
    v_accvgpr_write_b32 a20, v232
    v_accvgpr_write_b32 a21, v233
    v_mfma_f32_16x16x32_bf16 v[128:131], a[76:79], a[12:15], v[128:131]
    v_accvgpr_write_b32 a22, v234
    v_accvgpr_write_b32 a23, v235
    buffer_load_dwordx4 v198, s[16:19], s27 offen offset:2048 nt lds
    v_mul_f32 v68, s38, v68
    v_mul_f32 v69, s38, v69
    v_mul_f32 v70, s38, v70
    v_mul_f32 v71, s38, v71
    v_mfma_f32_16x16x32_bf16 v[132:135], a[80:83], a[0:3], 0
    v_mul_f32 v84, s38, v84
    v_mul_f32 v85, s38, v85
    v_mul_f32 v86, s38, v86
    v_mul_f32 v87, s38, v87
    v_mfma_f32_16x16x32_bf16 v[132:135], a[84:87], a[4:7], v[132:135]
    v_cvt_pk_bf16_f32 v228, v68, v69
    v_cvt_pk_bf16_f32 v229, v70, v71
    v_cvt_pk_bf16_f32 v230, v84, v85
    v_cvt_pk_bf16_f32 v231, v86, v87
    s_nop 1
    v_permlane32_swap_b32 v228, v230
    v_permlane32_swap_b32 v229, v231
    s_nop 0
    v_permlane16_swap_b32 v228, v230
    v_permlane16_swap_b32 v229, v231
    v_accvgpr_write_b32 a24, v228
    v_accvgpr_write_b32 a25, v229
    v_mfma_f32_16x16x32_bf16 v[132:135], a[88:91], a[8:11], v[132:135]
    v_accvgpr_write_b32 a26, v230
    v_accvgpr_write_b32 a27, v231
    v_mul_f32 v100, s38, v100
    v_mul_f32 v101, s38, v101
    v_mul_f32 v102, s38, v102
    v_mul_f32 v103, s38, v103
    v_mfma_f32_16x16x32_bf16 v[132:135], a[92:95], a[12:15], v[132:135]
    v_mul_f32 v116, s38, v116
    v_mul_f32 v117, s38, v117
    v_mul_f32 v118, s38, v118
    v_mul_f32 v119, s38, v119
    v_mfma_f32_16x16x32_bf16 v[4:7], v[144:147], v[144:147], 0
    v_cvt_pk_bf16_f32 v232, v100, v101
    v_cvt_pk_bf16_f32 v233, v102, v103
    v_cvt_pk_bf16_f32 v234, v116, v117
    v_cvt_pk_bf16_f32 v235, v118, v119
    s_nop 1
    v_permlane32_swap_b32 v232, v234
    v_permlane32_swap_b32 v233, v235
    s_nop 0
    v_permlane16_swap_b32 v232, v234
    v_permlane16_swap_b32 v233, v235
    v_accvgpr_write_b32 a28, v232
    v_accvgpr_write_b32 a29, v233
    v_mfma_f32_16x16x32_bf16 v[20:23], v[144:147], v[144:147], 0
    v_accvgpr_write_b32 a30, v234
    v_accvgpr_write_b32 a31, v235
    buffer_load_dwordx4 v199, s[16:19], s27 offen offset:3072 nt lds
    s_add_u32 s27, s27, 8192
    v_mul_f32 v8, s38, v8
    v_mul_f32 v9, s38, v9
    v_mul_f32 v10, s38, v10
    v_mul_f32 v11, s38, v11
    v_mfma_f32_16x16x32_bf16 v[36:39], v[144:147], v[144:147], 0
    v_mul_f32 v24, s38, v24
    v_mul_f32 v25, s38, v25
    v_mul_f32 v26, s38, v26
    v_mul_f32 v27, s38, v27
    v_mfma_f32_16x16x32_bf16 v[52:55], v[144:147], v[144:147], 0
    v_cvt_pk_bf16_f32 v228, v8, v9
    v_cvt_pk_bf16_f32 v229, v10, v11
    v_cvt_pk_bf16_f32 v230, v24, v25
    v_cvt_pk_bf16_f32 v231, v26, v27
    s_nop 1
    v_permlane32_swap_b32 v228, v230
    v_permlane32_swap_b32 v229, v231
    s_nop 0
    v_permlane16_swap_b32 v228, v230
    v_permlane16_swap_b32 v229, v231
    v_accvgpr_write_b32 a32, v228
    v_accvgpr_write_b32 a33, v229
    v_mfma_f32_16x16x32_bf16 v[68:71], v[144:147], v[144:147], 0
    v_accvgpr_write_b32 a34, v230
    v_accvgpr_write_b32 a35, v231
    v_mul_f32 v40, s38, v40
    v_mul_f32 v41, s38, v41
    v_mul_f32 v42, s38, v42
    v_mul_f32 v43, s38, v43
    v_mfma_f32_16x16x32_bf16 v[84:87], v[144:147], v[144:147], 0
    v_mul_f32 v56, s38, v56
    v_mul_f32 v57, s38, v57
    v_mul_f32 v58, s38, v58
    v_mul_f32 v59, s38, v59
    v_mfma_f32_16x16x32_bf16 v[100:103], v[144:147], v[144:147], 0
    v_cvt_pk_bf16_f32 v232, v40, v41
    v_cvt_pk_bf16_f32 v233, v42, v43
    v_cvt_pk_bf16_f32 v234, v56, v57
    v_cvt_pk_bf16_f32 v235, v58, v59
    s_nop 1
    v_permlane32_swap_b32 v232, v234
    v_permlane32_swap_b32 v233, v235
    s_nop 0
    v_permlane16_swap_b32 v232, v234
    v_permlane16_swap_b32 v233, v235
    v_accvgpr_write_b32 a36, v232
    v_accvgpr_write_b32 a37, v233
    v_mfma_f32_16x16x32_bf16 v[116:119], v[144:147], v[144:147], 0
    v_accvgpr_write_b32 a38, v234
    v_accvgpr_write_b32 a39, v235
    s_add_u32 m0, s35, 81920
    s_nop 0
    buffer_load_dwordx4 v196, s[12:15], s27 offen nt lds
    v_mul_f32 v72, s38, v72
    v_mul_f32 v73, s38, v73
    v_mul_f32 v74, s38, v74
    v_mul_f32 v75, s38, v75
    v_mfma_f32_16x16x32_bf16 v[136:139], a[64:67], a[16:19], 0
    v_mul_f32 v88, s38, v88
    v_mul_f32 v89, s38, v89
    v_mul_f32 v90, s38, v90
    v_mul_f32 v91, s38, v91
    v_mfma_f32_16x16x32_bf16 v[136:139], a[68:71], a[20:23], v[136:139]
    v_cvt_pk_bf16_f32 v228, v72, v73
    v_cvt_pk_bf16_f32 v229, v74, v75
    v_cvt_pk_bf16_f32 v230, v88, v89
    v_cvt_pk_bf16_f32 v231, v90, v91
    s_nop 1
    v_permlane32_swap_b32 v228, v230
    v_permlane32_swap_b32 v229, v231
    s_nop 0
    v_permlane16_swap_b32 v228, v230
    v_permlane16_swap_b32 v229, v231
    v_accvgpr_write_b32 a40, v228
    v_accvgpr_write_b32 a41, v229
    v_mfma_f32_16x16x32_bf16 v[136:139], a[72:75], a[24:27], v[136:139]
    v_accvgpr_write_b32 a42, v230
    v_accvgpr_write_b32 a43, v231
    v_mul_f32 v104, s38, v104
    v_mul_f32 v105, s38, v105
    v_mul_f32 v106, s38, v106
    v_mul_f32 v107, s38, v107
    v_mfma_f32_16x16x32_bf16 v[136:139], a[76:79], a[28:31], v[136:139]
    v_mul_f32 v120, s38, v120
    v_mul_f32 v121, s38, v121
    v_mul_f32 v122, s38, v122
    v_mul_f32 v123, s38, v123
    v_mfma_f32_16x16x32_bf16 v[140:143], a[80:83], a[16:19], 0
    v_cvt_pk_bf16_f32 v232, v104, v105
    v_cvt_pk_bf16_f32 v233, v106, v107
    v_cvt_pk_bf16_f32 v234, v120, v121
    v_cvt_pk_bf16_f32 v235, v122, v123
    s_nop 1
    v_permlane32_swap_b32 v232, v234
    v_permlane32_swap_b32 v233, v235
    s_nop 0
    v_permlane16_swap_b32 v232, v234
    v_permlane16_swap_b32 v233, v235
    v_accvgpr_write_b32 a44, v232
    v_accvgpr_write_b32 a45, v233
    v_mfma_f32_16x16x32_bf16 v[140:143], a[84:87], a[20:23], v[140:143]
    v_accvgpr_write_b32 a46, v234
    v_accvgpr_write_b32 a47, v235
    buffer_load_dwordx4 v197, s[12:15], s27 offen offset:1024 nt lds
    v_mul_f32 v12, s38, v12
    v_mul_f32 v13, s38, v13
    v_mul_f32 v14, s38, v14
    v_mul_f32 v15, s38, v15
    v_mfma_f32_16x16x32_bf16 v[140:143], a[88:91], a[24:27], v[140:143]
    v_mul_f32 v28, s38, v28
    v_mul_f32 v29, s38, v29
    v_mul_f32 v30, s38, v30
    v_mul_f32 v31, s38, v31
    v_mfma_f32_16x16x32_bf16 v[140:143], a[92:95], a[28:31], v[140:143]
    v_cvt_pk_bf16_f32 v228, v12, v13
    v_cvt_pk_bf16_f32 v229, v14, v15
    v_cvt_pk_bf16_f32 v230, v28, v29
    v_cvt_pk_bf16_f32 v231, v30, v31
    s_nop 1
    v_permlane32_swap_b32 v228, v230
    v_permlane32_swap_b32 v229, v231
    s_nop 0
    v_permlane16_swap_b32 v228, v230
    v_permlane16_swap_b32 v229, v231
    v_accvgpr_write_b32 a48, v228
    v_accvgpr_write_b32 a49, v229
    v_mfma_f32_16x16x32_bf16 v[8:11], v[144:147], v[144:147], 0
    v_accvgpr_write_b32 a50, v230
    v_accvgpr_write_b32 a51, v231
    v_mul_f32 v44, s38, v44
    v_mul_f32 v45, s38, v45
    v_mul_f32 v46, s38, v46
    v_mul_f32 v47, s38, v47
    v_mfma_f32_16x16x32_bf16 v[24:27], v[144:147], v[144:147], 0
    v_mul_f32 v60, s38, v60
    v_mul_f32 v61, s38, v61
    v_mul_f32 v62, s38, v62
    v_mul_f32 v63, s38, v63
    v_mfma_f32_16x16x32_bf16 v[40:43], v[144:147], v[144:147], 0
    v_cvt_pk_bf16_f32 v232, v44, v45
    v_cvt_pk_bf16_f32 v233, v46, v47
    v_cvt_pk_bf16_f32 v234, v60, v61
    v_cvt_pk_bf16_f32 v235, v62, v63
    s_nop 1
    v_permlane32_swap_b32 v232, v234
    v_permlane32_swap_b32 v233, v235
    s_nop 0
    v_permlane16_swap_b32 v232, v234
    v_permlane16_swap_b32 v233, v235
    v_accvgpr_write_b32 a52, v232
    v_accvgpr_write_b32 a53, v233
    v_mfma_f32_16x16x32_bf16 v[56:59], v[144:147], v[144:147], 0
    v_accvgpr_write_b32 a54, v234
    v_accvgpr_write_b32 a55, v235
    buffer_load_dwordx4 v198, s[16:19], s27 offen offset:2048 nt lds
    v_mul_f32 v76, s38, v76
    v_mul_f32 v77, s38, v77
    v_mul_f32 v78, s38, v78
    v_mul_f32 v79, s38, v79
    v_mfma_f32_16x16x32_bf16 v[72:75], v[144:147], v[144:147], 0
    v_mul_f32 v92, s38, v92
    v_mul_f32 v93, s38, v93
    v_mul_f32 v94, s38, v94
    v_mul_f32 v95, s38, v95
    v_mfma_f32_16x16x32_bf16 v[88:91], v[144:147], v[144:147], 0
    v_cvt_pk_bf16_f32 v228, v76, v77
    v_cvt_pk_bf16_f32 v229, v78, v79
    v_cvt_pk_bf16_f32 v230, v92, v93
    v_cvt_pk_bf16_f32 v231, v94, v95
    s_nop 1
    v_permlane32_swap_b32 v228, v230
    v_permlane32_swap_b32 v229, v231
    s_nop 0
    v_permlane16_swap_b32 v228, v230
    v_permlane16_swap_b32 v229, v231
    v_accvgpr_write_b32 a56, v228
    v_accvgpr_write_b32 a57, v229
    v_mfma_f32_16x16x32_bf16 v[104:107], v[144:147], v[144:147], 0
    v_accvgpr_write_b32 a58, v230
    v_accvgpr_write_b32 a59, v231
    v_mul_f32 v108, s38, v108
    v_mul_f32 v109, s38, v109
    v_mul_f32 v110, s38, v110
    v_mul_f32 v111, s38, v111
    v_mfma_f32_16x16x32_bf16 v[120:123], v[144:147], v[144:147], 0
    v_mul_f32 v124, s38, v124
    v_mul_f32 v125, s38, v125
    v_mul_f32 v126, s38, v126
    v_mul_f32 v127, s38, v127
    v_mfma_f32_16x16x32_bf16 v[200:203], a[64:67], a[32:35], 0
    v_cvt_pk_bf16_f32 v232, v108, v109
    v_cvt_pk_bf16_f32 v233, v110, v111
    v_cvt_pk_bf16_f32 v234, v124, v125
    v_cvt_pk_bf16_f32 v235, v126, v127
    s_nop 1
    v_permlane32_swap_b32 v232, v234
    v_permlane32_swap_b32 v233, v235
    s_nop 0
    v_permlane16_swap_b32 v232, v234
    v_permlane16_swap_b32 v233, v235
    v_accvgpr_write_b32 a60, v232
    v_accvgpr_write_b32 a61, v233
    v_mfma_f32_16x16x32_bf16 v[200:203], a[68:71], a[36:39], v[200:203]
    v_accvgpr_write_b32 a62, v234
    v_accvgpr_write_b32 a63, v235
    buffer_load_dwordx4 v199, s[16:19], s27 offen offset:3072 nt lds
    s_add_u32 s27, s27, 8192
    s_and_b32 s27, s27, 0x7ffff
    s_nop 1
    v_mfma_f32_16x16x32_bf16 v[200:203], a[72:75], a[40:43], v[200:203]
    v_mfma_f32_16x16x32_bf16 v[200:203], a[76:79], a[44:47], v[200:203]
    v_mfma_f32_16x16x32_bf16 v[204:207], a[80:83], a[32:35], 0
    v_mfma_f32_16x16x32_bf16 v[204:207], a[84:87], a[36:39], v[204:207]
    v_mfma_f32_16x16x32_bf16 v[204:207], a[88:91], a[40:43], v[204:207]
    v_mfma_f32_16x16x32_bf16 v[204:207], a[92:95], a[44:47], v[204:207]
    v_mfma_f32_16x16x32_bf16 v[12:15], v[144:147], v[144:147], 0
    v_mfma_f32_16x16x32_bf16 v[28:31], v[144:147], v[144:147], 0
    v_mfma_f32_16x16x32_bf16 v[44:47], v[144:147], v[144:147], 0
    v_mfma_f32_16x16x32_bf16 v[60:63], v[144:147], v[144:147], 0
    v_mfma_f32_16x16x32_bf16 v[76:79], v[144:147], v[144:147], 0
    v_mfma_f32_16x16x32_bf16 v[92:95], v[144:147], v[144:147], 0
    v_mfma_f32_16x16x32_bf16 v[108:111], v[144:147], v[144:147], 0
    v_mfma_f32_16x16x32_bf16 v[124:127], v[144:147], v[144:147], 0
    v_mfma_f32_16x16x32_bf16 v[208:211], a[64:67], a[48:51], 0
    v_mfma_f32_16x16x32_bf16 v[208:211], a[68:71], a[52:55], v[208:211]
    v_mfma_f32_16x16x32_bf16 v[208:211], a[72:75], a[56:59], v[208:211]
    v_mfma_f32_16x16x32_bf16 v[208:211], a[76:79], a[60:63], v[208:211]
    v_mfma_f32_16x16x32_bf16 v[212:215], a[80:83], a[48:51], 0
    v_mfma_f32_16x16x32_bf16 v[212:215], a[84:87], a[52:55], v[212:215]
    v_mfma_f32_16x16x32_bf16 v[212:215], a[88:91], a[56:59], v[212:215]
    v_mfma_f32_16x16x32_bf16 v[212:215], a[92:95], a[60:63], v[212:215]
    s_cmp_lg_u32 s24, 0
    s_cbranch_scc1 L_nocnt
    s_lshl_b32 s38, s25, 5
    v_mov_b32 v244, s38
    v_mov_b32 v245, 1
    s_mov_b64 s[62:63], exec
    s_mov_b64 exec, 1
    global_atomic_add v244, v245, s[64:65] sc1
    s_mov_b64 exec, s[62:63]
L_nocnt:
    s_mul_i32 s38, s2, 144
    s_mul_i32 s39, s24, 36
    s_add_u32 s38, s38, s39
    v_min_u32 v246, 35, v227
    v_add_u32 v246, s38, v246
    v_lshlrev_b32 v246, 7, v246
    buffer_load_dword v247, v246, s[4:7], 0 offen
    s_nop 7
    v_max3_f32 v228, v128, v129, v130
    v_max3_f32 v228, v228, v131, v132
    v_max3_f32 v228, v228, v133, v134
    v_max_f32 v228, v228, v135
    v_max3_f32 v229, v136, v137, v138
    v_max3_f32 v229, v229, v139, v140
    v_max3_f32 v229, v229, v141, v142
    v_max_f32 v229, v229, v143
    v_max3_f32 v230, v200, v201, v202
    v_max3_f32 v230, v230, v203, v204
    v_max3_f32 v230, v230, v205, v206
    v_max_f32 v230, v230, v207
    v_max3_f32 v231, v208, v209, v210
    v_max3_f32 v231, v231, v211, v212
    v_max3_f32 v231, v231, v213, v214
    v_max_f32 v231, v231, v215
    v_mov_b32 v232, v228
    v_mov_b32 v233, v229
    v_mov_b32 v234, v230
    v_mov_b32 v235, v231
    s_nop 1
    v_permlane32_swap_b32 v228, v232
    v_permlane32_swap_b32 v229, v233
    v_permlane32_swap_b32 v230, v234
    v_permlane32_swap_b32 v231, v235
    v_max_f32 v228, v228, v232
    v_max_f32 v229, v229, v233
    v_max_f32 v230, v230, v234
    v_max_f32 v231, v231, v235
    v_mov_b32 v232, v228
    v_mov_b32 v233, v229
    v_mov_b32 v234, v230
    v_mov_b32 v235, v231
    s_nop 1
    v_permlane16_swap_b32 v228, v232
    v_permlane16_swap_b32 v229, v233
    v_permlane16_swap_b32 v230, v234
    v_permlane16_swap_b32 v231, v235
    v_max_f32 v228, v228, v232
    v_max_f32 v229, v229, v233
    v_max_f32 v230, v230, v234
    v_max_f32 v231, v231, v235
    v_and_b32 v236, 15, v227
    s_lshl_b32 s38, s24, 6
    v_add_u32 v236, s38, v236
    v_mov_b32 v237, 0xff800000
    v_sub_f32 v238, 0, v228
    v_mov_b32 v152, v238
    v_mov_b32 v153, v238
    v_mov_b32 v154, v238
    v_mov_b32 v155, v238
    v_sub_f32 v238, 0, v229
    v_mov_b32 v156, v238
    v_mov_b32 v157, v238
    v_mov_b32 v158, v238
    v_mov_b32 v159, v238
    v_sub_f32 v238, 0, v230
    v_mov_b32 v160, v238
    v_mov_b32 v161, v238
    v_mov_b32 v162, v238
    v_mov_b32 v163, v238
    v_sub_f32 v238, 0, v231
    v_cmp_gt_u32 vcc, 192, v236
    s_nop 1
    v_cndmask_b32 v238, v237, v238, vcc
    v_mov_b32 v164, v238
    v_mov_b32 v165, v238
    v_mov_b32 v166, v238
    v_mov_b32 v167, v238
L_attn_go:
    ds_read_b64_tr_b16 a[128:129], v188 offset:32768
    ds_read_b64_tr_b16 a[130:131], v188 offset:40960
    ds_read_b64_tr_b16 a[132:133], v189 offset:32768
    ds_read_b64_tr_b16 a[134:135], v189 offset:40960
    ds_read_b64_tr_b16 a[136:137], v190 offset:32768
    ds_read_b64_tr_b16 a[138:139], v190 offset:40960
    ds_read_b64_tr_b16 a[140:141], v191 offset:32768
    ds_read_b64_tr_b16 a[142:143], v191 offset:40960
    ds_read_b64_tr_b16 a[144:145], v192 offset:32768
    ds_read_b64_tr_b16 a[146:147], v192 offset:40960
    ds_read_b64_tr_b16 a[148:149], v193 offset:32768
    ds_read_b64_tr_b16 a[150:151], v193 offset:40960
    ds_read_b64_tr_b16 a[152:153], v194 offset:32768
    ds_read_b64_tr_b16 a[154:155], v194 offset:40960
    ds_read_b64_tr_b16 a[156:157], v195 offset:32768
    ds_read_b64_tr_b16 a[158:159], v195 offset:40960
    v_mov_b32 v200, 0
    v_mov_b32 v201, 0
    v_mov_b32 v202, 0
    v_mov_b32 v203, 0
    v_mov_b32 v204, 0
    v_mov_b32 v205, 0
    v_mov_b32 v206, 0
    v_mov_b32 v207, 0
    v_mov_b32 v208, 0
    v_mov_b32 v209, 0
    v_mov_b32 v210, 0
    v_mov_b32 v211, 0
    v_mov_b32 v212, 0
    v_mov_b32 v213, 0
    v_mov_b32 v214, 0
    v_mov_b32 v215, 0
    v_mov_b32 v216, 0x3f803f80
    v_mov_b32 v217, 0x3f803f80
    v_mov_b32 v218, 0x3f803f80
    v_mov_b32 v219, 0x3f803f80
    v_mov_b32 v136, 0xff800000
    v_mov_b32 v137, 0xff800000
    v_mov_b32 v138, 0xff800000
    v_mov_b32 v139, 0xff800000
    v_mov_b32 v140, 0xff800000
    v_mov_b32 v141, 0xff800000
    v_mov_b32 v142, 0xff800000
    v_mov_b32 v143, 0xff800000
    s_mov_b32 s31, 7
    s_cmp_eq_u32 s24, 3
    s_cbranch_scc1 L_loop3
L_loop:
    s_waitcnt vmcnt(24) lgkmcnt(0)
    s_barrier
    s_add_u32 m0, s35, 98304
    v_mfma_f32_16x16x32_bf16 v[128:131], a[64:67], a[0:3], v[152:155]
    v_exp_f32 v136, v136
    v_mfma_f32_16x16x32_bf16 v[128:131], a[68:71], a[4:7], v[128:131]
    ds_read_b128 a[96:99], v176 offset:49152
    v_mfma_f32_16x16x32_bf16 v[128:131], a[72:75], a[8:11], v[128:131]
    v_exp_f32 v137, v137
    v_mfma_f32_16x16x32_bf16 v[128:131], a[76:79], a[12:15], v[128:131]
    ds_read_b128 a[100:103], v177 offset:49152
    v_cvt_pk_bf16_f32 v148, v136, v137
    v_mfma_f32_16x16x32_bf16 v[132:135], a[80:83], a[0:3], v[152:155]
    v_exp_f32 v138, v138
    v_mfma_f32_16x16x32_bf16 v[132:135], a[84:87], a[4:7], v[132:135]
    ds_read_b128 a[104:107], v178 offset:49152
    v_mfma_f32_16x16x32_bf16 v[132:135], a[88:91], a[8:11], v[132:135]
    v_exp_f32 v139, v139
    v_mfma_f32_16x16x32_bf16 v[132:135], a[92:95], a[12:15], v[132:135]
    v_cvt_pk_bf16_f32 v149, v138, v139
    v_mfma_f32_16x16x32_bf16 v[8:11], a[160:163], v[144:147], v[8:11]
    v_exp_f32 v140, v140
    v_mfma_f32_16x16x32_bf16 v[24:27], a[164:167], v[144:147], v[24:27]
    ds_read_b128 a[108:111], v179 offset:49152
    v_mfma_f32_16x16x32_bf16 v[40:43], a[168:171], v[144:147], v[40:43]
    v_exp_f32 v141, v141
    v_mfma_f32_16x16x32_bf16 v[56:59], a[172:175], v[144:147], v[56:59]
    ds_read_b128 a[112:115], v176 offset:57344
    v_cvt_pk_bf16_f32 v150, v140, v141
    v_mfma_f32_16x16x32_bf16 v[72:75], a[176:179], v[144:147], v[72:75]
    v_exp_f32 v142, v142
    v_mfma_f32_16x16x32_bf16 v[88:91], a[180:183], v[144:147], v[88:91]
    ds_read_b128 a[116:119], v177 offset:57344
    v_mfma_f32_16x16x32_bf16 v[104:107], a[184:187], v[144:147], v[104:107]
    v_exp_f32 v143, v143
    v_mfma_f32_16x16x32_bf16 v[120:123], a[188:191], v[144:147], v[120:123]
    v_cvt_pk_bf16_f32 v151, v142, v143
    v_mfma_f32_16x16x32_bf16 v[208:211], v[216:219], v[144:147], v[208:211]
    buffer_load_dwordx4 v196, s[12:15], s27 offen nt lds
    v_mfma_f32_16x16x32_bf16 v[136:139], a[64:67], a[16:19], v[156:159]
    v_exp_f32 v128, v128
    v_mfma_f32_16x16x32_bf16 v[136:139], a[68:71], a[20:23], v[136:139]
    ds_read_b128 a[120:123], v178 offset:57344
    v_mfma_f32_16x16x32_bf16 v[136:139], a[72:75], a[24:27], v[136:139]
    v_exp_f32 v129, v129
    v_mfma_f32_16x16x32_bf16 v[136:139], a[76:79], a[28:31], v[136:139]
    v_cvt_pk_bf16_f32 v144, v128, v129
    v_mfma_f32_16x16x32_bf16 v[140:143], a[80:83], a[16:19], v[156:159]
    v_exp_f32 v130, v130
    v_mfma_f32_16x16x32_bf16 v[140:143], a[84:87], a[20:23], v[140:143]
    ds_read_b128 a[124:127], v179 offset:57344
    v_mfma_f32_16x16x32_bf16 v[140:143], a[88:91], a[24:27], v[140:143]
    v_exp_f32 v131, v131
    v_mfma_f32_16x16x32_bf16 v[140:143], a[92:95], a[28:31], v[140:143]
    v_cvt_pk_bf16_f32 v145, v130, v131
    v_mfma_f32_16x16x32_bf16 v[12:15], a[160:163], v[148:151], v[12:15]
    v_exp_f32 v132, v132
    v_mfma_f32_16x16x32_bf16 v[28:31], a[164:167], v[148:151], v[28:31]
    ds_read_b64_tr_b16 a[160:161], v188 offset:49152
    v_mfma_f32_16x16x32_bf16 v[44:47], a[168:171], v[148:151], v[44:47]
    v_exp_f32 v133, v133
    v_mfma_f32_16x16x32_bf16 v[60:63], a[172:175], v[148:151], v[60:63]
    ds_read_b64_tr_b16 a[162:163], v188 offset:57344
    v_cvt_pk_bf16_f32 v146, v132, v133
    v_mfma_f32_16x16x32_bf16 v[76:79], a[176:179], v[148:151], v[76:79]
    v_exp_f32 v134, v134
    v_mfma_f32_16x16x32_bf16 v[92:95], a[180:183], v[148:151], v[92:95]
    ds_read_b64_tr_b16 a[164:165], v189 offset:49152
    v_mfma_f32_16x16x32_bf16 v[108:111], a[184:187], v[148:151], v[108:111]
    v_exp_f32 v135, v135
    v_mfma_f32_16x16x32_bf16 v[124:127], a[188:191], v[148:151], v[124:127]
    ds_read_b64_tr_b16 a[166:167], v189 offset:57344
    v_cvt_pk_bf16_f32 v147, v134, v135
    v_mfma_f32_16x16x32_bf16 v[212:215], v[216:219], v[148:151], v[212:215]
    buffer_load_dwordx4 v197, s[12:15], s27 offen offset:1024 nt lds
    v_mfma_f32_16x16x32_bf16 v[128:131], a[64:67], a[32:35], v[160:163]
    v_exp_f32 v136, v136
    v_mfma_f32_16x16x32_bf16 v[128:131], a[68:71], a[36:39], v[128:131]
    ds_read_b64_tr_b16 a[168:169], v190 offset:49152
    v_mfma_f32_16x16x32_bf16 v[128:131], a[72:75], a[40:43], v[128:131]
    v_exp_f32 v137, v137
    v_mfma_f32_16x16x32_bf16 v[128:131], a[76:79], a[44:47], v[128:131]
    ds_read_b64_tr_b16 a[170:171], v190 offset:57344
    v_cvt_pk_bf16_f32 v148, v136, v137
    v_mfma_f32_16x16x32_bf16 v[132:135], a[80:83], a[32:35], v[160:163]
    v_exp_f32 v138, v138
    v_mfma_f32_16x16x32_bf16 v[132:135], a[84:87], a[36:39], v[132:135]
    ds_read_b64_tr_b16 a[172:173], v191 offset:49152
    v_mfma_f32_16x16x32_bf16 v[132:135], a[88:91], a[40:43], v[132:135]
    v_exp_f32 v139, v139
    v_mfma_f32_16x16x32_bf16 v[132:135], a[92:95], a[44:47], v[132:135]
    v_cvt_pk_bf16_f32 v149, v138, v139
    v_mfma_f32_16x16x32_bf16 v[0:3], a[128:131], v[144:147], v[0:3]
    v_exp_f32 v140, v140
    v_mfma_f32_16x16x32_bf16 v[16:19], a[132:135], v[144:147], v[16:19]
    ds_read_b64_tr_b16 a[174:175], v191 offset:57344
    v_mfma_f32_16x16x32_bf16 v[32:35], a[136:139], v[144:147], v[32:35]
    v_exp_f32 v141, v141
    v_mfma_f32_16x16x32_bf16 v[48:51], a[140:143], v[144:147], v[48:51]
    ds_read_b64_tr_b16 a[176:177], v192 offset:49152
    v_cvt_pk_bf16_f32 v150, v140, v141
    v_mfma_f32_16x16x32_bf16 v[64:67], a[144:147], v[144:147], v[64:67]
    v_exp_f32 v142, v142
    v_mfma_f32_16x16x32_bf16 v[80:83], a[148:151], v[144:147], v[80:83]
    ds_read_b64_tr_b16 a[178:179], v192 offset:57344
    v_mfma_f32_16x16x32_bf16 v[96:99], a[152:155], v[144:147], v[96:99]
    v_exp_f32 v143, v143
    v_mfma_f32_16x16x32_bf16 v[112:115], a[156:159], v[144:147], v[112:115]
    v_cvt_pk_bf16_f32 v151, v142, v143
    v_mfma_f32_16x16x32_bf16 v[200:203], v[216:219], v[144:147], v[200:203]
    buffer_load_dwordx4 v198, s[16:19], s27 offen offset:2048 nt lds
    v_mfma_f32_16x16x32_bf16 v[136:139], a[64:67], a[48:51], v[164:167]
    v_exp_f32 v128, v128
    v_mfma_f32_16x16x32_bf16 v[136:139], a[68:71], a[52:55], v[136:139]
    ds_read_b64_tr_b16 a[180:181], v193 offset:49152
    v_mfma_f32_16x16x32_bf16 v[136:139], a[72:75], a[56:59], v[136:139]
    v_exp_f32 v129, v129
    v_mfma_f32_16x16x32_bf16 v[136:139], a[76:79], a[60:63], v[136:139]
    ds_read_b64_tr_b16 a[182:183], v193 offset:57344
    v_cvt_pk_bf16_f32 v144, v128, v129
    v_mfma_f32_16x16x32_bf16 v[140:143], a[80:83], a[48:51], v[164:167]
    v_exp_f32 v130, v130
    v_mfma_f32_16x16x32_bf16 v[140:143], a[84:87], a[52:55], v[140:143]
    ds_read_b64_tr_b16 a[184:185], v194 offset:49152
    v_mfma_f32_16x16x32_bf16 v[140:143], a[88:91], a[56:59], v[140:143]
    v_exp_f32 v131, v131
    v_mfma_f32_16x16x32_bf16 v[140:143], a[92:95], a[60:63], v[140:143]
    ds_read_b64_tr_b16 a[186:187], v194 offset:57344
    v_cvt_pk_bf16_f32 v145, v130, v131
    v_mfma_f32_16x16x32_bf16 v[4:7], a[128:131], v[148:151], v[4:7]
    v_exp_f32 v132, v132
    v_mfma_f32_16x16x32_bf16 v[20:23], a[132:135], v[148:151], v[20:23]
    ds_read_b64_tr_b16 a[188:189], v195 offset:49152
    v_mfma_f32_16x16x32_bf16 v[36:39], a[136:139], v[148:151], v[36:39]
    v_exp_f32 v133, v133
    v_mfma_f32_16x16x32_bf16 v[52:55], a[140:143], v[148:151], v[52:55]
    ds_read_b64_tr_b16 a[190:191], v195 offset:57344
    v_cvt_pk_bf16_f32 v146, v132, v133
    v_mfma_f32_16x16x32_bf16 v[68:71], a[144:147], v[148:151], v[68:71]
    v_exp_f32 v134, v134
    v_mfma_f32_16x16x32_bf16 v[84:87], a[148:151], v[148:151], v[84:87]
    buffer_load_dwordx4 v199, s[16:19], s27 offen offset:3072 nt lds
    s_add_u32 s27, s27, 8192
    v_mfma_f32_16x16x32_bf16 v[100:103], a[152:155], v[148:151], v[100:103]
    v_exp_f32 v135, v135
    v_mfma_f32_16x16x32_bf16 v[116:119], a[156:159], v[148:151], v[116:119]
    v_cvt_pk_bf16_f32 v147, v134, v135
    v_mfma_f32_16x16x32_bf16 v[204:207], v[216:219], v[148:151], v[204:207]
    s_waitcnt vmcnt(24) lgkmcnt(0)
    s_barrier
    s_add_u32 m0, s35, 114688
    v_mfma_f32_16x16x32_bf16 v[128:131], a[96:99], a[0:3], v[152:155]
    v_exp_f32 v136, v136
    v_mfma_f32_16x16x32_bf16 v[128:131], a[100:103], a[4:7], v[128:131]
    ds_read_b128 a[64:67], v172 offset:0
    v_mfma_f32_16x16x32_bf16 v[128:131], a[104:107], a[8:11], v[128:131]
    v_exp_f32 v137, v137
    v_mfma_f32_16x16x32_bf16 v[128:131], a[108:111], a[12:15], v[128:131]
    ds_read_b128 a[68:71], v173 offset:0
    v_cvt_pk_bf16_f32 v148, v136, v137
    v_mfma_f32_16x16x32_bf16 v[132:135], a[112:115], a[0:3], v[152:155]
    v_exp_f32 v138, v138
    v_mfma_f32_16x16x32_bf16 v[132:135], a[116:119], a[4:7], v[132:135]
    ds_read_b128 a[72:75], v174 offset:0
    v_mfma_f32_16x16x32_bf16 v[132:135], a[120:123], a[8:11], v[132:135]
    v_exp_f32 v139, v139
    v_mfma_f32_16x16x32_bf16 v[132:135], a[124:127], a[12:15], v[132:135]
    v_cvt_pk_bf16_f32 v149, v138, v139
    v_mfma_f32_16x16x32_bf16 v[8:11], a[128:131], v[144:147], v[8:11]
    v_exp_f32 v140, v140
    v_mfma_f32_16x16x32_bf16 v[24:27], a[132:135], v[144:147], v[24:27]
    ds_read_b128 a[76:79], v175 offset:0
    v_mfma_f32_16x16x32_bf16 v[40:43], a[136:139], v[144:147], v[40:43]
    v_exp_f32 v141, v141
    v_mfma_f32_16x16x32_bf16 v[56:59], a[140:143], v[144:147], v[56:59]
    ds_read_b128 a[80:83], v172 offset:8192
    v_cvt_pk_bf16_f32 v150, v140, v141
    v_mfma_f32_16x16x32_bf16 v[72:75], a[144:147], v[144:147], v[72:75]
    v_exp_f32 v142, v142
    v_mfma_f32_16x16x32_bf16 v[88:91], a[148:151], v[144:147], v[88:91]
    ds_read_b128 a[84:87], v173 offset:8192
    v_mfma_f32_16x16x32_bf16 v[104:107], a[152:155], v[144:147], v[104:107]
    v_exp_f32 v143, v143
    v_mfma_f32_16x16x32_bf16 v[120:123], a[156:159], v[144:147], v[120:123]
    v_cvt_pk_bf16_f32 v151, v142, v143
    v_mfma_f32_16x16x32_bf16 v[208:211], v[216:219], v[144:147], v[208:211]
    buffer_load_dwordx4 v196, s[12:15], s27 offen nt lds
    v_mfma_f32_16x16x32_bf16 v[136:139], a[96:99], a[16:19], v[156:159]
    v_exp_f32 v128, v128
    v_mfma_f32_16x16x32_bf16 v[136:139], a[100:103], a[20:23], v[136:139]
    ds_read_b128 a[88:91], v174 offset:8192
    v_mfma_f32_16x16x32_bf16 v[136:139], a[104:107], a[24:27], v[136:139]
    v_exp_f32 v129, v129
    v_mfma_f32_16x16x32_bf16 v[136:139], a[108:111], a[28:31], v[136:139]
    v_cvt_pk_bf16_f32 v144, v128, v129
    v_mfma_f32_16x16x32_bf16 v[140:143], a[112:115], a[16:19], v[156:159]
    v_exp_f32 v130, v130
    v_mfma_f32_16x16x32_bf16 v[140:143], a[116:119], a[20:23], v[140:143]
    ds_read_b128 a[92:95], v175 offset:8192
    v_mfma_f32_16x16x32_bf16 v[140:143], a[120:123], a[24:27], v[140:143]
    v_exp_f32 v131, v131
    v_mfma_f32_16x16x32_bf16 v[140:143], a[124:127], a[28:31], v[140:143]
    v_cvt_pk_bf16_f32 v145, v130, v131
    v_mfma_f32_16x16x32_bf16 v[12:15], a[128:131], v[148:151], v[12:15]
    v_exp_f32 v132, v132
    v_mfma_f32_16x16x32_bf16 v[28:31], a[132:135], v[148:151], v[28:31]
    ds_read_b64_tr_b16 a[128:129], v180 offset:0
    v_mfma_f32_16x16x32_bf16 v[44:47], a[136:139], v[148:151], v[44:47]
    v_exp_f32 v133, v133
    v_mfma_f32_16x16x32_bf16 v[60:63], a[140:143], v[148:151], v[60:63]
    ds_read_b64_tr_b16 a[130:131], v180 offset:8192
    v_cvt_pk_bf16_f32 v146, v132, v133
    v_mfma_f32_16x16x32_bf16 v[76:79], a[144:147], v[148:151], v[76:79]
    v_exp_f32 v134, v134
    v_mfma_f32_16x16x32_bf16 v[92:95], a[148:151], v[148:151], v[92:95]
    ds_read_b64_tr_b16 a[132:133], v181 offset:0
    v_mfma_f32_16x16x32_bf16 v[108:111], a[152:155], v[148:151], v[108:111]
    v_exp_f32 v135, v135
    v_mfma_f32_16x16x32_bf16 v[124:127], a[156:159], v[148:151], v[124:127]
    ds_read_b64_tr_b16 a[134:135], v181 offset:8192
    v_cvt_pk_bf16_f32 v147, v134, v135
    v_mfma_f32_16x16x32_bf16 v[212:215], v[216:219], v[148:151], v[212:215]
    buffer_load_dwordx4 v197, s[12:15], s27 offen offset:1024 nt lds
    v_mfma_f32_16x16x32_bf16 v[128:131], a[96:99], a[32:35], v[160:163]
    v_exp_f32 v136, v136
    v_mfma_f32_16x16x32_bf16 v[128:131], a[100:103], a[36:39], v[128:131]
    ds_read_b64_tr_b16 a[136:137], v182 offset:0
    v_mfma_f32_16x16x32_bf16 v[128:131], a[104:107], a[40:43], v[128:131]
    v_exp_f32 v137, v137
    v_mfma_f32_16x16x32_bf16 v[128:131], a[108:111], a[44:47], v[128:131]
    ds_read_b64_tr_b16 a[138:139], v182 offset:8192
    v_cvt_pk_bf16_f32 v148, v136, v137
    v_mfma_f32_16x16x32_bf16 v[132:135], a[112:115], a[32:35], v[160:163]
    v_exp_f32 v138, v138
    v_mfma_f32_16x16x32_bf16 v[132:135], a[116:119], a[36:39], v[132:135]
    ds_read_b64_tr_b16 a[140:141], v183 offset:0
    v_mfma_f32_16x16x32_bf16 v[132:135], a[120:123], a[40:43], v[132:135]
    v_exp_f32 v139, v139
    v_mfma_f32_16x16x32_bf16 v[132:135], a[124:127], a[44:47], v[132:135]
    v_cvt_pk_bf16_f32 v149, v138, v139
    v_mfma_f32_16x16x32_bf16 v[0:3], a[160:163], v[144:147], v[0:3]
    v_exp_f32 v140, v140
    v_mfma_f32_16x16x32_bf16 v[16:19], a[164:167], v[144:147], v[16:19]
    ds_read_b64_tr_b16 a[142:143], v183 offset:8192
    v_mfma_f32_16x16x32_bf16 v[32:35], a[168:171], v[144:147], v[32:35]
    v_exp_f32 v141, v141
    v_mfma_f32_16x16x32_bf16 v[48:51], a[172:175], v[144:147], v[48:51]
    ds_read_b64_tr_b16 a[144:145], v184 offset:0
    v_cvt_pk_bf16_f32 v150, v140, v141
    v_mfma_f32_16x16x32_bf16 v[64:67], a[176:179], v[144:147], v[64:67]
    v_exp_f32 v142, v142
    v_mfma_f32_16x16x32_bf16 v[80:83], a[180:183], v[144:147], v[80:83]
    ds_read_b64_tr_b16 a[146:147], v184 offset:8192
    v_mfma_f32_16x16x32_bf16 v[96:99], a[184:187], v[144:147], v[96:99]
    v_exp_f32 v143, v143
    v_mfma_f32_16x16x32_bf16 v[112:115], a[188:191], v[144:147], v[112:115]
    v_cvt_pk_bf16_f32 v151, v142, v143
    v_mfma_f32_16x16x32_bf16 v[200:203], v[216:219], v[144:147], v[200:203]
    buffer_load_dwordx4 v198, s[16:19], s27 offen offset:2048 nt lds
    v_mfma_f32_16x16x32_bf16 v[136:139], a[96:99], a[48:51], v[164:167]
    v_exp_f32 v128, v128
    v_mfma_f32_16x16x32_bf16 v[136:139], a[100:103], a[52:55], v[136:139]
    ds_read_b64_tr_b16 a[148:149], v185 offset:0
    v_mfma_f32_16x16x32_bf16 v[136:139], a[104:107], a[56:59], v[136:139]
    v_exp_f32 v129, v129
    v_mfma_f32_16x16x32_bf16 v[136:139], a[108:111], a[60:63], v[136:139]
    ds_read_b64_tr_b16 a[150:151], v185 offset:8192
    v_cvt_pk_bf16_f32 v144, v128, v129
    v_mfma_f32_16x16x32_bf16 v[140:143], a[112:115], a[48:51], v[164:167]
    v_exp_f32 v130, v130
    v_mfma_f32_16x16x32_bf16 v[140:143], a[116:119], a[52:55], v[140:143]
    ds_read_b64_tr_b16 a[152:153], v186 offset:0
    v_mfma_f32_16x16x32_bf16 v[140:143], a[120:123], a[56:59], v[140:143]
    v_exp_f32 v131, v131
    v_mfma_f32_16x16x32_bf16 v[140:143], a[124:127], a[60:63], v[140:143]
    ds_read_b64_tr_b16 a[154:155], v186 offset:8192
    v_cvt_pk_bf16_f32 v145, v130, v131
    v_mfma_f32_16x16x32_bf16 v[4:7], a[160:163], v[148:151], v[4:7]
    v_exp_f32 v132, v132
    v_mfma_f32_16x16x32_bf16 v[20:23], a[164:167], v[148:151], v[20:23]
    ds_read_b64_tr_b16 a[156:157], v187 offset:0
    v_mfma_f32_16x16x32_bf16 v[36:39], a[168:171], v[148:151], v[36:39]
    v_exp_f32 v133, v133
    v_mfma_f32_16x16x32_bf16 v[52:55], a[172:175], v[148:151], v[52:55]
    ds_read_b64_tr_b16 a[158:159], v187 offset:8192
    v_cvt_pk_bf16_f32 v146, v132, v133
    v_mfma_f32_16x16x32_bf16 v[68:71], a[176:179], v[148:151], v[68:71]
    v_exp_f32 v134, v134
    v_mfma_f32_16x16x32_bf16 v[84:87], a[180:183], v[148:151], v[84:87]
    buffer_load_dwordx4 v199, s[16:19], s27 offen offset:3072 nt lds
    s_add_u32 s27, s27, 8192
    v_mfma_f32_16x16x32_bf16 v[100:103], a[184:187], v[148:151], v[100:103]
    v_exp_f32 v135, v135
    v_mfma_f32_16x16x32_bf16 v[116:119], a[188:191], v[148:151], v[116:119]
    v_cvt_pk_bf16_f32 v147, v134, v135
    v_mfma_f32_16x16x32_bf16 v[204:207], v[216:219], v[148:151], v[204:207]
    s_waitcnt vmcnt(24) lgkmcnt(0)
    s_barrier
    s_add_u32 m0, s35, 0
    v_mfma_f32_16x16x32_bf16 v[128:131], a[64:67], a[0:3], v[152:155]
    v_exp_f32 v136, v136
    v_mfma_f32_16x16x32_bf16 v[128:131], a[68:71], a[4:7], v[128:131]
    ds_read_b128 a[96:99], v172 offset:16384
    v_mfma_f32_16x16x32_bf16 v[128:131], a[72:75], a[8:11], v[128:131]
    v_exp_f32 v137, v137
    v_mfma_f32_16x16x32_bf16 v[128:131], a[76:79], a[12:15], v[128:131]
    ds_read_b128 a[100:103], v173 offset:16384
    v_cvt_pk_bf16_f32 v148, v136, v137
    v_mfma_f32_16x16x32_bf16 v[132:135], a[80:83], a[0:3], v[152:155]
    v_exp_f32 v138, v138
    v_mfma_f32_16x16x32_bf16 v[132:135], a[84:87], a[4:7], v[132:135]
    ds_read_b128 a[104:107], v174 offset:16384
    v_mfma_f32_16x16x32_bf16 v[132:135], a[88:91], a[8:11], v[132:135]
    v_exp_f32 v139, v139
    v_mfma_f32_16x16x32_bf16 v[132:135], a[92:95], a[12:15], v[132:135]
    v_cvt_pk_bf16_f32 v149, v138, v139
    v_mfma_f32_16x16x32_bf16 v[8:11], a[160:163], v[144:147], v[8:11]
    v_exp_f32 v140, v140
    v_mfma_f32_16x16x32_bf16 v[24:27], a[164:167], v[144:147], v[24:27]
    ds_read_b128 a[108:111], v175 offset:16384
    v_mfma_f32_16x16x32_bf16 v[40:43], a[168:171], v[144:147], v[40:43]
    v_exp_f32 v141, v141
    v_mfma_f32_16x16x32_bf16 v[56:59], a[172:175], v[144:147], v[56:59]
    ds_read_b128 a[112:115], v172 offset:24576
    v_cvt_pk_bf16_f32 v150, v140, v141
    v_mfma_f32_16x16x32_bf16 v[72:75], a[176:179], v[144:147], v[72:75]
    v_exp_f32 v142, v142
    v_mfma_f32_16x16x32_bf16 v[88:91], a[180:183], v[144:147], v[88:91]
    ds_read_b128 a[116:119], v173 offset:24576
    v_mfma_f32_16x16x32_bf16 v[104:107], a[184:187], v[144:147], v[104:107]
    v_exp_f32 v143, v143
    v_mfma_f32_16x16x32_bf16 v[120:123], a[188:191], v[144:147], v[120:123]
    v_cvt_pk_bf16_f32 v151, v142, v143
    v_mfma_f32_16x16x32_bf16 v[208:211], v[216:219], v[144:147], v[208:211]
    buffer_load_dwordx4 v196, s[12:15], s27 offen nt lds
    v_mfma_f32_16x16x32_bf16 v[136:139], a[64:67], a[16:19], v[156:159]
    v_exp_f32 v128, v128
    v_mfma_f32_16x16x32_bf16 v[136:139], a[68:71], a[20:23], v[136:139]
    ds_read_b128 a[120:123], v174 offset:24576
    v_mfma_f32_16x16x32_bf16 v[136:139], a[72:75], a[24:27], v[136:139]
    v_exp_f32 v129, v129
    v_mfma_f32_16x16x32_bf16 v[136:139], a[76:79], a[28:31], v[136:139]
    v_cvt_pk_bf16_f32 v144, v128, v129
    v_mfma_f32_16x16x32_bf16 v[140:143], a[80:83], a[16:19], v[156:159]
    v_exp_f32 v130, v130
    v_mfma_f32_16x16x32_bf16 v[140:143], a[84:87], a[20:23], v[140:143]
    ds_read_b128 a[124:127], v175 offset:24576
    v_mfma_f32_16x16x32_bf16 v[140:143], a[88:91], a[24:27], v[140:143]
    v_exp_f32 v131, v131
    v_mfma_f32_16x16x32_bf16 v[140:143], a[92:95], a[28:31], v[140:143]
    v_cvt_pk_bf16_f32 v145, v130, v131
    v_mfma_f32_16x16x32_bf16 v[12:15], a[160:163], v[148:151], v[12:15]
    v_exp_f32 v132, v132
    v_mfma_f32_16x16x32_bf16 v[28:31], a[164:167], v[148:151], v[28:31]
    ds_read_b64_tr_b16 a[160:161], v180 offset:16384
    v_mfma_f32_16x16x32_bf16 v[44:47], a[168:171], v[148:151], v[44:47]
    v_exp_f32 v133, v133
    v_mfma_f32_16x16x32_bf16 v[60:63], a[172:175], v[148:151], v[60:63]
    ds_read_b64_tr_b16 a[162:163], v180 offset:24576
    v_cvt_pk_bf16_f32 v146, v132, v133
    v_mfma_f32_16x16x32_bf16 v[76:79], a[176:179], v[148:151], v[76:79]
    v_exp_f32 v134, v134
    v_mfma_f32_16x16x32_bf16 v[92:95], a[180:183], v[148:151], v[92:95]
    ds_read_b64_tr_b16 a[164:165], v181 offset:16384
    v_mfma_f32_16x16x32_bf16 v[108:111], a[184:187], v[148:151], v[108:111]
    v_exp_f32 v135, v135
    v_mfma_f32_16x16x32_bf16 v[124:127], a[188:191], v[148:151], v[124:127]
    ds_read_b64_tr_b16 a[166:167], v181 offset:24576
    v_cvt_pk_bf16_f32 v147, v134, v135
    v_mfma_f32_16x16x32_bf16 v[212:215], v[216:219], v[148:151], v[212:215]
    buffer_load_dwordx4 v197, s[12:15], s27 offen offset:1024 nt lds
    v_mfma_f32_16x16x32_bf16 v[128:131], a[64:67], a[32:35], v[160:163]
    v_exp_f32 v136, v136
    v_mfma_f32_16x16x32_bf16 v[128:131], a[68:71], a[36:39], v[128:131]
    ds_read_b64_tr_b16 a[168:169], v182 offset:16384
    v_mfma_f32_16x16x32_bf16 v[128:131], a[72:75], a[40:43], v[128:131]
    v_exp_f32 v137, v137
    v_mfma_f32_16x16x32_bf16 v[128:131], a[76:79], a[44:47], v[128:131]
    ds_read_b64_tr_b16 a[170:171], v182 offset:24576
    v_cvt_pk_bf16_f32 v148, v136, v137
    v_mfma_f32_16x16x32_bf16 v[132:135], a[80:83], a[32:35], v[160:163]
    v_exp_f32 v138, v138
    v_mfma_f32_16x16x32_bf16 v[132:135], a[84:87], a[36:39], v[132:135]
    ds_read_b64_tr_b16 a[172:173], v183 offset:16384
    v_mfma_f32_16x16x32_bf16 v[132:135], a[88:91], a[40:43], v[132:135]
    v_exp_f32 v139, v139
    v_mfma_f32_16x16x32_bf16 v[132:135], a[92:95], a[44:47], v[132:135]
    v_cvt_pk_bf16_f32 v149, v138, v139
    v_mfma_f32_16x16x32_bf16 v[0:3], a[128:131], v[144:147], v[0:3]
    v_exp_f32 v140, v140
    v_mfma_f32_16x16x32_bf16 v[16:19], a[132:135], v[144:147], v[16:19]
    ds_read_b64_tr_b16 a[174:175], v183 offset:24576
    v_mfma_f32_16x16x32_bf16 v[32:35], a[136:139], v[144:147], v[32:35]
    v_exp_f32 v141, v141
    v_mfma_f32_16x16x32_bf16 v[48:51], a[140:143], v[144:147], v[48:51]
    ds_read_b64_tr_b16 a[176:177], v184 offset:16384
    v_cvt_pk_bf16_f32 v150, v140, v141
    v_mfma_f32_16x16x32_bf16 v[64:67], a[144:147], v[144:147], v[64:67]
    v_exp_f32 v142, v142
    v_mfma_f32_16x16x32_bf16 v[80:83], a[148:151], v[144:147], v[80:83]
    ds_read_b64_tr_b16 a[178:179], v184 offset:24576
    v_mfma_f32_16x16x32_bf16 v[96:99], a[152:155], v[144:147], v[96:99]
    v_exp_f32 v143, v143
    v_mfma_f32_16x16x32_bf16 v[112:115], a[156:159], v[144:147], v[112:115]
    v_cvt_pk_bf16_f32 v151, v142, v143
    v_mfma_f32_16x16x32_bf16 v[200:203], v[216:219], v[144:147], v[200:203]
    buffer_load_dwordx4 v198, s[16:19], s27 offen offset:2048 nt lds
    v_mfma_f32_16x16x32_bf16 v[136:139], a[64:67], a[48:51], v[164:167]
    v_exp_f32 v128, v128
    v_mfma_f32_16x16x32_bf16 v[136:139], a[68:71], a[52:55], v[136:139]
    ds_read_b64_tr_b16 a[180:181], v185 offset:16384
    v_mfma_f32_16x16x32_bf16 v[136:139], a[72:75], a[56:59], v[136:139]
    v_exp_f32 v129, v129
    v_mfma_f32_16x16x32_bf16 v[136:139], a[76:79], a[60:63], v[136:139]
    ds_read_b64_tr_b16 a[182:183], v185 offset:24576
    v_cvt_pk_bf16_f32 v144, v128, v129
    v_mfma_f32_16x16x32_bf16 v[140:143], a[80:83], a[48:51], v[164:167]
    v_exp_f32 v130, v130
    v_mfma_f32_16x16x32_bf16 v[140:143], a[84:87], a[52:55], v[140:143]
    ds_read_b64_tr_b16 a[184:185], v186 offset:16384
    v_mfma_f32_16x16x32_bf16 v[140:143], a[88:91], a[56:59], v[140:143]
    v_exp_f32 v131, v131
    v_mfma_f32_16x16x32_bf16 v[140:143], a[92:95], a[60:63], v[140:143]
    ds_read_b64_tr_b16 a[186:187], v186 offset:24576
    v_cvt_pk_bf16_f32 v145, v130, v131
    v_mfma_f32_16x16x32_bf16 v[4:7], a[128:131], v[148:151], v[4:7]
    v_exp_f32 v132, v132
    v_mfma_f32_16x16x32_bf16 v[20:23], a[132:135], v[148:151], v[20:23]
    ds_read_b64_tr_b16 a[188:189], v187 offset:16384
    v_mfma_f32_16x16x32_bf16 v[36:39], a[136:139], v[148:151], v[36:39]
    v_exp_f32 v133, v133
    v_mfma_f32_16x16x32_bf16 v[52:55], a[140:143], v[148:151], v[52:55]
    ds_read_b64_tr_b16 a[190:191], v187 offset:24576
    v_cvt_pk_bf16_f32 v146, v132, v133
    v_mfma_f32_16x16x32_bf16 v[68:71], a[144:147], v[148:151], v[68:71]
    v_exp_f32 v134, v134
    v_mfma_f32_16x16x32_bf16 v[84:87], a[148:151], v[148:151], v[84:87]
    buffer_load_dwordx4 v199, s[16:19], s27 offen offset:3072 nt lds
    s_add_u32 s27, s27, 8192
    v_mfma_f32_16x16x32_bf16 v[100:103], a[152:155], v[148:151], v[100:103]
    v_exp_f32 v135, v135
    v_mfma_f32_16x16x32_bf16 v[116:119], a[156:159], v[148:151], v[116:119]
    v_cvt_pk_bf16_f32 v147, v134, v135
    v_mfma_f32_16x16x32_bf16 v[204:207], v[216:219], v[148:151], v[204:207]
    s_waitcnt vmcnt(24) lgkmcnt(0)
    s_barrier
    s_add_u32 m0, s35, 16384
    v_mfma_f32_16x16x32_bf16 v[128:131], a[96:99], a[0:3], v[152:155]
    v_exp_f32 v136, v136
    v_mfma_f32_16x16x32_bf16 v[128:131], a[100:103], a[4:7], v[128:131]
    ds_read_b128 a[64:67], v172 offset:32768
    v_mfma_f32_16x16x32_bf16 v[128:131], a[104:107], a[8:11], v[128:131]
    v_exp_f32 v137, v137
    v_mfma_f32_16x16x32_bf16 v[128:131], a[108:111], a[12:15], v[128:131]
    ds_read_b128 a[68:71], v173 offset:32768
    v_cvt_pk_bf16_f32 v148, v136, v137
    v_mfma_f32_16x16x32_bf16 v[132:135], a[112:115], a[0:3], v[152:155]
    v_exp_f32 v138, v138
    v_mfma_f32_16x16x32_bf16 v[132:135], a[116:119], a[4:7], v[132:135]
    ds_read_b128 a[72:75], v174 offset:32768
    v_mfma_f32_16x16x32_bf16 v[132:135], a[120:123], a[8:11], v[132:135]
    v_exp_f32 v139, v139
    v_mfma_f32_16x16x32_bf16 v[132:135], a[124:127], a[12:15], v[132:135]
    v_cvt_pk_bf16_f32 v149, v138, v139
    v_mfma_f32_16x16x32_bf16 v[8:11], a[128:131], v[144:147], v[8:11]
    v_exp_f32 v140, v140
    v_mfma_f32_16x16x32_bf16 v[24:27], a[132:135], v[144:147], v[24:27]
    ds_read_b128 a[76:79], v175 offset:32768
    v_mfma_f32_16x16x32_bf16 v[40:43], a[136:139], v[144:147], v[40:43]
    v_exp_f32 v141, v141
    v_mfma_f32_16x16x32_bf16 v[56:59], a[140:143], v[144:147], v[56:59]
    ds_read_b128 a[80:83], v172 offset:40960
    v_cvt_pk_bf16_f32 v150, v140, v141
    v_mfma_f32_16x16x32_bf16 v[72:75], a[144:147], v[144:147], v[72:75]
    v_exp_f32 v142, v142
    v_mfma_f32_16x16x32_bf16 v[88:91], a[148:151], v[144:147], v[88:91]
    ds_read_b128 a[84:87], v173 offset:40960
    v_mfma_f32_16x16x32_bf16 v[104:107], a[152:155], v[144:147], v[104:107]
    v_exp_f32 v143, v143
    v_mfma_f32_16x16x32_bf16 v[120:123], a[156:159], v[144:147], v[120:123]
    v_cvt_pk_bf16_f32 v151, v142, v143
    v_mfma_f32_16x16x32_bf16 v[208:211], v[216:219], v[144:147], v[208:211]
    buffer_load_dwordx4 v196, s[12:15], s27 offen nt lds
    v_mfma_f32_16x16x32_bf16 v[136:139], a[96:99], a[16:19], v[156:159]
    v_exp_f32 v128, v128
    v_mfma_f32_16x16x32_bf16 v[136:139], a[100:103], a[20:23], v[136:139]
    ds_read_b128 a[88:91], v174 offset:40960
    v_mfma_f32_16x16x32_bf16 v[136:139], a[104:107], a[24:27], v[136:139]
    v_exp_f32 v129, v129
    v_mfma_f32_16x16x32_bf16 v[136:139], a[108:111], a[28:31], v[136:139]
    v_cvt_pk_bf16_f32 v144, v128, v129
    v_mfma_f32_16x16x32_bf16 v[140:143], a[112:115], a[16:19], v[156:159]
    v_exp_f32 v130, v130
    v_mfma_f32_16x16x32_bf16 v[140:143], a[116:119], a[20:23], v[140:143]
    ds_read_b128 a[92:95], v175 offset:40960
    v_mfma_f32_16x16x32_bf16 v[140:143], a[120:123], a[24:27], v[140:143]
    v_exp_f32 v131, v131
    v_mfma_f32_16x16x32_bf16 v[140:143], a[124:127], a[28:31], v[140:143]
    v_cvt_pk_bf16_f32 v145, v130, v131
    v_mfma_f32_16x16x32_bf16 v[12:15], a[128:131], v[148:151], v[12:15]
    v_exp_f32 v132, v132
    v_mfma_f32_16x16x32_bf16 v[28:31], a[132:135], v[148:151], v[28:31]
    ds_read_b64_tr_b16 a[128:129], v180 offset:32768
    v_mfma_f32_16x16x32_bf16 v[44:47], a[136:139], v[148:151], v[44:47]
    v_exp_f32 v133, v133
    v_mfma_f32_16x16x32_bf16 v[60:63], a[140:143], v[148:151], v[60:63]
    ds_read_b64_tr_b16 a[130:131], v180 offset:40960
    v_cvt_pk_bf16_f32 v146, v132, v133
    v_mfma_f32_16x16x32_bf16 v[76:79], a[144:147], v[148:151], v[76:79]
    v_exp_f32 v134, v134
    v_mfma_f32_16x16x32_bf16 v[92:95], a[148:151], v[148:151], v[92:95]
    ds_read_b64_tr_b16 a[132:133], v181 offset:32768
    v_mfma_f32_16x16x32_bf16 v[108:111], a[152:155], v[148:151], v[108:111]
    v_exp_f32 v135, v135
    v_mfma_f32_16x16x32_bf16 v[124:127], a[156:159], v[148:151], v[124:127]
    ds_read_b64_tr_b16 a[134:135], v181 offset:40960
    v_cvt_pk_bf16_f32 v147, v134, v135
    v_mfma_f32_16x16x32_bf16 v[212:215], v[216:219], v[148:151], v[212:215]
    buffer_load_dwordx4 v197, s[12:15], s27 offen offset:1024 nt lds
    v_mfma_f32_16x16x32_bf16 v[128:131], a[96:99], a[32:35], v[160:163]
    v_exp_f32 v136, v136
    v_mfma_f32_16x16x32_bf16 v[128:131], a[100:103], a[36:39], v[128:131]
    ds_read_b64_tr_b16 a[136:137], v182 offset:32768
    v_mfma_f32_16x16x32_bf16 v[128:131], a[104:107], a[40:43], v[128:131]
    v_exp_f32 v137, v137
    v_mfma_f32_16x16x32_bf16 v[128:131], a[108:111], a[44:47], v[128:131]
    ds_read_b64_tr_b16 a[138:139], v182 offset:40960
    v_cvt_pk_bf16_f32 v148, v136, v137
    v_mfma_f32_16x16x32_bf16 v[132:135], a[112:115], a[32:35], v[160:163]
    v_exp_f32 v138, v138
    v_mfma_f32_16x16x32_bf16 v[132:135], a[116:119], a[36:39], v[132:135]
    ds_read_b64_tr_b16 a[140:141], v183 offset:32768
    v_mfma_f32_16x16x32_bf16 v[132:135], a[120:123], a[40:43], v[132:135]
    v_exp_f32 v139, v139
    v_mfma_f32_16x16x32_bf16 v[132:135], a[124:127], a[44:47], v[132:135]
    v_cvt_pk_bf16_f32 v149, v138, v139
    v_mfma_f32_16x16x32_bf16 v[0:3], a[160:163], v[144:147], v[0:3]
    v_exp_f32 v140, v140
    v_mfma_f32_16x16x32_bf16 v[16:19], a[164:167], v[144:147], v[16:19]
    ds_read_b64_tr_b16 a[142:143], v183 offset:40960
    v_mfma_f32_16x16x32_bf16 v[32:35], a[168:171], v[144:147], v[32:35]
    v_exp_f32 v141, v141
    v_mfma_f32_16x16x32_bf16 v[48:51], a[172:175], v[144:147], v[48:51]
    ds_read_b64_tr_b16 a[144:145], v184 offset:32768
    v_cvt_pk_bf16_f32 v150, v140, v141
    v_mfma_f32_16x16x32_bf16 v[64:67], a[176:179], v[144:147], v[64:67]
    v_exp_f32 v142, v142
    v_mfma_f32_16x16x32_bf16 v[80:83], a[180:183], v[144:147], v[80:83]
    ds_read_b64_tr_b16 a[146:147], v184 offset:40960
    v_mfma_f32_16x16x32_bf16 v[96:99], a[184:187], v[144:147], v[96:99]
    v_exp_f32 v143, v143
    v_mfma_f32_16x16x32_bf16 v[112:115], a[188:191], v[144:147], v[112:115]
    v_cvt_pk_bf16_f32 v151, v142, v143
    v_mfma_f32_16x16x32_bf16 v[200:203], v[216:219], v[144:147], v[200:203]
    buffer_load_dwordx4 v198, s[16:19], s27 offen offset:2048 nt lds
    v_mfma_f32_16x16x32_bf16 v[136:139], a[96:99], a[48:51], v[164:167]
    v_exp_f32 v128, v128
    v_mfma_f32_16x16x32_bf16 v[136:139], a[100:103], a[52:55], v[136:139]
    ds_read_b64_tr_b16 a[148:149], v185 offset:32768
    v_mfma_f32_16x16x32_bf16 v[136:139], a[104:107], a[56:59], v[136:139]
    v_exp_f32 v129, v129
    v_mfma_f32_16x16x32_bf16 v[136:139], a[108:111], a[60:63], v[136:139]
    ds_read_b64_tr_b16 a[150:151], v185 offset:40960
    v_cvt_pk_bf16_f32 v144, v128, v129
    v_mfma_f32_16x16x32_bf16 v[140:143], a[112:115], a[48:51], v[164:167]
    v_exp_f32 v130, v130
    v_mfma_f32_16x16x32_bf16 v[140:143], a[116:119], a[52:55], v[140:143]
    ds_read_b64_tr_b16 a[152:153], v186 offset:32768
    v_mfma_f32_16x16x32_bf16 v[140:143], a[120:123], a[56:59], v[140:143]
    v_exp_f32 v131, v131
    v_mfma_f32_16x16x32_bf16 v[140:143], a[124:127], a[60:63], v[140:143]
    ds_read_b64_tr_b16 a[154:155], v186 offset:40960
    v_cvt_pk_bf16_f32 v145, v130, v131
    v_mfma_f32_16x16x32_bf16 v[4:7], a[160:163], v[148:151], v[4:7]
    v_exp_f32 v132, v132
    v_mfma_f32_16x16x32_bf16 v[20:23], a[164:167], v[148:151], v[20:23]
    ds_read_b64_tr_b16 a[156:157], v187 offset:32768
    v_mfma_f32_16x16x32_bf16 v[36:39], a[168:171], v[148:151], v[36:39]
    v_exp_f32 v133, v133
    v_mfma_f32_16x16x32_bf16 v[52:55], a[172:175], v[148:151], v[52:55]
    ds_read_b64_tr_b16 a[158:159], v187 offset:40960
    v_cvt_pk_bf16_f32 v146, v132, v133
    v_mfma_f32_16x16x32_bf16 v[68:71], a[176:179], v[148:151], v[68:71]
    v_exp_f32 v134, v134
    v_mfma_f32_16x16x32_bf16 v[84:87], a[180:183], v[148:151], v[84:87]
    buffer_load_dwordx4 v199, s[16:19], s27 offen offset:3072 nt lds
    s_add_u32 s27, s27, 8192
    v_mfma_f32_16x16x32_bf16 v[100:103], a[184:187], v[148:151], v[100:103]
    v_exp_f32 v135, v135
    v_mfma_f32_16x16x32_bf16 v[116:119], a[188:191], v[148:151], v[116:119]
    v_cvt_pk_bf16_f32 v147, v134, v135
    v_mfma_f32_16x16x32_bf16 v[204:207], v[216:219], v[148:151], v[204:207]
    s_waitcnt vmcnt(24) lgkmcnt(0)
    s_barrier
    s_add_u32 m0, s35, 32768
    v_mfma_f32_16x16x32_bf16 v[128:131], a[64:67], a[0:3], v[152:155]
    v_exp_f32 v136, v136
    v_mfma_f32_16x16x32_bf16 v[128:131], a[68:71], a[4:7], v[128:131]
    ds_read_b128 a[96:99], v172 offset:49152
    v_mfma_f32_16x16x32_bf16 v[128:131], a[72:75], a[8:11], v[128:131]
    v_exp_f32 v137, v137
    v_mfma_f32_16x16x32_bf16 v[128:131], a[76:79], a[12:15], v[128:131]
    ds_read_b128 a[100:103], v173 offset:49152
    v_cvt_pk_bf16_f32 v148, v136, v137
    v_mfma_f32_16x16x32_bf16 v[132:135], a[80:83], a[0:3], v[152:155]
    v_exp_f32 v138, v138
    v_mfma_f32_16x16x32_bf16 v[132:135], a[84:87], a[4:7], v[132:135]
    ds_read_b128 a[104:107], v174 offset:49152
    v_mfma_f32_16x16x32_bf16 v[132:135], a[88:91], a[8:11], v[132:135]
    v_exp_f32 v139, v139
    v_mfma_f32_16x16x32_bf16 v[132:135], a[92:95], a[12:15], v[132:135]
    v_cvt_pk_bf16_f32 v149, v138, v139
    v_mfma_f32_16x16x32_bf16 v[8:11], a[160:163], v[144:147], v[8:11]
    v_exp_f32 v140, v140
    v_mfma_f32_16x16x32_bf16 v[24:27], a[164:167], v[144:147], v[24:27]
    ds_read_b128 a[108:111], v175 offset:49152
    v_mfma_f32_16x16x32_bf16 v[40:43], a[168:171], v[144:147], v[40:43]
    v_exp_f32 v141, v141
    v_mfma_f32_16x16x32_bf16 v[56:59], a[172:175], v[144:147], v[56:59]
    ds_read_b128 a[112:115], v172 offset:57344
    v_cvt_pk_bf16_f32 v150, v140, v141
    v_mfma_f32_16x16x32_bf16 v[72:75], a[176:179], v[144:147], v[72:75]
    v_exp_f32 v142, v142
    v_mfma_f32_16x16x32_bf16 v[88:91], a[180:183], v[144:147], v[88:91]
    ds_read_b128 a[116:119], v173 offset:57344
    v_mfma_f32_16x16x32_bf16 v[104:107], a[184:187], v[144:147], v[104:107]
    v_exp_f32 v143, v143
    v_mfma_f32_16x16x32_bf16 v[120:123], a[188:191], v[144:147], v[120:123]
    v_cvt_pk_bf16_f32 v151, v142, v143
    v_mfma_f32_16x16x32_bf16 v[208:211], v[216:219], v[144:147], v[208:211]
    buffer_load_dwordx4 v196, s[12:15], s27 offen nt lds
    v_mfma_f32_16x16x32_bf16 v[136:139], a[64:67], a[16:19], v[156:159]
    v_exp_f32 v128, v128
    v_mfma_f32_16x16x32_bf16 v[136:139], a[68:71], a[20:23], v[136:139]
    ds_read_b128 a[120:123], v174 offset:57344
    v_mfma_f32_16x16x32_bf16 v[136:139], a[72:75], a[24:27], v[136:139]
    v_exp_f32 v129, v129
    v_mfma_f32_16x16x32_bf16 v[136:139], a[76:79], a[28:31], v[136:139]
    v_cvt_pk_bf16_f32 v144, v128, v129
    v_mfma_f32_16x16x32_bf16 v[140:143], a[80:83], a[16:19], v[156:159]
    v_exp_f32 v130, v130
    v_mfma_f32_16x16x32_bf16 v[140:143], a[84:87], a[20:23], v[140:143]
    ds_read_b128 a[124:127], v175 offset:57344
    v_mfma_f32_16x16x32_bf16 v[140:143], a[88:91], a[24:27], v[140:143]
    v_exp_f32 v131, v131
    v_mfma_f32_16x16x32_bf16 v[140:143], a[92:95], a[28:31], v[140:143]
    v_cvt_pk_bf16_f32 v145, v130, v131
    v_mfma_f32_16x16x32_bf16 v[12:15], a[160:163], v[148:151], v[12:15]
    v_exp_f32 v132, v132
    v_mfma_f32_16x16x32_bf16 v[28:31], a[164:167], v[148:151], v[28:31]
    ds_read_b64_tr_b16 a[160:161], v180 offset:49152
    v_mfma_f32_16x16x32_bf16 v[44:47], a[168:171], v[148:151], v[44:47]
    v_exp_f32 v133, v133
    v_mfma_f32_16x16x32_bf16 v[60:63], a[172:175], v[148:151], v[60:63]
    ds_read_b64_tr_b16 a[162:163], v180 offset:57344
    v_cvt_pk_bf16_f32 v146, v132, v133
    v_mfma_f32_16x16x32_bf16 v[76:79], a[176:179], v[148:151], v[76:79]
    v_exp_f32 v134, v134
    v_mfma_f32_16x16x32_bf16 v[92:95], a[180:183], v[148:151], v[92:95]
    ds_read_b64_tr_b16 a[164:165], v181 offset:49152
    v_mfma_f32_16x16x32_bf16 v[108:111], a[184:187], v[148:151], v[108:111]
    v_exp_f32 v135, v135
    v_mfma_f32_16x16x32_bf16 v[124:127], a[188:191], v[148:151], v[124:127]
    ds_read_b64_tr_b16 a[166:167], v181 offset:57344
    v_cvt_pk_bf16_f32 v147, v134, v135
    v_mfma_f32_16x16x32_bf16 v[212:215], v[216:219], v[148:151], v[212:215]
    buffer_load_dwordx4 v197, s[12:15], s27 offen offset:1024 nt lds
    v_mfma_f32_16x16x32_bf16 v[128:131], a[64:67], a[32:35], v[160:163]
    v_exp_f32 v136, v136
    v_mfma_f32_16x16x32_bf16 v[128:131], a[68:71], a[36:39], v[128:131]
    ds_read_b64_tr_b16 a[168:169], v182 offset:49152
    v_mfma_f32_16x16x32_bf16 v[128:131], a[72:75], a[40:43], v[128:131]
    v_exp_f32 v137, v137
    v_mfma_f32_16x16x32_bf16 v[128:131], a[76:79], a[44:47], v[128:131]
    ds_read_b64_tr_b16 a[170:171], v182 offset:57344
    v_cvt_pk_bf16_f32 v148, v136, v137
    v_mfma_f32_16x16x32_bf16 v[132:135], a[80:83], a[32:35], v[160:163]
    v_exp_f32 v138, v138
    v_mfma_f32_16x16x32_bf16 v[132:135], a[84:87], a[36:39], v[132:135]
    ds_read_b64_tr_b16 a[172:173], v183 offset:49152
    v_mfma_f32_16x16x32_bf16 v[132:135], a[88:91], a[40:43], v[132:135]
    v_exp_f32 v139, v139
    v_mfma_f32_16x16x32_bf16 v[132:135], a[92:95], a[44:47], v[132:135]
    v_cvt_pk_bf16_f32 v149, v138, v139
    v_mfma_f32_16x16x32_bf16 v[0:3], a[128:131], v[144:147], v[0:3]
    v_exp_f32 v140, v140
    v_mfma_f32_16x16x32_bf16 v[16:19], a[132:135], v[144:147], v[16:19]
    ds_read_b64_tr_b16 a[174:175], v183 offset:57344
    v_mfma_f32_16x16x32_bf16 v[32:35], a[136:139], v[144:147], v[32:35]
    v_exp_f32 v141, v141
    v_mfma_f32_16x16x32_bf16 v[48:51], a[140:143], v[144:147], v[48:51]
    ds_read_b64_tr_b16 a[176:177], v184 offset:49152
    v_cvt_pk_bf16_f32 v150, v140, v141
    v_mfma_f32_16x16x32_bf16 v[64:67], a[144:147], v[144:147], v[64:67]
    v_exp_f32 v142, v142
    v_mfma_f32_16x16x32_bf16 v[80:83], a[148:151], v[144:147], v[80:83]
    ds_read_b64_tr_b16 a[178:179], v184 offset:57344
    v_mfma_f32_16x16x32_bf16 v[96:99], a[152:155], v[144:147], v[96:99]
    v_exp_f32 v143, v143
    v_mfma_f32_16x16x32_bf16 v[112:115], a[156:159], v[144:147], v[112:115]
    v_cvt_pk_bf16_f32 v151, v142, v143
    v_mfma_f32_16x16x32_bf16 v[200:203], v[216:219], v[144:147], v[200:203]
    buffer_load_dwordx4 v198, s[16:19], s27 offen offset:2048 nt lds
    v_mfma_f32_16x16x32_bf16 v[136:139], a[64:67], a[48:51], v[164:167]
    v_exp_f32 v128, v128
    v_mfma_f32_16x16x32_bf16 v[136:139], a[68:71], a[52:55], v[136:139]
    ds_read_b64_tr_b16 a[180:181], v185 offset:49152
    v_mfma_f32_16x16x32_bf16 v[136:139], a[72:75], a[56:59], v[136:139]
    v_exp_f32 v129, v129
    v_mfma_f32_16x16x32_bf16 v[136:139], a[76:79], a[60:63], v[136:139]
    ds_read_b64_tr_b16 a[182:183], v185 offset:57344
    v_cvt_pk_bf16_f32 v144, v128, v129
    v_mfma_f32_16x16x32_bf16 v[140:143], a[80:83], a[48:51], v[164:167]
    v_exp_f32 v130, v130
    v_mfma_f32_16x16x32_bf16 v[140:143], a[84:87], a[52:55], v[140:143]
    ds_read_b64_tr_b16 a[184:185], v186 offset:49152
    v_mfma_f32_16x16x32_bf16 v[140:143], a[88:91], a[56:59], v[140:143]
    v_exp_f32 v131, v131
    v_mfma_f32_16x16x32_bf16 v[140:143], a[92:95], a[60:63], v[140:143]
    ds_read_b64_tr_b16 a[186:187], v186 offset:57344
    v_cvt_pk_bf16_f32 v145, v130, v131
    v_mfma_f32_16x16x32_bf16 v[4:7], a[128:131], v[148:151], v[4:7]
    v_exp_f32 v132, v132
    v_mfma_f32_16x16x32_bf16 v[20:23], a[132:135], v[148:151], v[20:23]
    ds_read_b64_tr_b16 a[188:189], v187 offset:49152
    v_mfma_f32_16x16x32_bf16 v[36:39], a[136:139], v[148:151], v[36:39]
    v_exp_f32 v133, v133
    v_mfma_f32_16x16x32_bf16 v[52:55], a[140:143], v[148:151], v[52:55]
    ds_read_b64_tr_b16 a[190:191], v187 offset:57344
    v_cvt_pk_bf16_f32 v146, v132, v133
    v_mfma_f32_16x16x32_bf16 v[68:71], a[144:147], v[148:151], v[68:71]
    v_exp_f32 v134, v134
    v_mfma_f32_16x16x32_bf16 v[84:87], a[148:151], v[148:151], v[84:87]
    buffer_load_dwordx4 v199, s[16:19], s27 offen offset:3072 nt lds
    s_add_u32 s27, s27, 8192
    v_mfma_f32_16x16x32_bf16 v[100:103], a[152:155], v[148:151], v[100:103]
    v_exp_f32 v135, v135
    v_mfma_f32_16x16x32_bf16 v[116:119], a[156:159], v[148:151], v[116:119]
    v_cvt_pk_bf16_f32 v147, v134, v135
    v_mfma_f32_16x16x32_bf16 v[204:207], v[216:219], v[148:151], v[204:207]
    s_waitcnt vmcnt(24) lgkmcnt(0)
    s_barrier
    s_add_u32 m0, s35, 49152
    v_mfma_f32_16x16x32_bf16 v[128:131], a[96:99], a[0:3], v[152:155]
    v_exp_f32 v136, v136
    v_mfma_f32_16x16x32_bf16 v[128:131], a[100:103], a[4:7], v[128:131]
    ds_read_b128 a[64:67], v176 offset:0
    v_mfma_f32_16x16x32_bf16 v[128:131], a[104:107], a[8:11], v[128:131]
    v_exp_f32 v137, v137
    v_mfma_f32_16x16x32_bf16 v[128:131], a[108:111], a[12:15], v[128:131]
    ds_read_b128 a[68:71], v177 offset:0
    v_cvt_pk_bf16_f32 v148, v136, v137
    v_mfma_f32_16x16x32_bf16 v[132:135], a[112:115], a[0:3], v[152:155]
    v_exp_f32 v138, v138
    v_mfma_f32_16x16x32_bf16 v[132:135], a[116:119], a[4:7], v[132:135]
    ds_read_b128 a[72:75], v178 offset:0
    v_mfma_f32_16x16x32_bf16 v[132:135], a[120:123], a[8:11], v[132:135]
    v_exp_f32 v139, v139
    v_mfma_f32_16x16x32_bf16 v[132:135], a[124:127], a[12:15], v[132:135]
    v_cvt_pk_bf16_f32 v149, v138, v139
    v_mfma_f32_16x16x32_bf16 v[8:11], a[128:131], v[144:147], v[8:11]
    v_exp_f32 v140, v140
    v_mfma_f32_16x16x32_bf16 v[24:27], a[132:135], v[144:147], v[24:27]
    ds_read_b128 a[76:79], v179 offset:0
    v_mfma_f32_16x16x32_bf16 v[40:43], a[136:139], v[144:147], v[40:43]
    v_exp_f32 v141, v141
    v_mfma_f32_16x16x32_bf16 v[56:59], a[140:143], v[144:147], v[56:59]
    ds_read_b128 a[80:83], v176 offset:8192
    v_cvt_pk_bf16_f32 v150, v140, v141
    v_mfma_f32_16x16x32_bf16 v[72:75], a[144:147], v[144:147], v[72:75]
    v_exp_f32 v142, v142
    v_mfma_f32_16x16x32_bf16 v[88:91], a[148:151], v[144:147], v[88:91]
    ds_read_b128 a[84:87], v177 offset:8192
    v_mfma_f32_16x16x32_bf16 v[104:107], a[152:155], v[144:147], v[104:107]
    v_exp_f32 v143, v143
    v_mfma_f32_16x16x32_bf16 v[120:123], a[156:159], v[144:147], v[120:123]
    v_cvt_pk_bf16_f32 v151, v142, v143
    v_mfma_f32_16x16x32_bf16 v[208:211], v[216:219], v[144:147], v[208:211]
    buffer_load_dwordx4 v196, s[12:15], s27 offen nt lds
    v_mfma_f32_16x16x32_bf16 v[136:139], a[96:99], a[16:19], v[156:159]
    v_exp_f32 v128, v128
    v_mfma_f32_16x16x32_bf16 v[136:139], a[100:103], a[20:23], v[136:139]
    ds_read_b128 a[88:91], v178 offset:8192
    v_mfma_f32_16x16x32_bf16 v[136:139], a[104:107], a[24:27], v[136:139]
    v_exp_f32 v129, v129
    v_mfma_f32_16x16x32_bf16 v[136:139], a[108:111], a[28:31], v[136:139]
    v_cvt_pk_bf16_f32 v144, v128, v129
    v_mfma_f32_16x16x32_bf16 v[140:143], a[112:115], a[16:19], v[156:159]
    v_exp_f32 v130, v130
    v_mfma_f32_16x16x32_bf16 v[140:143], a[116:119], a[20:23], v[140:143]
    ds_read_b128 a[92:95], v179 offset:8192
    v_mfma_f32_16x16x32_bf16 v[140:143], a[120:123], a[24:27], v[140:143]
    v_exp_f32 v131, v131
    v_mfma_f32_16x16x32_bf16 v[140:143], a[124:127], a[28:31], v[140:143]
    v_cvt_pk_bf16_f32 v145, v130, v131
    v_mfma_f32_16x16x32_bf16 v[12:15], a[128:131], v[148:151], v[12:15]
    v_exp_f32 v132, v132
    v_mfma_f32_16x16x32_bf16 v[28:31], a[132:135], v[148:151], v[28:31]
    ds_read_b64_tr_b16 a[128:129], v188 offset:0
    v_mfma_f32_16x16x32_bf16 v[44:47], a[136:139], v[148:151], v[44:47]
    v_exp_f32 v133, v133
    v_mfma_f32_16x16x32_bf16 v[60:63], a[140:143], v[148:151], v[60:63]
    ds_read_b64_tr_b16 a[130:131], v188 offset:8192
    v_cvt_pk_bf16_f32 v146, v132, v133
    v_mfma_f32_16x16x32_bf16 v[76:79], a[144:147], v[148:151], v[76:79]
    v_exp_f32 v134, v134
    v_mfma_f32_16x16x32_bf16 v[92:95], a[148:151], v[148:151], v[92:95]
    ds_read_b64_tr_b16 a[132:133], v189 offset:0
    v_mfma_f32_16x16x32_bf16 v[108:111], a[152:155], v[148:151], v[108:111]
    v_exp_f32 v135, v135
    v_mfma_f32_16x16x32_bf16 v[124:127], a[156:159], v[148:151], v[124:127]
    ds_read_b64_tr_b16 a[134:135], v189 offset:8192
    v_cvt_pk_bf16_f32 v147, v134, v135
    v_mfma_f32_16x16x32_bf16 v[212:215], v[216:219], v[148:151], v[212:215]
    buffer_load_dwordx4 v197, s[12:15], s27 offen offset:1024 nt lds
    v_mfma_f32_16x16x32_bf16 v[128:131], a[96:99], a[32:35], v[160:163]
    v_exp_f32 v136, v136
    v_mfma_f32_16x16x32_bf16 v[128:131], a[100:103], a[36:39], v[128:131]
    ds_read_b64_tr_b16 a[136:137], v190 offset:0
    v_mfma_f32_16x16x32_bf16 v[128:131], a[104:107], a[40:43], v[128:131]
    v_exp_f32 v137, v137
    v_mfma_f32_16x16x32_bf16 v[128:131], a[108:111], a[44:47], v[128:131]
    ds_read_b64_tr_b16 a[138:139], v190 offset:8192
    v_cvt_pk_bf16_f32 v148, v136, v137
    v_mfma_f32_16x16x32_bf16 v[132:135], a[112:115], a[32:35], v[160:163]
    v_exp_f32 v138, v138
    v_mfma_f32_16x16x32_bf16 v[132:135], a[116:119], a[36:39], v[132:135]
    ds_read_b64_tr_b16 a[140:141], v191 offset:0
    v_mfma_f32_16x16x32_bf16 v[132:135], a[120:123], a[40:43], v[132:135]
    v_exp_f32 v139, v139
    v_mfma_f32_16x16x32_bf16 v[132:135], a[124:127], a[44:47], v[132:135]
    v_cvt_pk_bf16_f32 v149, v138, v139
    v_mfma_f32_16x16x32_bf16 v[0:3], a[160:163], v[144:147], v[0:3]
    v_exp_f32 v140, v140
    v_mfma_f32_16x16x32_bf16 v[16:19], a[164:167], v[144:147], v[16:19]
    ds_read_b64_tr_b16 a[142:143], v191 offset:8192
    v_mfma_f32_16x16x32_bf16 v[32:35], a[168:171], v[144:147], v[32:35]
    v_exp_f32 v141, v141
    v_mfma_f32_16x16x32_bf16 v[48:51], a[172:175], v[144:147], v[48:51]
    ds_read_b64_tr_b16 a[144:145], v192 offset:0
    v_cvt_pk_bf16_f32 v150, v140, v141
    v_mfma_f32_16x16x32_bf16 v[64:67], a[176:179], v[144:147], v[64:67]
    v_exp_f32 v142, v142
    v_mfma_f32_16x16x32_bf16 v[80:83], a[180:183], v[144:147], v[80:83]
    ds_read_b64_tr_b16 a[146:147], v192 offset:8192
    v_mfma_f32_16x16x32_bf16 v[96:99], a[184:187], v[144:147], v[96:99]
    v_exp_f32 v143, v143
    v_mfma_f32_16x16x32_bf16 v[112:115], a[188:191], v[144:147], v[112:115]
    v_cvt_pk_bf16_f32 v151, v142, v143
    v_mfma_f32_16x16x32_bf16 v[200:203], v[216:219], v[144:147], v[200:203]
    buffer_load_dwordx4 v198, s[16:19], s27 offen offset:2048 nt lds
    v_mfma_f32_16x16x32_bf16 v[136:139], a[96:99], a[48:51], v[164:167]
    v_exp_f32 v128, v128
    v_mfma_f32_16x16x32_bf16 v[136:139], a[100:103], a[52:55], v[136:139]
    ds_read_b64_tr_b16 a[148:149], v193 offset:0
    v_mfma_f32_16x16x32_bf16 v[136:139], a[104:107], a[56:59], v[136:139]
    v_exp_f32 v129, v129
    v_mfma_f32_16x16x32_bf16 v[136:139], a[108:111], a[60:63], v[136:139]
    ds_read_b64_tr_b16 a[150:151], v193 offset:8192
    v_cvt_pk_bf16_f32 v144, v128, v129
    v_mfma_f32_16x16x32_bf16 v[140:143], a[112:115], a[48:51], v[164:167]
    v_exp_f32 v130, v130
    v_mfma_f32_16x16x32_bf16 v[140:143], a[116:119], a[52:55], v[140:143]
    ds_read_b64_tr_b16 a[152:153], v194 offset:0
    v_mfma_f32_16x16x32_bf16 v[140:143], a[120:123], a[56:59], v[140:143]
    v_exp_f32 v131, v131
    v_mfma_f32_16x16x32_bf16 v[140:143], a[124:127], a[60:63], v[140:143]
    ds_read_b64_tr_b16 a[154:155], v194 offset:8192
    v_cvt_pk_bf16_f32 v145, v130, v131
    v_mfma_f32_16x16x32_bf16 v[4:7], a[160:163], v[148:151], v[4:7]
    v_exp_f32 v132, v132
    v_mfma_f32_16x16x32_bf16 v[20:23], a[164:167], v[148:151], v[20:23]
    ds_read_b64_tr_b16 a[156:157], v195 offset:0
    v_mfma_f32_16x16x32_bf16 v[36:39], a[168:171], v[148:151], v[36:39]
    v_exp_f32 v133, v133
    v_mfma_f32_16x16x32_bf16 v[52:55], a[172:175], v[148:151], v[52:55]
    ds_read_b64_tr_b16 a[158:159], v195 offset:8192
    v_cvt_pk_bf16_f32 v146, v132, v133
    v_mfma_f32_16x16x32_bf16 v[68:71], a[176:179], v[148:151], v[68:71]
    v_exp_f32 v134, v134
    v_mfma_f32_16x16x32_bf16 v[84:87], a[180:183], v[148:151], v[84:87]
    buffer_load_dwordx4 v199, s[16:19], s27 offen offset:3072 nt lds
    s_add_u32 s27, s27, 8192
    v_mfma_f32_16x16x32_bf16 v[100:103], a[184:187], v[148:151], v[100:103]
    v_exp_f32 v135, v135
    v_mfma_f32_16x16x32_bf16 v[116:119], a[188:191], v[148:151], v[116:119]
    v_cvt_pk_bf16_f32 v147, v134, v135
    v_mfma_f32_16x16x32_bf16 v[204:207], v[216:219], v[148:151], v[204:207]
    s_waitcnt vmcnt(24) lgkmcnt(0)
    s_barrier
    s_add_u32 m0, s35, 65536
    v_mfma_f32_16x16x32_bf16 v[128:131], a[64:67], a[0:3], v[152:155]
    v_exp_f32 v136, v136
    v_mfma_f32_16x16x32_bf16 v[128:131], a[68:71], a[4:7], v[128:131]
    ds_read_b128 a[96:99], v176 offset:16384
    v_mfma_f32_16x16x32_bf16 v[128:131], a[72:75], a[8:11], v[128:131]
    v_exp_f32 v137, v137
    v_mfma_f32_16x16x32_bf16 v[128:131], a[76:79], a[12:15], v[128:131]
    ds_read_b128 a[100:103], v177 offset:16384
    v_cvt_pk_bf16_f32 v148, v136, v137
    v_mfma_f32_16x16x32_bf16 v[132:135], a[80:83], a[0:3], v[152:155]
    v_exp_f32 v138, v138
    v_mfma_f32_16x16x32_bf16 v[132:135], a[84:87], a[4:7], v[132:135]
    ds_read_b128 a[104:107], v178 offset:16384
    v_mfma_f32_16x16x32_bf16 v[132:135], a[88:91], a[8:11], v[132:135]
    v_exp_f32 v139, v139
    v_mfma_f32_16x16x32_bf16 v[132:135], a[92:95], a[12:15], v[132:135]
    v_cvt_pk_bf16_f32 v149, v138, v139
    v_mfma_f32_16x16x32_bf16 v[8:11], a[160:163], v[144:147], v[8:11]
    v_exp_f32 v140, v140
    v_mfma_f32_16x16x32_bf16 v[24:27], a[164:167], v[144:147], v[24:27]
    ds_read_b128 a[108:111], v179 offset:16384
    v_mfma_f32_16x16x32_bf16 v[40:43], a[168:171], v[144:147], v[40:43]
    v_exp_f32 v141, v141
    v_mfma_f32_16x16x32_bf16 v[56:59], a[172:175], v[144:147], v[56:59]
    ds_read_b128 a[112:115], v176 offset:24576
    v_cvt_pk_bf16_f32 v150, v140, v141
    v_mfma_f32_16x16x32_bf16 v[72:75], a[176:179], v[144:147], v[72:75]
    v_exp_f32 v142, v142
    v_mfma_f32_16x16x32_bf16 v[88:91], a[180:183], v[144:147], v[88:91]
    ds_read_b128 a[116:119], v177 offset:24576
    v_mfma_f32_16x16x32_bf16 v[104:107], a[184:187], v[144:147], v[104:107]
    v_exp_f32 v143, v143
    v_mfma_f32_16x16x32_bf16 v[120:123], a[188:191], v[144:147], v[120:123]
    v_cvt_pk_bf16_f32 v151, v142, v143
    v_mfma_f32_16x16x32_bf16 v[208:211], v[216:219], v[144:147], v[208:211]
    buffer_load_dwordx4 v196, s[12:15], s27 offen nt lds
    v_mfma_f32_16x16x32_bf16 v[136:139], a[64:67], a[16:19], v[156:159]
    v_exp_f32 v128, v128
    v_mfma_f32_16x16x32_bf16 v[136:139], a[68:71], a[20:23], v[136:139]
    ds_read_b128 a[120:123], v178 offset:24576
    v_mfma_f32_16x16x32_bf16 v[136:139], a[72:75], a[24:27], v[136:139]
    v_exp_f32 v129, v129
    v_mfma_f32_16x16x32_bf16 v[136:139], a[76:79], a[28:31], v[136:139]
    v_cvt_pk_bf16_f32 v144, v128, v129
    v_mfma_f32_16x16x32_bf16 v[140:143], a[80:83], a[16:19], v[156:159]
    v_exp_f32 v130, v130
    v_mfma_f32_16x16x32_bf16 v[140:143], a[84:87], a[20:23], v[140:143]
    ds_read_b128 a[124:127], v179 offset:24576
    v_mfma_f32_16x16x32_bf16 v[140:143], a[88:91], a[24:27], v[140:143]
    v_exp_f32 v131, v131
    v_mfma_f32_16x16x32_bf16 v[140:143], a[92:95], a[28:31], v[140:143]
    v_cvt_pk_bf16_f32 v145, v130, v131
    v_mfma_f32_16x16x32_bf16 v[12:15], a[160:163], v[148:151], v[12:15]
    v_exp_f32 v132, v132
    v_mfma_f32_16x16x32_bf16 v[28:31], a[164:167], v[148:151], v[28:31]
    ds_read_b64_tr_b16 a[160:161], v188 offset:16384
    v_mfma_f32_16x16x32_bf16 v[44:47], a[168:171], v[148:151], v[44:47]
    v_exp_f32 v133, v133
    v_mfma_f32_16x16x32_bf16 v[60:63], a[172:175], v[148:151], v[60:63]
    ds_read_b64_tr_b16 a[162:163], v188 offset:24576
    v_cvt_pk_bf16_f32 v146, v132, v133
    v_mfma_f32_16x16x32_bf16 v[76:79], a[176:179], v[148:151], v[76:79]
    v_exp_f32 v134, v134
    v_mfma_f32_16x16x32_bf16 v[92:95], a[180:183], v[148:151], v[92:95]
    ds_read_b64_tr_b16 a[164:165], v189 offset:16384
    v_mfma_f32_16x16x32_bf16 v[108:111], a[184:187], v[148:151], v[108:111]
    v_exp_f32 v135, v135
    v_mfma_f32_16x16x32_bf16 v[124:127], a[188:191], v[148:151], v[124:127]
    ds_read_b64_tr_b16 a[166:167], v189 offset:24576
    v_cvt_pk_bf16_f32 v147, v134, v135
    v_mfma_f32_16x16x32_bf16 v[212:215], v[216:219], v[148:151], v[212:215]
    buffer_load_dwordx4 v197, s[12:15], s27 offen offset:1024 nt lds
    v_mfma_f32_16x16x32_bf16 v[128:131], a[64:67], a[32:35], v[160:163]
    v_exp_f32 v136, v136
    v_mfma_f32_16x16x32_bf16 v[128:131], a[68:71], a[36:39], v[128:131]
    ds_read_b64_tr_b16 a[168:169], v190 offset:16384
    v_mfma_f32_16x16x32_bf16 v[128:131], a[72:75], a[40:43], v[128:131]
    v_exp_f32 v137, v137
    v_mfma_f32_16x16x32_bf16 v[128:131], a[76:79], a[44:47], v[128:131]
    ds_read_b64_tr_b16 a[170:171], v190 offset:24576
    v_cvt_pk_bf16_f32 v148, v136, v137
    v_mfma_f32_16x16x32_bf16 v[132:135], a[80:83], a[32:35], v[160:163]
    v_exp_f32 v138, v138
    v_mfma_f32_16x16x32_bf16 v[132:135], a[84:87], a[36:39], v[132:135]
    ds_read_b64_tr_b16 a[172:173], v191 offset:16384
    v_mfma_f32_16x16x32_bf16 v[132:135], a[88:91], a[40:43], v[132:135]
    v_exp_f32 v139, v139
    v_mfma_f32_16x16x32_bf16 v[132:135], a[92:95], a[44:47], v[132:135]
    v_cvt_pk_bf16_f32 v149, v138, v139
    v_mfma_f32_16x16x32_bf16 v[0:3], a[128:131], v[144:147], v[0:3]
    v_exp_f32 v140, v140
    v_mfma_f32_16x16x32_bf16 v[16:19], a[132:135], v[144:147], v[16:19]
    ds_read_b64_tr_b16 a[174:175], v191 offset:24576
    v_mfma_f32_16x16x32_bf16 v[32:35], a[136:139], v[144:147], v[32:35]
    v_exp_f32 v141, v141
    v_mfma_f32_16x16x32_bf16 v[48:51], a[140:143], v[144:147], v[48:51]
    ds_read_b64_tr_b16 a[176:177], v192 offset:16384
    v_cvt_pk_bf16_f32 v150, v140, v141
    v_mfma_f32_16x16x32_bf16 v[64:67], a[144:147], v[144:147], v[64:67]
    v_exp_f32 v142, v142
    v_mfma_f32_16x16x32_bf16 v[80:83], a[148:151], v[144:147], v[80:83]
    ds_read_b64_tr_b16 a[178:179], v192 offset:24576
    v_mfma_f32_16x16x32_bf16 v[96:99], a[152:155], v[144:147], v[96:99]
    v_exp_f32 v143, v143
    v_mfma_f32_16x16x32_bf16 v[112:115], a[156:159], v[144:147], v[112:115]
    v_cvt_pk_bf16_f32 v151, v142, v143
    v_mfma_f32_16x16x32_bf16 v[200:203], v[216:219], v[144:147], v[200:203]
    buffer_load_dwordx4 v198, s[16:19], s27 offen offset:2048 nt lds
    v_mfma_f32_16x16x32_bf16 v[136:139], a[64:67], a[48:51], v[164:167]
    v_exp_f32 v128, v128
    v_mfma_f32_16x16x32_bf16 v[136:139], a[68:71], a[52:55], v[136:139]
    ds_read_b64_tr_b16 a[180:181], v193 offset:16384
    v_mfma_f32_16x16x32_bf16 v[136:139], a[72:75], a[56:59], v[136:139]
    v_exp_f32 v129, v129
    v_mfma_f32_16x16x32_bf16 v[136:139], a[76:79], a[60:63], v[136:139]
    ds_read_b64_tr_b16 a[182:183], v193 offset:24576
    v_cvt_pk_bf16_f32 v144, v128, v129
    v_mfma_f32_16x16x32_bf16 v[140:143], a[80:83], a[48:51], v[164:167]
    v_exp_f32 v130, v130
    v_mfma_f32_16x16x32_bf16 v[140:143], a[84:87], a[52:55], v[140:143]
    ds_read_b64_tr_b16 a[184:185], v194 offset:16384
    v_mfma_f32_16x16x32_bf16 v[140:143], a[88:91], a[56:59], v[140:143]
    v_exp_f32 v131, v131
    v_mfma_f32_16x16x32_bf16 v[140:143], a[92:95], a[60:63], v[140:143]
    ds_read_b64_tr_b16 a[186:187], v194 offset:24576
    v_cvt_pk_bf16_f32 v145, v130, v131
    v_mfma_f32_16x16x32_bf16 v[4:7], a[128:131], v[148:151], v[4:7]
    v_exp_f32 v132, v132
    v_mfma_f32_16x16x32_bf16 v[20:23], a[132:135], v[148:151], v[20:23]
    ds_read_b64_tr_b16 a[188:189], v195 offset:16384
    v_mfma_f32_16x16x32_bf16 v[36:39], a[136:139], v[148:151], v[36:39]
    v_exp_f32 v133, v133
    v_mfma_f32_16x16x32_bf16 v[52:55], a[140:143], v[148:151], v[52:55]
    ds_read_b64_tr_b16 a[190:191], v195 offset:24576
    v_cvt_pk_bf16_f32 v146, v132, v133
    v_mfma_f32_16x16x32_bf16 v[68:71], a[144:147], v[148:151], v[68:71]
    v_exp_f32 v134, v134
    v_mfma_f32_16x16x32_bf16 v[84:87], a[148:151], v[148:151], v[84:87]
    buffer_load_dwordx4 v199, s[16:19], s27 offen offset:3072 nt lds
    s_add_u32 s27, s27, 8192
    v_mfma_f32_16x16x32_bf16 v[100:103], a[152:155], v[148:151], v[100:103]
    v_exp_f32 v135, v135
    v_mfma_f32_16x16x32_bf16 v[116:119], a[156:159], v[148:151], v[116:119]
    v_cvt_pk_bf16_f32 v147, v134, v135
    v_mfma_f32_16x16x32_bf16 v[204:207], v[216:219], v[148:151], v[204:207]
    s_waitcnt vmcnt(24) lgkmcnt(0)
    s_barrier
    s_add_u32 m0, s35, 81920
    v_mfma_f32_16x16x32_bf16 v[128:131], a[96:99], a[0:3], v[152:155]
    v_exp_f32 v136, v136
    v_mfma_f32_16x16x32_bf16 v[128:131], a[100:103], a[4:7], v[128:131]
    ds_read_b128 a[64:67], v176 offset:32768
    v_mfma_f32_16x16x32_bf16 v[128:131], a[104:107], a[8:11], v[128:131]
    v_exp_f32 v137, v137
    v_mfma_f32_16x16x32_bf16 v[128:131], a[108:111], a[12:15], v[128:131]
    ds_read_b128 a[68:71], v177 offset:32768
    v_cvt_pk_bf16_f32 v148, v136, v137
    v_mfma_f32_16x16x32_bf16 v[132:135], a[112:115], a[0:3], v[152:155]
    v_exp_f32 v138, v138
    v_mfma_f32_16x16x32_bf16 v[132:135], a[116:119], a[4:7], v[132:135]
    ds_read_b128 a[72:75], v178 offset:32768
    v_mfma_f32_16x16x32_bf16 v[132:135], a[120:123], a[8:11], v[132:135]
    v_exp_f32 v139, v139
    v_mfma_f32_16x16x32_bf16 v[132:135], a[124:127], a[12:15], v[132:135]
    v_cvt_pk_bf16_f32 v149, v138, v139
    v_mfma_f32_16x16x32_bf16 v[8:11], a[128:131], v[144:147], v[8:11]
    v_exp_f32 v140, v140
    v_mfma_f32_16x16x32_bf16 v[24:27], a[132:135], v[144:147], v[24:27]
    ds_read_b128 a[76:79], v179 offset:32768
    v_mfma_f32_16x16x32_bf16 v[40:43], a[136:139], v[144:147], v[40:43]
    v_exp_f32 v141, v141
    v_mfma_f32_16x16x32_bf16 v[56:59], a[140:143], v[144:147], v[56:59]
    ds_read_b128 a[80:83], v176 offset:40960
    v_cvt_pk_bf16_f32 v150, v140, v141
    v_mfma_f32_16x16x32_bf16 v[72:75], a[144:147], v[144:147], v[72:75]
    v_exp_f32 v142, v142
    v_mfma_f32_16x16x32_bf16 v[88:91], a[148:151], v[144:147], v[88:91]
    ds_read_b128 a[84:87], v177 offset:40960
    v_mfma_f32_16x16x32_bf16 v[104:107], a[152:155], v[144:147], v[104:107]
    v_exp_f32 v143, v143
    v_mfma_f32_16x16x32_bf16 v[120:123], a[156:159], v[144:147], v[120:123]
    v_cvt_pk_bf16_f32 v151, v142, v143
    v_mfma_f32_16x16x32_bf16 v[208:211], v[216:219], v[144:147], v[208:211]
    buffer_load_dwordx4 v196, s[12:15], s27 offen nt lds
    v_mfma_f32_16x16x32_bf16 v[136:139], a[96:99], a[16:19], v[156:159]
    v_exp_f32 v128, v128
    v_mfma_f32_16x16x32_bf16 v[136:139], a[100:103], a[20:23], v[136:139]
    ds_read_b128 a[88:91], v178 offset:40960
    v_mfma_f32_16x16x32_bf16 v[136:139], a[104:107], a[24:27], v[136:139]
    v_exp_f32 v129, v129
    v_mfma_f32_16x16x32_bf16 v[136:139], a[108:111], a[28:31], v[136:139]
    v_cvt_pk_bf16_f32 v144, v128, v129
    v_mfma_f32_16x16x32_bf16 v[140:143], a[112:115], a[16:19], v[156:159]
    v_exp_f32 v130, v130
    v_mfma_f32_16x16x32_bf16 v[140:143], a[116:119], a[20:23], v[140:143]
    ds_read_b128 a[92:95], v179 offset:40960
    v_mfma_f32_16x16x32_bf16 v[140:143], a[120:123], a[24:27], v[140:143]
    v_exp_f32 v131, v131
    v_mfma_f32_16x16x32_bf16 v[140:143], a[124:127], a[28:31], v[140:143]
    v_cvt_pk_bf16_f32 v145, v130, v131
    v_mfma_f32_16x16x32_bf16 v[12:15], a[128:131], v[148:151], v[12:15]
    v_exp_f32 v132, v132
    v_mfma_f32_16x16x32_bf16 v[28:31], a[132:135], v[148:151], v[28:31]
    ds_read_b64_tr_b16 a[128:129], v188 offset:32768
    v_mfma_f32_16x16x32_bf16 v[44:47], a[136:139], v[148:151], v[44:47]
    v_exp_f32 v133, v133
    v_mfma_f32_16x16x32_bf16 v[60:63], a[140:143], v[148:151], v[60:63]
    ds_read_b64_tr_b16 a[130:131], v188 offset:40960
    v_cvt_pk_bf16_f32 v146, v132, v133
    v_mfma_f32_16x16x32_bf16 v[76:79], a[144:147], v[148:151], v[76:79]
    v_exp_f32 v134, v134
    v_mfma_f32_16x16x32_bf16 v[92:95], a[148:151], v[148:151], v[92:95]
    ds_read_b64_tr_b16 a[132:133], v189 offset:32768
    v_mfma_f32_16x16x32_bf16 v[108:111], a[152:155], v[148:151], v[108:111]
    v_exp_f32 v135, v135
    v_mfma_f32_16x16x32_bf16 v[124:127], a[156:159], v[148:151], v[124:127]
    ds_read_b64_tr_b16 a[134:135], v189 offset:40960
    v_cvt_pk_bf16_f32 v147, v134, v135
    v_mfma_f32_16x16x32_bf16 v[212:215], v[216:219], v[148:151], v[212:215]
    buffer_load_dwordx4 v197, s[12:15], s27 offen offset:1024 nt lds
    v_mfma_f32_16x16x32_bf16 v[128:131], a[96:99], a[32:35], v[160:163]
    v_exp_f32 v136, v136
    v_mfma_f32_16x16x32_bf16 v[128:131], a[100:103], a[36:39], v[128:131]
    ds_read_b64_tr_b16 a[136:137], v190 offset:32768
    v_mfma_f32_16x16x32_bf16 v[128:131], a[104:107], a[40:43], v[128:131]
    v_exp_f32 v137, v137
    v_mfma_f32_16x16x32_bf16 v[128:131], a[108:111], a[44:47], v[128:131]
    ds_read_b64_tr_b16 a[138:139], v190 offset:40960
    v_cvt_pk_bf16_f32 v148, v136, v137
    v_mfma_f32_16x16x32_bf16 v[132:135], a[112:115], a[32:35], v[160:163]
    v_exp_f32 v138, v138
    v_mfma_f32_16x16x32_bf16 v[132:135], a[116:119], a[36:39], v[132:135]
    ds_read_b64_tr_b16 a[140:141], v191 offset:32768
    v_mfma_f32_16x16x32_bf16 v[132:135], a[120:123], a[40:43], v[132:135]
    v_exp_f32 v139, v139
    v_mfma_f32_16x16x32_bf16 v[132:135], a[124:127], a[44:47], v[132:135]
    v_cvt_pk_bf16_f32 v149, v138, v139
    v_mfma_f32_16x16x32_bf16 v[0:3], a[160:163], v[144:147], v[0:3]
    v_exp_f32 v140, v140
    v_mfma_f32_16x16x32_bf16 v[16:19], a[164:167], v[144:147], v[16:19]
    ds_read_b64_tr_b16 a[142:143], v191 offset:40960
    v_mfma_f32_16x16x32_bf16 v[32:35], a[168:171], v[144:147], v[32:35]
    v_exp_f32 v141, v141
    v_mfma_f32_16x16x32_bf16 v[48:51], a[172:175], v[144:147], v[48:51]
    ds_read_b64_tr_b16 a[144:145], v192 offset:32768
    v_cvt_pk_bf16_f32 v150, v140, v141
    v_mfma_f32_16x16x32_bf16 v[64:67], a[176:179], v[144:147], v[64:67]
    v_exp_f32 v142, v142
    v_mfma_f32_16x16x32_bf16 v[80:83], a[180:183], v[144:147], v[80:83]
    ds_read_b64_tr_b16 a[146:147], v192 offset:40960
    v_mfma_f32_16x16x32_bf16 v[96:99], a[184:187], v[144:147], v[96:99]
    v_exp_f32 v143, v143
    v_mfma_f32_16x16x32_bf16 v[112:115], a[188:191], v[144:147], v[112:115]
    v_cvt_pk_bf16_f32 v151, v142, v143
    v_mfma_f32_16x16x32_bf16 v[200:203], v[216:219], v[144:147], v[200:203]
    buffer_load_dwordx4 v198, s[16:19], s27 offen offset:2048 nt lds
    v_mfma_f32_16x16x32_bf16 v[136:139], a[96:99], a[48:51], v[164:167]
    v_exp_f32 v128, v128
    v_mfma_f32_16x16x32_bf16 v[136:139], a[100:103], a[52:55], v[136:139]
    ds_read_b64_tr_b16 a[148:149], v193 offset:32768
    v_mfma_f32_16x16x32_bf16 v[136:139], a[104:107], a[56:59], v[136:139]
    v_exp_f32 v129, v129
    v_mfma_f32_16x16x32_bf16 v[136:139], a[108:111], a[60:63], v[136:139]
    ds_read_b64_tr_b16 a[150:151], v193 offset:40960
    v_cvt_pk_bf16_f32 v144, v128, v129
    v_mfma_f32_16x16x32_bf16 v[140:143], a[112:115], a[48:51], v[164:167]
    v_exp_f32 v130, v130
    v_mfma_f32_16x16x32_bf16 v[140:143], a[116:119], a[52:55], v[140:143]
    ds_read_b64_tr_b16 a[152:153], v194 offset:32768
    v_mfma_f32_16x16x32_bf16 v[140:143], a[120:123], a[56:59], v[140:143]
    v_exp_f32 v131, v131
    v_mfma_f32_16x16x32_bf16 v[140:143], a[124:127], a[60:63], v[140:143]
    ds_read_b64_tr_b16 a[154:155], v194 offset:40960
    v_cvt_pk_bf16_f32 v145, v130, v131
    v_mfma_f32_16x16x32_bf16 v[4:7], a[160:163], v[148:151], v[4:7]
    v_exp_f32 v132, v132
    v_mfma_f32_16x16x32_bf16 v[20:23], a[164:167], v[148:151], v[20:23]
    ds_read_b64_tr_b16 a[156:157], v195 offset:32768
    v_mfma_f32_16x16x32_bf16 v[36:39], a[168:171], v[148:151], v[36:39]
    v_exp_f32 v133, v133
    v_mfma_f32_16x16x32_bf16 v[52:55], a[172:175], v[148:151], v[52:55]
    ds_read_b64_tr_b16 a[158:159], v195 offset:40960
    v_cvt_pk_bf16_f32 v146, v132, v133
    v_mfma_f32_16x16x32_bf16 v[68:71], a[176:179], v[148:151], v[68:71]
    v_exp_f32 v134, v134
    v_mfma_f32_16x16x32_bf16 v[84:87], a[180:183], v[148:151], v[84:87]
    buffer_load_dwordx4 v199, s[16:19], s27 offen offset:3072 nt lds
    s_add_u32 s27, s27, 8192
    s_and_b32 s27, s27, 0x7ffff
    v_mfma_f32_16x16x32_bf16 v[100:103], a[184:187], v[148:151], v[100:103]
    v_exp_f32 v135, v135
    v_mfma_f32_16x16x32_bf16 v[116:119], a[188:191], v[148:151], v[116:119]
    v_cvt_pk_bf16_f32 v147, v134, v135
    v_mfma_f32_16x16x32_bf16 v[204:207], v[216:219], v[148:151], v[204:207]
    s_sub_u32 s31, s31, 1
    s_cmp_lg_u32 s31, 0
    s_cbranch_scc1 L_loop
    s_lshl_b32 s38, s47, 5
    v_mov_b32 v221, s38
    global_load_dword v220, v221, s[64:65] sc1
    s_mul_i32 s49, s24, 1179648
    s_add_u32 s46, s49, 368640
    s_waitcnt vmcnt(24) lgkmcnt(0)
    s_barrier
    s_add_u32 m0, s35, 98304
    v_mfma_f32_16x16x32_bf16 v[128:131], a[64:67], a[0:3], v[152:155]
    v_exp_f32 v136, v136
    v_mfma_f32_16x16x32_bf16 v[128:131], a[68:71], a[4:7], v[128:131]
    ds_read_b128 a[96:99], v176 offset:49152
    v_mfma_f32_16x16x32_bf16 v[128:131], a[72:75], a[8:11], v[128:131]
    v_exp_f32 v137, v137
    v_mfma_f32_16x16x32_bf16 v[128:131], a[76:79], a[12:15], v[128:131]
    ds_read_b128 a[100:103], v177 offset:49152
    v_cvt_pk_bf16_f32 v148, v136, v137
    v_mfma_f32_16x16x32_bf16 v[132:135], a[80:83], a[0:3], v[152:155]
    v_exp_f32 v138, v138
    v_mfma_f32_16x16x32_bf16 v[132:135], a[84:87], a[4:7], v[132:135]
    ds_read_b128 a[104:107], v178 offset:49152
    v_mfma_f32_16x16x32_bf16 v[132:135], a[88:91], a[8:11], v[132:135]
    v_exp_f32 v139, v139
    v_mfma_f32_16x16x32_bf16 v[132:135], a[92:95], a[12:15], v[132:135]
    v_cvt_pk_bf16_f32 v149, v138, v139
    v_mfma_f32_16x16x32_bf16 v[8:11], a[160:163], v[144:147], v[8:11]
    v_exp_f32 v140, v140
    v_mfma_f32_16x16x32_bf16 v[24:27], a[164:167], v[144:147], v[24:27]
    ds_read_b128 a[108:111], v179 offset:49152
    buffer_load_dwordx4 a[192:195], v250, s[4:7], s46 offen offset:0
    v_mfma_f32_16x16x32_bf16 v[40:43], a[168:171], v[144:147], v[40:43]
    v_exp_f32 v141, v141
    v_mfma_f32_16x16x32_bf16 v[56:59], a[172:175], v[144:147], v[56:59]
    ds_read_b128 a[112:115], v176 offset:57344
    v_cvt_pk_bf16_f32 v150, v140, v141
    v_mfma_f32_16x16x32_bf16 v[72:75], a[176:179], v[144:147], v[72:75]
    v_exp_f32 v142, v142
    v_mfma_f32_16x16x32_bf16 v[88:91], a[180:183], v[144:147], v[88:91]
    ds_read_b128 a[116:119], v177 offset:57344
    v_mfma_f32_16x16x32_bf16 v[104:107], a[184:187], v[144:147], v[104:107]
    v_exp_f32 v143, v143
    v_mfma_f32_16x16x32_bf16 v[120:123], a[188:191], v[144:147], v[120:123]
    v_cvt_pk_bf16_f32 v151, v142, v143
    v_mfma_f32_16x16x32_bf16 v[208:211], v[216:219], v[144:147], v[208:211]
    buffer_load_dwordx4 v250, s[4:7], s49 offen offset:0 lds
    v_mfma_f32_16x16x32_bf16 v[136:139], a[64:67], a[16:19], v[156:159]
    v_exp_f32 v128, v128
    v_mfma_f32_16x16x32_bf16 v[136:139], a[68:71], a[20:23], v[136:139]
    ds_read_b128 a[120:123], v178 offset:57344
    v_mfma_f32_16x16x32_bf16 v[136:139], a[72:75], a[24:27], v[136:139]
    v_exp_f32 v129, v129
    v_mfma_f32_16x16x32_bf16 v[136:139], a[76:79], a[28:31], v[136:139]
    v_cvt_pk_bf16_f32 v144, v128, v129
    v_mfma_f32_16x16x32_bf16 v[140:143], a[80:83], a[16:19], v[156:159]
    v_exp_f32 v130, v130
    v_mfma_f32_16x16x32_bf16 v[140:143], a[84:87], a[20:23], v[140:143]
    ds_read_b128 a[124:127], v179 offset:57344
    v_mfma_f32_16x16x32_bf16 v[140:143], a[88:91], a[24:27], v[140:143]
    v_exp_f32 v131, v131
    v_mfma_f32_16x16x32_bf16 v[140:143], a[92:95], a[28:31], v[140:143]
    v_cvt_pk_bf16_f32 v145, v130, v131
    v_mfma_f32_16x16x32_bf16 v[12:15], a[160:163], v[148:151], v[12:15]
    v_exp_f32 v132, v132
    v_mfma_f32_16x16x32_bf16 v[28:31], a[164:167], v[148:151], v[28:31]
    ds_read_b64_tr_b16 a[160:161], v188 offset:49152
    buffer_load_dwordx4 a[196:199], v251, s[4:7], s46 offen offset:1024
    v_mfma_f32_16x16x32_bf16 v[44:47], a[168:171], v[148:151], v[44:47]
    v_exp_f32 v133, v133
    v_mfma_f32_16x16x32_bf16 v[60:63], a[172:175], v[148:151], v[60:63]
    ds_read_b64_tr_b16 a[162:163], v188 offset:57344
    v_cvt_pk_bf16_f32 v146, v132, v133
    v_mfma_f32_16x16x32_bf16 v[76:79], a[176:179], v[148:151], v[76:79]
    v_exp_f32 v134, v134
    v_mfma_f32_16x16x32_bf16 v[92:95], a[180:183], v[148:151], v[92:95]
    ds_read_b64_tr_b16 a[164:165], v189 offset:49152
    v_mfma_f32_16x16x32_bf16 v[108:111], a[184:187], v[148:151], v[108:111]
    v_exp_f32 v135, v135
    v_mfma_f32_16x16x32_bf16 v[124:127], a[188:191], v[148:151], v[124:127]
    ds_read_b64_tr_b16 a[166:167], v189 offset:57344
    v_cvt_pk_bf16_f32 v147, v134, v135
    v_mfma_f32_16x16x32_bf16 v[212:215], v[216:219], v[148:151], v[212:215]
    buffer_load_dwordx4 v251, s[4:7], s49 offen offset:1024 lds
    v_mfma_f32_16x16x32_bf16 v[128:131], a[64:67], a[32:35], v[160:163]
    v_exp_f32 v136, v136
    v_mfma_f32_16x16x32_bf16 v[128:131], a[68:71], a[36:39], v[128:131]
    ds_read_b64_tr_b16 a[168:169], v190 offset:49152
    v_mfma_f32_16x16x32_bf16 v[128:131], a[72:75], a[40:43], v[128:131]
    v_exp_f32 v137, v137
    v_mfma_f32_16x16x32_bf16 v[128:131], a[76:79], a[44:47], v[128:131]
    ds_read_b64_tr_b16 a[170:171], v190 offset:57344
    v_cvt_pk_bf16_f32 v148, v136, v137
    v_mfma_f32_16x16x32_bf16 v[132:135], a[80:83], a[32:35], v[160:163]
    v_exp_f32 v138, v138
    v_mfma_f32_16x16x32_bf16 v[132:135], a[84:87], a[36:39], v[132:135]
    ds_read_b64_tr_b16 a[172:173], v191 offset:49152
    v_mfma_f32_16x16x32_bf16 v[132:135], a[88:91], a[40:43], v[132:135]
    v_exp_f32 v139, v139
    v_mfma_f32_16x16x32_bf16 v[132:135], a[92:95], a[44:47], v[132:135]
    v_cvt_pk_bf16_f32 v149, v138, v139
    v_mfma_f32_16x16x32_bf16 v[0:3], a[128:131], v[144:147], v[0:3]
    v_exp_f32 v140, v140
    v_mfma_f32_16x16x32_bf16 v[16:19], a[132:135], v[144:147], v[16:19]
    ds_read_b64_tr_b16 a[174:175], v191 offset:57344
    buffer_load_dwordx4 a[200:203], v252, s[4:7], s46 offen offset:2048
    v_mfma_f32_16x16x32_bf16 v[32:35], a[136:139], v[144:147], v[32:35]
    v_exp_f32 v141, v141
    v_mfma_f32_16x16x32_bf16 v[48:51], a[140:143], v[144:147], v[48:51]
    ds_read_b64_tr_b16 a[176:177], v192 offset:49152
    v_cvt_pk_bf16_f32 v150, v140, v141
    v_mfma_f32_16x16x32_bf16 v[64:67], a[144:147], v[144:147], v[64:67]
    v_exp_f32 v142, v142
    v_mfma_f32_16x16x32_bf16 v[80:83], a[148:151], v[144:147], v[80:83]
    ds_read_b64_tr_b16 a[178:179], v192 offset:57344
    v_mfma_f32_16x16x32_bf16 v[96:99], a[152:155], v[144:147], v[96:99]
    v_exp_f32 v143, v143
    v_mfma_f32_16x16x32_bf16 v[112:115], a[156:159], v[144:147], v[112:115]
    v_cvt_pk_bf16_f32 v151, v142, v143
    v_mfma_f32_16x16x32_bf16 v[200:203], v[216:219], v[144:147], v[200:203]
    buffer_load_dwordx4 v252, s[4:7], s49 offen offset:2048 lds
    v_mfma_f32_16x16x32_bf16 v[136:139], a[64:67], a[48:51], v[164:167]
    v_exp_f32 v128, v128
    v_mfma_f32_16x16x32_bf16 v[136:139], a[68:71], a[52:55], v[136:139]
    ds_read_b64_tr_b16 a[180:181], v193 offset:49152
    v_mfma_f32_16x16x32_bf16 v[136:139], a[72:75], a[56:59], v[136:139]
    v_exp_f32 v129, v129
    v_mfma_f32_16x16x32_bf16 v[136:139], a[76:79], a[60:63], v[136:139]
    ds_read_b64_tr_b16 a[182:183], v193 offset:57344
    v_cvt_pk_bf16_f32 v144, v128, v129
    v_mfma_f32_16x16x32_bf16 v[140:143], a[80:83], a[48:51], v[164:167]
    v_exp_f32 v130, v130
    v_mfma_f32_16x16x32_bf16 v[140:143], a[84:87], a[52:55], v[140:143]
    ds_read_b64_tr_b16 a[184:185], v194 offset:49152
    v_mfma_f32_16x16x32_bf16 v[140:143], a[88:91], a[56:59], v[140:143]
    v_exp_f32 v131, v131
    v_mfma_f32_16x16x32_bf16 v[140:143], a[92:95], a[60:63], v[140:143]
    ds_read_b64_tr_b16 a[186:187], v194 offset:57344
    v_cvt_pk_bf16_f32 v145, v130, v131
    v_mfma_f32_16x16x32_bf16 v[4:7], a[128:131], v[148:151], v[4:7]
    v_exp_f32 v132, v132
    v_mfma_f32_16x16x32_bf16 v[20:23], a[132:135], v[148:151], v[20:23]
    ds_read_b64_tr_b16 a[188:189], v195 offset:49152
    buffer_load_dwordx4 a[204:207], v253, s[4:7], s46 offen offset:3072
    s_add_u32 s46, s46, 36864
    v_mfma_f32_16x16x32_bf16 v[36:39], a[136:139], v[148:151], v[36:39]
    v_exp_f32 v133, v133
    v_mfma_f32_16x16x32_bf16 v[52:55], a[140:143], v[148:151], v[52:55]
    ds_read_b64_tr_b16 a[190:191], v195 offset:57344
    v_cvt_pk_bf16_f32 v146, v132, v133
    v_mfma_f32_16x16x32_bf16 v[68:71], a[144:147], v[148:151], v[68:71]
    v_exp_f32 v134, v134
    v_mfma_f32_16x16x32_bf16 v[84:87], a[148:151], v[148:151], v[84:87]
    buffer_load_dwordx4 v253, s[4:7], s49 offen offset:3072 lds
    s_add_u32 s49, s49, 36864
    v_mfma_f32_16x16x32_bf16 v[100:103], a[152:155], v[148:151], v[100:103]
    v_exp_f32 v135, v135
    v_mfma_f32_16x16x32_bf16 v[116:119], a[156:159], v[148:151], v[116:119]
    v_cvt_pk_bf16_f32 v147, v134, v135
    v_mfma_f32_16x16x32_bf16 v[204:207], v[216:219], v[148:151], v[204:207]
    s_waitcnt vmcnt(28) lgkmcnt(0)
    s_barrier
    s_add_u32 m0, s35, 114688
    v_mfma_f32_16x16x32_bf16 v[128:131], a[96:99], a[0:3], v[152:155]
    v_exp_f32 v136, v136
    v_mfma_f32_16x16x32_bf16 v[128:131], a[100:103], a[4:7], v[128:131]
    ds_read_b128 a[64:67], v172 offset:0
    v_mfma_f32_16x16x32_bf16 v[128:131], a[104:107], a[8:11], v[128:131]
    v_exp_f32 v137, v137
    v_mfma_f32_16x16x32_bf16 v[128:131], a[108:111], a[12:15], v[128:131]
    ds_read_b128 a[68:71], v173 offset:0
    v_cvt_pk_bf16_f32 v148, v136, v137
    v_mfma_f32_16x16x32_bf16 v[132:135], a[112:115], a[0:3], v[152:155]
    v_exp_f32 v138, v138
    v_mfma_f32_16x16x32_bf16 v[132:135], a[116:119], a[4:7], v[132:135]
    ds_read_b128 a[72:75], v174 offset:0
    v_mfma_f32_16x16x32_bf16 v[132:135], a[120:123], a[8:11], v[132:135]
    v_exp_f32 v139, v139
    v_mfma_f32_16x16x32_bf16 v[132:135], a[124:127], a[12:15], v[132:135]
    v_cvt_pk_bf16_f32 v149, v138, v139
    v_mfma_f32_16x16x32_bf16 v[8:11], a[128:131], v[144:147], v[8:11]
    v_exp_f32 v140, v140
    v_mfma_f32_16x16x32_bf16 v[24:27], a[132:135], v[144:147], v[24:27]
    ds_read_b128 a[76:79], v175 offset:0
    buffer_load_dwordx4 a[208:211], v250, s[4:7], s46 offen offset:0
    v_mfma_f32_16x16x32_bf16 v[40:43], a[136:139], v[144:147], v[40:43]
    v_exp_f32 v141, v141
    v_mfma_f32_16x16x32_bf16 v[56:59], a[140:143], v[144:147], v[56:59]
    ds_read_b128 a[80:83], v172 offset:8192
    v_cvt_pk_bf16_f32 v150, v140, v141
    v_mfma_f32_16x16x32_bf16 v[72:75], a[144:147], v[144:147], v[72:75]
    v_exp_f32 v142, v142
    v_mfma_f32_16x16x32_bf16 v[88:91], a[148:151], v[144:147], v[88:91]
    ds_read_b128 a[84:87], v173 offset:8192
    v_mfma_f32_16x16x32_bf16 v[104:107], a[152:155], v[144:147], v[104:107]
    v_exp_f32 v143, v143
    v_mfma_f32_16x16x32_bf16 v[120:123], a[156:159], v[144:147], v[120:123]
    v_cvt_pk_bf16_f32 v151, v142, v143
    v_mfma_f32_16x16x32_bf16 v[208:211], v[216:219], v[144:147], v[208:211]
    buffer_load_dwordx4 v250, s[4:7], s49 offen offset:0 lds
    v_mfma_f32_16x16x32_bf16 v[136:139], a[96:99], a[16:19], v[156:159]
    v_exp_f32 v128, v128
    v_mfma_f32_16x16x32_bf16 v[136:139], a[100:103], a[20:23], v[136:139]
    ds_read_b128 a[88:91], v174 offset:8192
    v_mfma_f32_16x16x32_bf16 v[136:139], a[104:107], a[24:27], v[136:139]
    v_exp_f32 v129, v129
    v_mfma_f32_16x16x32_bf16 v[136:139], a[108:111], a[28:31], v[136:139]
    v_cvt_pk_bf16_f32 v144, v128, v129
    v_mfma_f32_16x16x32_bf16 v[140:143], a[112:115], a[16:19], v[156:159]
    v_exp_f32 v130, v130
    v_mfma_f32_16x16x32_bf16 v[140:143], a[116:119], a[20:23], v[140:143]
    ds_read_b128 a[92:95], v175 offset:8192
    v_mfma_f32_16x16x32_bf16 v[140:143], a[120:123], a[24:27], v[140:143]
    v_exp_f32 v131, v131
    v_mfma_f32_16x16x32_bf16 v[140:143], a[124:127], a[28:31], v[140:143]
    v_cvt_pk_bf16_f32 v145, v130, v131
    v_mfma_f32_16x16x32_bf16 v[12:15], a[128:131], v[148:151], v[12:15]
    v_exp_f32 v132, v132
    v_mfma_f32_16x16x32_bf16 v[28:31], a[132:135], v[148:151], v[28:31]
    ds_read_b64_tr_b16 a[128:129], v180 offset:0
    buffer_load_dwordx4 a[212:215], v251, s[4:7], s46 offen offset:1024
    v_mfma_f32_16x16x32_bf16 v[44:47], a[136:139], v[148:151], v[44:47]
    v_exp_f32 v133, v133
    v_mfma_f32_16x16x32_bf16 v[60:63], a[140:143], v[148:151], v[60:63]
    ds_read_b64_tr_b16 a[130:131], v180 offset:8192
    v_cvt_pk_bf16_f32 v146, v132, v133
    v_mfma_f32_16x16x32_bf16 v[76:79], a[144:147], v[148:151], v[76:79]
    v_exp_f32 v134, v134
    v_mfma_f32_16x16x32_bf16 v[92:95], a[148:151], v[148:151], v[92:95]
    ds_read_b64_tr_b16 a[132:133], v181 offset:0
    v_mfma_f32_16x16x32_bf16 v[108:111], a[152:155], v[148:151], v[108:111]
    v_exp_f32 v135, v135
    v_mfma_f32_16x16x32_bf16 v[124:127], a[156:159], v[148:151], v[124:127]
    ds_read_b64_tr_b16 a[134:135], v181 offset:8192
    v_cvt_pk_bf16_f32 v147, v134, v135
    v_mfma_f32_16x16x32_bf16 v[212:215], v[216:219], v[148:151], v[212:215]
    buffer_load_dwordx4 v251, s[4:7], s49 offen offset:1024 lds
    v_mfma_f32_16x16x32_bf16 v[128:131], a[96:99], a[32:35], v[160:163]
    v_exp_f32 v136, v136
    v_mfma_f32_16x16x32_bf16 v[128:131], a[100:103], a[36:39], v[128:131]
    ds_read_b64_tr_b16 a[136:137], v182 offset:0
    v_mfma_f32_16x16x32_bf16 v[128:131], a[104:107], a[40:43], v[128:131]
    v_exp_f32 v137, v137
    v_mfma_f32_16x16x32_bf16 v[128:131], a[108:111], a[44:47], v[128:131]
    ds_read_b64_tr_b16 a[138:139], v182 offset:8192
    v_cvt_pk_bf16_f32 v148, v136, v137
    v_mfma_f32_16x16x32_bf16 v[132:135], a[112:115], a[32:35], v[160:163]
    v_exp_f32 v138, v138
    v_mfma_f32_16x16x32_bf16 v[132:135], a[116:119], a[36:39], v[132:135]
    ds_read_b64_tr_b16 a[140:141], v183 offset:0
    v_mfma_f32_16x16x32_bf16 v[132:135], a[120:123], a[40:43], v[132:135]
    v_exp_f32 v139, v139
    v_mfma_f32_16x16x32_bf16 v[132:135], a[124:127], a[44:47], v[132:135]
    v_cvt_pk_bf16_f32 v149, v138, v139
    v_mfma_f32_16x16x32_bf16 v[0:3], a[160:163], v[144:147], v[0:3]
    v_exp_f32 v140, v140
    v_mfma_f32_16x16x32_bf16 v[16:19], a[164:167], v[144:147], v[16:19]
    ds_read_b64_tr_b16 a[142:143], v183 offset:8192
    buffer_load_dwordx4 a[216:219], v252, s[4:7], s46 offen offset:2048
    v_mfma_f32_16x16x32_bf16 v[32:35], a[168:171], v[144:147], v[32:35]
    v_exp_f32 v141, v141
    v_mfma_f32_16x16x32_bf16 v[48:51], a[172:175], v[144:147], v[48:51]
    ds_read_b64_tr_b16 a[144:145], v184 offset:0
    v_cvt_pk_bf16_f32 v150, v140, v141
    v_mfma_f32_16x16x32_bf16 v[64:67], a[176:179], v[144:147], v[64:67]
    v_exp_f32 v142, v142
    v_mfma_f32_16x16x32_bf16 v[80:83], a[180:183], v[144:147], v[80:83]
    ds_read_b64_tr_b16 a[146:147], v184 offset:8192
    v_mfma_f32_16x16x32_bf16 v[96:99], a[184:187], v[144:147], v[96:99]
    v_exp_f32 v143, v143
    v_mfma_f32_16x16x32_bf16 v[112:115], a[188:191], v[144:147], v[112:115]
    v_cvt_pk_bf16_f32 v151, v142, v143
    v_mfma_f32_16x16x32_bf16 v[200:203], v[216:219], v[144:147], v[200:203]
    buffer_load_dwordx4 v252, s[4:7], s49 offen offset:2048 lds
    v_mfma_f32_16x16x32_bf16 v[136:139], a[96:99], a[48:51], v[164:167]
    v_exp_f32 v128, v128
    v_mfma_f32_16x16x32_bf16 v[136:139], a[100:103], a[52:55], v[136:139]
    ds_read_b64_tr_b16 a[148:149], v185 offset:0
    v_mfma_f32_16x16x32_bf16 v[136:139], a[104:107], a[56:59], v[136:139]
    v_exp_f32 v129, v129
    v_mfma_f32_16x16x32_bf16 v[136:139], a[108:111], a[60:63], v[136:139]
    ds_read_b64_tr_b16 a[150:151], v185 offset:8192
    v_cvt_pk_bf16_f32 v144, v128, v129
    v_mfma_f32_16x16x32_bf16 v[140:143], a[112:115], a[48:51], v[164:167]
    v_exp_f32 v130, v130
    v_mfma_f32_16x16x32_bf16 v[140:143], a[116:119], a[52:55], v[140:143]
    ds_read_b64_tr_b16 a[152:153], v186 offset:0
    v_mfma_f32_16x16x32_bf16 v[140:143], a[120:123], a[56:59], v[140:143]
    v_exp_f32 v131, v131
    v_mfma_f32_16x16x32_bf16 v[140:143], a[124:127], a[60:63], v[140:143]
    ds_read_b64_tr_b16 a[154:155], v186 offset:8192
    v_cvt_pk_bf16_f32 v145, v130, v131
    v_mfma_f32_16x16x32_bf16 v[4:7], a[160:163], v[148:151], v[4:7]
    v_exp_f32 v132, v132
    v_mfma_f32_16x16x32_bf16 v[20:23], a[164:167], v[148:151], v[20:23]
    ds_read_b64_tr_b16 a[156:157], v187 offset:0
    buffer_load_dwordx4 a[220:223], v253, s[4:7], s46 offen offset:3072
    s_add_u32 s46, s46, 36864
    v_mfma_f32_16x16x32_bf16 v[36:39], a[168:171], v[148:151], v[36:39]
    v_exp_f32 v133, v133
    v_mfma_f32_16x16x32_bf16 v[52:55], a[172:175], v[148:151], v[52:55]
    ds_read_b64_tr_b16 a[158:159], v187 offset:8192
    v_cvt_pk_bf16_f32 v146, v132, v133
    v_mfma_f32_16x16x32_bf16 v[68:71], a[176:179], v[148:151], v[68:71]
    v_exp_f32 v134, v134
    v_mfma_f32_16x16x32_bf16 v[84:87], a[180:183], v[148:151], v[84:87]
    buffer_load_dwordx4 v253, s[4:7], s49 offen offset:3072 lds
    s_add_u32 s49, s49, 36864
    v_mfma_f32_16x16x32_bf16 v[100:103], a[184:187], v[148:151], v[100:103]
    v_exp_f32 v135, v135
    v_mfma_f32_16x16x32_bf16 v[116:119], a[188:191], v[148:151], v[116:119]
    v_cvt_pk_bf16_f32 v147, v134, v135
    v_mfma_f32_16x16x32_bf16 v[204:207], v[216:219], v[148:151], v[204:207]
    s_waitcnt vmcnt(32) lgkmcnt(0)
    s_barrier
    s_add_u32 m0, s35, 0
    v_mfma_f32_16x16x32_bf16 v[128:131], a[64:67], a[0:3], v[152:155]
    v_exp_f32 v136, v136
    v_mfma_f32_16x16x32_bf16 v[128:131], a[68:71], a[4:7], v[128:131]
    ds_read_b128 a[96:99], v172 offset:16384
    v_mfma_f32_16x16x32_bf16 v[128:131], a[72:75], a[8:11], v[128:131]
    v_exp_f32 v137, v137
    v_mfma_f32_16x16x32_bf16 v[128:131], a[76:79], a[12:15], v[128:131]
    ds_read_b128 a[100:103], v173 offset:16384
    v_cvt_pk_bf16_f32 v148, v136, v137
    v_mfma_f32_16x16x32_bf16 v[132:135], a[80:83], a[0:3], v[152:155]
    v_exp_f32 v138, v138
    v_mfma_f32_16x16x32_bf16 v[132:135], a[84:87], a[4:7], v[132:135]
    ds_read_b128 a[104:107], v174 offset:16384
    v_mfma_f32_16x16x32_bf16 v[132:135], a[88:91], a[8:11], v[132:135]
    v_exp_f32 v139, v139
    v_mfma_f32_16x16x32_bf16 v[132:135], a[92:95], a[12:15], v[132:135]
    v_cvt_pk_bf16_f32 v149, v138, v139
    v_mfma_f32_16x16x32_bf16 v[8:11], a[160:163], v[144:147], v[8:11]
    v_exp_f32 v140, v140
    v_mfma_f32_16x16x32_bf16 v[24:27], a[164:167], v[144:147], v[24:27]
    ds_read_b128 a[108:111], v175 offset:16384
    buffer_load_dwordx4 a[224:227], v250, s[4:7], s46 offen offset:0
    v_mfma_f32_16x16x32_bf16 v[40:43], a[168:171], v[144:147], v[40:43]
    v_exp_f32 v141, v141
    v_mfma_f32_16x16x32_bf16 v[56:59], a[172:175], v[144:147], v[56:59]
    ds_read_b128 a[112:115], v172 offset:24576
    v_cvt_pk_bf16_f32 v150, v140, v141
    v_mfma_f32_16x16x32_bf16 v[72:75], a[176:179], v[144:147], v[72:75]
    v_exp_f32 v142, v142
    v_mfma_f32_16x16x32_bf16 v[88:91], a[180:183], v[144:147], v[88:91]
    ds_read_b128 a[116:119], v173 offset:24576
    v_mfma_f32_16x16x32_bf16 v[104:107], a[184:187], v[144:147], v[104:107]
    v_exp_f32 v143, v143
    v_mfma_f32_16x16x32_bf16 v[120:123], a[188:191], v[144:147], v[120:123]
    v_cvt_pk_bf16_f32 v151, v142, v143
    v_mfma_f32_16x16x32_bf16 v[208:211], v[216:219], v[144:147], v[208:211]
    buffer_load_dwordx4 v250, s[4:7], s49 offen offset:0 lds
    v_mfma_f32_16x16x32_bf16 v[136:139], a[64:67], a[16:19], v[156:159]
    v_exp_f32 v128, v128
    v_mfma_f32_16x16x32_bf16 v[136:139], a[68:71], a[20:23], v[136:139]
    ds_read_b128 a[120:123], v174 offset:24576
    v_mfma_f32_16x16x32_bf16 v[136:139], a[72:75], a[24:27], v[136:139]
    v_exp_f32 v129, v129
    v_mfma_f32_16x16x32_bf16 v[136:139], a[76:79], a[28:31], v[136:139]
    v_cvt_pk_bf16_f32 v144, v128, v129
    v_mfma_f32_16x16x32_bf16 v[140:143], a[80:83], a[16:19], v[156:159]
    v_exp_f32 v130, v130
    v_mfma_f32_16x16x32_bf16 v[140:143], a[84:87], a[20:23], v[140:143]
    ds_read_b128 a[124:127], v175 offset:24576
    v_mfma_f32_16x16x32_bf16 v[140:143], a[88:91], a[24:27], v[140:143]
    v_exp_f32 v131, v131
    v_mfma_f32_16x16x32_bf16 v[140:143], a[92:95], a[28:31], v[140:143]
    v_cvt_pk_bf16_f32 v145, v130, v131
    v_mfma_f32_16x16x32_bf16 v[12:15], a[160:163], v[148:151], v[12:15]
    v_exp_f32 v132, v132
    v_mfma_f32_16x16x32_bf16 v[28:31], a[164:167], v[148:151], v[28:31]
    ds_read_b64_tr_b16 a[160:161], v180 offset:16384
    buffer_load_dwordx4 a[228:231], v251, s[4:7], s46 offen offset:1024
    v_mfma_f32_16x16x32_bf16 v[44:47], a[168:171], v[148:151], v[44:47]
    v_exp_f32 v133, v133
    v_mfma_f32_16x16x32_bf16 v[60:63], a[172:175], v[148:151], v[60:63]
    ds_read_b64_tr_b16 a[162:163], v180 offset:24576
    v_cvt_pk_bf16_f32 v146, v132, v133
    v_mfma_f32_16x16x32_bf16 v[76:79], a[176:179], v[148:151], v[76:79]
    v_exp_f32 v134, v134
    v_mfma_f32_16x16x32_bf16 v[92:95], a[180:183], v[148:151], v[92:95]
    ds_read_b64_tr_b16 a[164:165], v181 offset:16384
    v_mfma_f32_16x16x32_bf16 v[108:111], a[184:187], v[148:151], v[108:111]
    v_exp_f32 v135, v135
    v_mfma_f32_16x16x32_bf16 v[124:127], a[188:191], v[148:151], v[124:127]
    ds_read_b64_tr_b16 a[166:167], v181 offset:24576
    v_cvt_pk_bf16_f32 v147, v134, v135
    v_mfma_f32_16x16x32_bf16 v[212:215], v[216:219], v[148:151], v[212:215]
    buffer_load_dwordx4 v251, s[4:7], s49 offen offset:1024 lds
    v_mfma_f32_16x16x32_bf16 v[128:131], a[64:67], a[32:35], v[160:163]
    v_exp_f32 v136, v136
    v_mfma_f32_16x16x32_bf16 v[128:131], a[68:71], a[36:39], v[128:131]
    ds_read_b64_tr_b16 a[168:169], v182 offset:16384
    v_mfma_f32_16x16x32_bf16 v[128:131], a[72:75], a[40:43], v[128:131]
    v_exp_f32 v137, v137
    v_mfma_f32_16x16x32_bf16 v[128:131], a[76:79], a[44:47], v[128:131]
    ds_read_b64_tr_b16 a[170:171], v182 offset:24576
    v_cvt_pk_bf16_f32 v148, v136, v137
    v_mfma_f32_16x16x32_bf16 v[132:135], a[80:83], a[32:35], v[160:163]
    v_exp_f32 v138, v138
    v_mfma_f32_16x16x32_bf16 v[132:135], a[84:87], a[36:39], v[132:135]
    ds_read_b64_tr_b16 a[172:173], v183 offset:16384
    v_mfma_f32_16x16x32_bf16 v[132:135], a[88:91], a[40:43], v[132:135]
    v_exp_f32 v139, v139
    v_mfma_f32_16x16x32_bf16 v[132:135], a[92:95], a[44:47], v[132:135]
    v_cvt_pk_bf16_f32 v149, v138, v139
    v_mfma_f32_16x16x32_bf16 v[0:3], a[128:131], v[144:147], v[0:3]
    v_exp_f32 v140, v140
    v_mfma_f32_16x16x32_bf16 v[16:19], a[132:135], v[144:147], v[16:19]
    ds_read_b64_tr_b16 a[174:175], v183 offset:24576
    buffer_load_dwordx4 a[232:235], v252, s[4:7], s46 offen offset:2048
    v_mfma_f32_16x16x32_bf16 v[32:35], a[136:139], v[144:147], v[32:35]
    v_exp_f32 v141, v141
    v_mfma_f32_16x16x32_bf16 v[48:51], a[140:143], v[144:147], v[48:51]
    ds_read_b64_tr_b16 a[176:177], v184 offset:16384
    v_cvt_pk_bf16_f32 v150, v140, v141
    v_mfma_f32_16x16x32_bf16 v[64:67], a[144:147], v[144:147], v[64:67]
    v_exp_f32 v142, v142
    v_mfma_f32_16x16x32_bf16 v[80:83], a[148:151], v[144:147], v[80:83]
    ds_read_b64_tr_b16 a[178:179], v184 offset:24576
    v_mfma_f32_16x16x32_bf16 v[96:99], a[152:155], v[144:147], v[96:99]
    v_exp_f32 v143, v143
    v_mfma_f32_16x16x32_bf16 v[112:115], a[156:159], v[144:147], v[112:115]
    v_cvt_pk_bf16_f32 v151, v142, v143
    v_mfma_f32_16x16x32_bf16 v[200:203], v[216:219], v[144:147], v[200:203]
    buffer_load_dwordx4 v252, s[4:7], s49 offen offset:2048 lds
    v_mfma_f32_16x16x32_bf16 v[136:139], a[64:67], a[48:51], v[164:167]
    v_exp_f32 v128, v128
    v_mfma_f32_16x16x32_bf16 v[136:139], a[68:71], a[52:55], v[136:139]
    ds_read_b64_tr_b16 a[180:181], v185 offset:16384
    v_mfma_f32_16x16x32_bf16 v[136:139], a[72:75], a[56:59], v[136:139]
    v_exp_f32 v129, v129
    v_mfma_f32_16x16x32_bf16 v[136:139], a[76:79], a[60:63], v[136:139]
    ds_read_b64_tr_b16 a[182:183], v185 offset:24576
    v_cvt_pk_bf16_f32 v144, v128, v129
    v_mfma_f32_16x16x32_bf16 v[140:143], a[80:83], a[48:51], v[164:167]
    v_exp_f32 v130, v130
    v_mfma_f32_16x16x32_bf16 v[140:143], a[84:87], a[52:55], v[140:143]
    ds_read_b64_tr_b16 a[184:185], v186 offset:16384
    v_mfma_f32_16x16x32_bf16 v[140:143], a[88:91], a[56:59], v[140:143]
    v_exp_f32 v131, v131
    v_mfma_f32_16x16x32_bf16 v[140:143], a[92:95], a[60:63], v[140:143]
    ds_read_b64_tr_b16 a[186:187], v186 offset:24576
    v_cvt_pk_bf16_f32 v145, v130, v131
    v_mfma_f32_16x16x32_bf16 v[4:7], a[128:131], v[148:151], v[4:7]
    v_exp_f32 v132, v132
    v_mfma_f32_16x16x32_bf16 v[20:23], a[132:135], v[148:151], v[20:23]
    ds_read_b64_tr_b16 a[188:189], v187 offset:16384
    buffer_load_dwordx4 a[236:239], v253, s[4:7], s46 offen offset:3072
    s_add_u32 s46, s46, 36864
    v_mfma_f32_16x16x32_bf16 v[36:39], a[136:139], v[148:151], v[36:39]
    v_exp_f32 v133, v133
    v_mfma_f32_16x16x32_bf16 v[52:55], a[140:143], v[148:151], v[52:55]
    ds_read_b64_tr_b16 a[190:191], v187 offset:24576
    v_cvt_pk_bf16_f32 v146, v132, v133
    v_mfma_f32_16x16x32_bf16 v[68:71], a[144:147], v[148:151], v[68:71]
    v_exp_f32 v134, v134
    v_mfma_f32_16x16x32_bf16 v[84:87], a[148:151], v[148:151], v[84:87]
    buffer_load_dwordx4 v253, s[4:7], s49 offen offset:3072 lds
    s_add_u32 s49, s49, 36864
    v_mfma_f32_16x16x32_bf16 v[100:103], a[152:155], v[148:151], v[100:103]
    v_exp_f32 v135, v135
    v_mfma_f32_16x16x32_bf16 v[116:119], a[156:159], v[148:151], v[116:119]
    v_cvt_pk_bf16_f32 v147, v134, v135
    v_mfma_f32_16x16x32_bf16 v[204:207], v[216:219], v[148:151], v[204:207]
    s_waitcnt vmcnt(36) lgkmcnt(0)
    s_barrier
    s_add_u32 m0, s35, 16384
    v_mfma_f32_16x16x32_bf16 v[128:131], a[96:99], a[0:3], v[152:155]
    v_exp_f32 v136, v136
    v_mfma_f32_16x16x32_bf16 v[128:131], a[100:103], a[4:7], v[128:131]
    ds_read_b128 a[64:67], v172 offset:32768
    v_mfma_f32_16x16x32_bf16 v[128:131], a[104:107], a[8:11], v[128:131]
    v_exp_f32 v137, v137
    v_mfma_f32_16x16x32_bf16 v[128:131], a[108:111], a[12:15], v[128:131]
    ds_read_b128 a[68:71], v173 offset:32768
    v_cvt_pk_bf16_f32 v148, v136, v137
    v_mfma_f32_16x16x32_bf16 v[132:135], a[112:115], a[0:3], v[152:155]
    v_exp_f32 v138, v138
    v_mfma_f32_16x16x32_bf16 v[132:135], a[116:119], a[4:7], v[132:135]
    ds_read_b128 a[72:75], v174 offset:32768
    v_mfma_f32_16x16x32_bf16 v[132:135], a[120:123], a[8:11], v[132:135]
    v_exp_f32 v139, v139
    v_mfma_f32_16x16x32_bf16 v[132:135], a[124:127], a[12:15], v[132:135]
    v_cvt_pk_bf16_f32 v149, v138, v139
    v_mfma_f32_16x16x32_bf16 v[8:11], a[128:131], v[144:147], v[8:11]
    v_exp_f32 v140, v140
    v_mfma_f32_16x16x32_bf16 v[24:27], a[132:135], v[144:147], v[24:27]
    ds_read_b128 a[76:79], v175 offset:32768
    buffer_load_dwordx4 a[240:243], v250, s[4:7], s46 offen offset:0
    v_mfma_f32_16x16x32_bf16 v[40:43], a[136:139], v[144:147], v[40:43]
    v_exp_f32 v141, v141
    v_mfma_f32_16x16x32_bf16 v[56:59], a[140:143], v[144:147], v[56:59]
    ds_read_b128 a[80:83], v172 offset:40960
    v_cvt_pk_bf16_f32 v150, v140, v141
    v_mfma_f32_16x16x32_bf16 v[72:75], a[144:147], v[144:147], v[72:75]
    v_exp_f32 v142, v142
    v_mfma_f32_16x16x32_bf16 v[88:91], a[148:151], v[144:147], v[88:91]
    ds_read_b128 a[84:87], v173 offset:40960
    v_mfma_f32_16x16x32_bf16 v[104:107], a[152:155], v[144:147], v[104:107]
    v_exp_f32 v143, v143
    v_mfma_f32_16x16x32_bf16 v[120:123], a[156:159], v[144:147], v[120:123]
    v_cvt_pk_bf16_f32 v151, v142, v143
    v_mfma_f32_16x16x32_bf16 v[208:211], v[216:219], v[144:147], v[208:211]
    buffer_load_dwordx4 v250, s[4:7], s49 offen offset:0 lds
    v_mfma_f32_16x16x32_bf16 v[136:139], a[96:99], a[16:19], v[156:159]
    v_exp_f32 v128, v128
    v_mfma_f32_16x16x32_bf16 v[136:139], a[100:103], a[20:23], v[136:139]
    ds_read_b128 a[88:91], v174 offset:40960
    v_mfma_f32_16x16x32_bf16 v[136:139], a[104:107], a[24:27], v[136:139]
    v_exp_f32 v129, v129
    v_mfma_f32_16x16x32_bf16 v[136:139], a[108:111], a[28:31], v[136:139]
    v_cvt_pk_bf16_f32 v144, v128, v129
    v_mfma_f32_16x16x32_bf16 v[140:143], a[112:115], a[16:19], v[156:159]
    v_exp_f32 v130, v130
    v_mfma_f32_16x16x32_bf16 v[140:143], a[116:119], a[20:23], v[140:143]
    ds_read_b128 a[92:95], v175 offset:40960
    v_mfma_f32_16x16x32_bf16 v[140:143], a[120:123], a[24:27], v[140:143]
    v_exp_f32 v131, v131
    v_mfma_f32_16x16x32_bf16 v[140:143], a[124:127], a[28:31], v[140:143]
    v_cvt_pk_bf16_f32 v145, v130, v131
    v_mfma_f32_16x16x32_bf16 v[12:15], a[128:131], v[148:151], v[12:15]
    v_exp_f32 v132, v132
    v_mfma_f32_16x16x32_bf16 v[28:31], a[132:135], v[148:151], v[28:31]
    ds_read_b64_tr_b16 a[128:129], v180 offset:32768
    buffer_load_dwordx4 a[244:247], v251, s[4:7], s46 offen offset:1024
    v_mfma_f32_16x16x32_bf16 v[44:47], a[136:139], v[148:151], v[44:47]
    v_exp_f32 v133, v133
    v_mfma_f32_16x16x32_bf16 v[60:63], a[140:143], v[148:151], v[60:63]
    ds_read_b64_tr_b16 a[130:131], v180 offset:40960
    v_cvt_pk_bf16_f32 v146, v132, v133
    v_mfma_f32_16x16x32_bf16 v[76:79], a[144:147], v[148:151], v[76:79]
    v_exp_f32 v134, v134
    v_mfma_f32_16x16x32_bf16 v[92:95], a[148:151], v[148:151], v[92:95]
    ds_read_b64_tr_b16 a[132:133], v181 offset:32768
    v_mfma_f32_16x16x32_bf16 v[108:111], a[152:155], v[148:151], v[108:111]
    v_exp_f32 v135, v135
    v_mfma_f32_16x16x32_bf16 v[124:127], a[156:159], v[148:151], v[124:127]
    ds_read_b64_tr_b16 a[134:135], v181 offset:40960
    v_cvt_pk_bf16_f32 v147, v134, v135
    v_mfma_f32_16x16x32_bf16 v[212:215], v[216:219], v[148:151], v[212:215]
    buffer_load_dwordx4 v251, s[4:7], s49 offen offset:1024 lds
    v_mfma_f32_16x16x32_bf16 v[128:131], a[96:99], a[32:35], v[160:163]
    v_exp_f32 v136, v136
    v_mfma_f32_16x16x32_bf16 v[128:131], a[100:103], a[36:39], v[128:131]
    ds_read_b64_tr_b16 a[136:137], v182 offset:32768
    v_mfma_f32_16x16x32_bf16 v[128:131], a[104:107], a[40:43], v[128:131]
    v_exp_f32 v137, v137
    v_mfma_f32_16x16x32_bf16 v[128:131], a[108:111], a[44:47], v[128:131]
    ds_read_b64_tr_b16 a[138:139], v182 offset:40960
    v_cvt_pk_bf16_f32 v148, v136, v137
    v_mfma_f32_16x16x32_bf16 v[132:135], a[112:115], a[32:35], v[160:163]
    v_exp_f32 v138, v138
    v_mfma_f32_16x16x32_bf16 v[132:135], a[116:119], a[36:39], v[132:135]
    ds_read_b64_tr_b16 a[140:141], v183 offset:32768
    v_mfma_f32_16x16x32_bf16 v[132:135], a[120:123], a[40:43], v[132:135]
    v_exp_f32 v139, v139
    v_mfma_f32_16x16x32_bf16 v[132:135], a[124:127], a[44:47], v[132:135]
    v_cvt_pk_bf16_f32 v149, v138, v139
    v_mfma_f32_16x16x32_bf16 v[0:3], a[160:163], v[144:147], v[0:3]
    v_exp_f32 v140, v140
    v_mfma_f32_16x16x32_bf16 v[16:19], a[164:167], v[144:147], v[16:19]
    ds_read_b64_tr_b16 a[142:143], v183 offset:40960
    buffer_load_dwordx4 a[248:251], v252, s[4:7], s46 offen offset:2048
    v_mfma_f32_16x16x32_bf16 v[32:35], a[168:171], v[144:147], v[32:35]
    v_exp_f32 v141, v141
    v_mfma_f32_16x16x32_bf16 v[48:51], a[172:175], v[144:147], v[48:51]
    ds_read_b64_tr_b16 a[144:145], v184 offset:32768
    v_cvt_pk_bf16_f32 v150, v140, v141
    v_mfma_f32_16x16x32_bf16 v[64:67], a[176:179], v[144:147], v[64:67]
    v_exp_f32 v142, v142
    v_mfma_f32_16x16x32_bf16 v[80:83], a[180:183], v[144:147], v[80:83]
    ds_read_b64_tr_b16 a[146:147], v184 offset:40960
    v_mfma_f32_16x16x32_bf16 v[96:99], a[184:187], v[144:147], v[96:99]
    v_exp_f32 v143, v143
    v_mfma_f32_16x16x32_bf16 v[112:115], a[188:191], v[144:147], v[112:115]
    v_cvt_pk_bf16_f32 v151, v142, v143
    v_mfma_f32_16x16x32_bf16 v[200:203], v[216:219], v[144:147], v[200:203]
    buffer_load_dwordx4 v252, s[4:7], s49 offen offset:2048 lds
    v_mfma_f32_16x16x32_bf16 v[136:139], a[96:99], a[48:51], v[164:167]
    v_exp_f32 v128, v128
    v_mfma_f32_16x16x32_bf16 v[136:139], a[100:103], a[52:55], v[136:139]
    ds_read_b64_tr_b16 a[148:149], v185 offset:32768
    v_mfma_f32_16x16x32_bf16 v[136:139], a[104:107], a[56:59], v[136:139]
    v_exp_f32 v129, v129
    v_mfma_f32_16x16x32_bf16 v[136:139], a[108:111], a[60:63], v[136:139]
    ds_read_b64_tr_b16 a[150:151], v185 offset:40960
    v_cvt_pk_bf16_f32 v144, v128, v129
    v_mfma_f32_16x16x32_bf16 v[140:143], a[112:115], a[48:51], v[164:167]
    v_exp_f32 v130, v130
    v_mfma_f32_16x16x32_bf16 v[140:143], a[116:119], a[52:55], v[140:143]
    ds_read_b64_tr_b16 a[152:153], v186 offset:32768
    v_mfma_f32_16x16x32_bf16 v[140:143], a[120:123], a[56:59], v[140:143]
    v_exp_f32 v131, v131
    v_mfma_f32_16x16x32_bf16 v[140:143], a[124:127], a[60:63], v[140:143]
    ds_read_b64_tr_b16 a[154:155], v186 offset:40960
    v_cvt_pk_bf16_f32 v145, v130, v131
    v_mfma_f32_16x16x32_bf16 v[4:7], a[160:163], v[148:151], v[4:7]
    v_exp_f32 v132, v132
    v_mfma_f32_16x16x32_bf16 v[20:23], a[164:167], v[148:151], v[20:23]
    ds_read_b64_tr_b16 a[156:157], v187 offset:32768
    buffer_load_dwordx4 a[252:255], v253, s[4:7], s46 offen offset:3072
    s_add_u32 s46, s46, 36864
    v_mfma_f32_16x16x32_bf16 v[36:39], a[168:171], v[148:151], v[36:39]
    v_exp_f32 v133, v133
    v_mfma_f32_16x16x32_bf16 v[52:55], a[172:175], v[148:151], v[52:55]
    ds_read_b64_tr_b16 a[158:159], v187 offset:40960
    v_cvt_pk_bf16_f32 v146, v132, v133
    v_mfma_f32_16x16x32_bf16 v[68:71], a[176:179], v[148:151], v[68:71]
    v_exp_f32 v134, v134
    v_mfma_f32_16x16x32_bf16 v[84:87], a[180:183], v[148:151], v[84:87]
    buffer_load_dwordx4 v253, s[4:7], s49 offen offset:3072 lds
    s_add_u32 s49, s49, 36864
    v_mfma_f32_16x16x32_bf16 v[100:103], a[184:187], v[148:151], v[100:103]
    v_exp_f32 v135, v135
    v_mfma_f32_16x16x32_bf16 v[116:119], a[188:191], v[148:151], v[116:119]
    v_cvt_pk_bf16_f32 v147, v134, v135
    v_mfma_f32_16x16x32_bf16 v[204:207], v[216:219], v[148:151], v[204:207]
    s_waitcnt vmcnt(40) lgkmcnt(0)
    s_barrier
    s_add_u32 m0, s35, 32768
    v_mfma_f32_16x16x32_bf16 v[128:131], a[64:67], a[0:3], v[152:155]
    v_exp_f32 v136, v136
    v_mfma_f32_16x16x32_bf16 v[128:131], a[68:71], a[4:7], v[128:131]
    ds_read_b128 a[96:99], v172 offset:49152
    v_mfma_f32_16x16x32_bf16 v[128:131], a[72:75], a[8:11], v[128:131]
    v_exp_f32 v137, v137
    v_mfma_f32_16x16x32_bf16 v[128:131], a[76:79], a[12:15], v[128:131]
    ds_read_b128 a[100:103], v173 offset:49152
    v_cvt_pk_bf16_f32 v148, v136, v137
    v_mfma_f32_16x16x32_bf16 v[132:135], a[80:83], a[0:3], v[152:155]
    v_exp_f32 v138, v138
    v_mfma_f32_16x16x32_bf16 v[132:135], a[84:87], a[4:7], v[132:135]
    ds_read_b128 a[104:107], v174 offset:49152
    v_mfma_f32_16x16x32_bf16 v[132:135], a[88:91], a[8:11], v[132:135]
    v_exp_f32 v139, v139
    v_mfma_f32_16x16x32_bf16 v[132:135], a[92:95], a[12:15], v[132:135]
    v_cvt_pk_bf16_f32 v149, v138, v139
    v_mfma_f32_16x16x32_bf16 v[8:11], a[160:163], v[144:147], v[8:11]
    v_exp_f32 v140, v140
    v_mfma_f32_16x16x32_bf16 v[24:27], a[164:167], v[144:147], v[24:27]
    ds_read_b128 a[108:111], v175 offset:49152
    v_mfma_f32_16x16x32_bf16 v[40:43], a[168:171], v[144:147], v[40:43]
    v_exp_f32 v141, v141
    v_mfma_f32_16x16x32_bf16 v[56:59], a[172:175], v[144:147], v[56:59]
    ds_read_b128 a[112:115], v172 offset:57344
    v_cvt_pk_bf16_f32 v150, v140, v141
    v_mfma_f32_16x16x32_bf16 v[72:75], a[176:179], v[144:147], v[72:75]
    v_exp_f32 v142, v142
    v_mfma_f32_16x16x32_bf16 v[88:91], a[180:183], v[144:147], v[88:91]
    ds_read_b128 a[116:119], v173 offset:57344
    v_mfma_f32_16x16x32_bf16 v[104:107], a[184:187], v[144:147], v[104:107]
    v_exp_f32 v143, v143
    v_mfma_f32_16x16x32_bf16 v[120:123], a[188:191], v[144:147], v[120:123]
    v_cvt_pk_bf16_f32 v151, v142, v143
    v_mfma_f32_16x16x32_bf16 v[208:211], v[216:219], v[144:147], v[208:211]
    buffer_load_dwordx4 v250, s[4:7], s49 offen offset:0 lds
    v_mfma_f32_16x16x32_bf16 v[136:139], a[64:67], a[16:19], v[156:159]
    v_exp_f32 v128, v128
    v_mfma_f32_16x16x32_bf16 v[136:139], a[68:71], a[20:23], v[136:139]
    ds_read_b128 a[120:123], v174 offset:57344
    v_mfma_f32_16x16x32_bf16 v[136:139], a[72:75], a[24:27], v[136:139]
    v_exp_f32 v129, v129
    v_mfma_f32_16x16x32_bf16 v[136:139], a[76:79], a[28:31], v[136:139]
    v_cvt_pk_bf16_f32 v144, v128, v129
    v_mfma_f32_16x16x32_bf16 v[140:143], a[80:83], a[16:19], v[156:159]
    v_exp_f32 v130, v130
    v_mfma_f32_16x16x32_bf16 v[140:143], a[84:87], a[20:23], v[140:143]
    ds_read_b128 a[124:127], v175 offset:57344
    v_mfma_f32_16x16x32_bf16 v[140:143], a[88:91], a[24:27], v[140:143]
    v_exp_f32 v131, v131
    v_mfma_f32_16x16x32_bf16 v[140:143], a[92:95], a[28:31], v[140:143]
    v_cvt_pk_bf16_f32 v145, v130, v131
    v_mfma_f32_16x16x32_bf16 v[12:15], a[160:163], v[148:151], v[12:15]
    v_exp_f32 v132, v132
    v_mfma_f32_16x16x32_bf16 v[28:31], a[164:167], v[148:151], v[28:31]
    ds_read_b64_tr_b16 a[160:161], v180 offset:49152
    v_mfma_f32_16x16x32_bf16 v[44:47], a[168:171], v[148:151], v[44:47]
    v_exp_f32 v133, v133
    v_mfma_f32_16x16x32_bf16 v[60:63], a[172:175], v[148:151], v[60:63]
    ds_read_b64_tr_b16 a[162:163], v180 offset:57344
    v_cvt_pk_bf16_f32 v146, v132, v133
    v_mfma_f32_16x16x32_bf16 v[76:79], a[176:179], v[148:151], v[76:79]
    v_exp_f32 v134, v134
    v_mfma_f32_16x16x32_bf16 v[92:95], a[180:183], v[148:151], v[92:95]
    ds_read_b64_tr_b16 a[164:165], v181 offset:49152
    v_mfma_f32_16x16x32_bf16 v[108:111], a[184:187], v[148:151], v[108:111]
    v_exp_f32 v135, v135
    v_mfma_f32_16x16x32_bf16 v[124:127], a[188:191], v[148:151], v[124:127]
    ds_read_b64_tr_b16 a[166:167], v181 offset:57344
    v_cvt_pk_bf16_f32 v147, v134, v135
    v_mfma_f32_16x16x32_bf16 v[212:215], v[216:219], v[148:151], v[212:215]
    buffer_load_dwordx4 v251, s[4:7], s49 offen offset:1024 lds
    v_mfma_f32_16x16x32_bf16 v[128:131], a[64:67], a[32:35], v[160:163]
    v_exp_f32 v136, v136
    v_mfma_f32_16x16x32_bf16 v[128:131], a[68:71], a[36:39], v[128:131]
    ds_read_b64_tr_b16 a[168:169], v182 offset:49152
    v_mfma_f32_16x16x32_bf16 v[128:131], a[72:75], a[40:43], v[128:131]
    v_exp_f32 v137, v137
    v_mfma_f32_16x16x32_bf16 v[128:131], a[76:79], a[44:47], v[128:131]
    ds_read_b64_tr_b16 a[170:171], v182 offset:57344
    v_cvt_pk_bf16_f32 v148, v136, v137
    v_mfma_f32_16x16x32_bf16 v[132:135], a[80:83], a[32:35], v[160:163]
    v_exp_f32 v138, v138
    v_mfma_f32_16x16x32_bf16 v[132:135], a[84:87], a[36:39], v[132:135]
    ds_read_b64_tr_b16 a[172:173], v183 offset:49152
    v_mfma_f32_16x16x32_bf16 v[132:135], a[88:91], a[40:43], v[132:135]
    v_exp_f32 v139, v139
    v_mfma_f32_16x16x32_bf16 v[132:135], a[92:95], a[44:47], v[132:135]
    v_cvt_pk_bf16_f32 v149, v138, v139
    v_mfma_f32_16x16x32_bf16 v[0:3], a[128:131], v[144:147], v[0:3]
    v_exp_f32 v140, v140
    v_mfma_f32_16x16x32_bf16 v[16:19], a[132:135], v[144:147], v[16:19]
    ds_read_b64_tr_b16 a[174:175], v183 offset:57344
    v_mfma_f32_16x16x32_bf16 v[32:35], a[136:139], v[144:147], v[32:35]
    v_exp_f32 v141, v141
    v_mfma_f32_16x16x32_bf16 v[48:51], a[140:143], v[144:147], v[48:51]
    ds_read_b64_tr_b16 a[176:177], v184 offset:49152
    v_cvt_pk_bf16_f32 v150, v140, v141
    v_mfma_f32_16x16x32_bf16 v[64:67], a[144:147], v[144:147], v[64:67]
    v_exp_f32 v142, v142
    v_mfma_f32_16x16x32_bf16 v[80:83], a[148:151], v[144:147], v[80:83]
    ds_read_b64_tr_b16 a[178:179], v184 offset:57344
    v_mfma_f32_16x16x32_bf16 v[96:99], a[152:155], v[144:147], v[96:99]
    v_exp_f32 v143, v143
    v_mfma_f32_16x16x32_bf16 v[112:115], a[156:159], v[144:147], v[112:115]
    v_cvt_pk_bf16_f32 v151, v142, v143
    v_mfma_f32_16x16x32_bf16 v[200:203], v[216:219], v[144:147], v[200:203]
    buffer_load_dwordx4 v252, s[4:7], s49 offen offset:2048 lds
    v_mfma_f32_16x16x32_bf16 v[136:139], a[64:67], a[48:51], v[164:167]
    v_exp_f32 v128, v128
    v_mfma_f32_16x16x32_bf16 v[136:139], a[68:71], a[52:55], v[136:139]
    ds_read_b64_tr_b16 a[180:181], v185 offset:49152
    v_mfma_f32_16x16x32_bf16 v[136:139], a[72:75], a[56:59], v[136:139]
    v_exp_f32 v129, v129
    v_mfma_f32_16x16x32_bf16 v[136:139], a[76:79], a[60:63], v[136:139]
    ds_read_b64_tr_b16 a[182:183], v185 offset:57344
    v_cvt_pk_bf16_f32 v144, v128, v129
    v_mfma_f32_16x16x32_bf16 v[140:143], a[80:83], a[48:51], v[164:167]
    v_exp_f32 v130, v130
    v_mfma_f32_16x16x32_bf16 v[140:143], a[84:87], a[52:55], v[140:143]
    ds_read_b64_tr_b16 a[184:185], v186 offset:49152
    v_mfma_f32_16x16x32_bf16 v[140:143], a[88:91], a[56:59], v[140:143]
    v_exp_f32 v131, v131
    v_mfma_f32_16x16x32_bf16 v[140:143], a[92:95], a[60:63], v[140:143]
    ds_read_b64_tr_b16 a[186:187], v186 offset:57344
    v_cvt_pk_bf16_f32 v145, v130, v131
    v_mfma_f32_16x16x32_bf16 v[4:7], a[128:131], v[148:151], v[4:7]
    v_exp_f32 v132, v132
    v_mfma_f32_16x16x32_bf16 v[20:23], a[132:135], v[148:151], v[20:23]
    ds_read_b64_tr_b16 a[188:189], v187 offset:49152
    v_mfma_f32_16x16x32_bf16 v[36:39], a[136:139], v[148:151], v[36:39]
    v_exp_f32 v133, v133
    v_mfma_f32_16x16x32_bf16 v[52:55], a[140:143], v[148:151], v[52:55]
    ds_read_b64_tr_b16 a[190:191], v187 offset:57344
    v_cvt_pk_bf16_f32 v146, v132, v133
    v_mfma_f32_16x16x32_bf16 v[68:71], a[144:147], v[148:151], v[68:71]
    v_exp_f32 v134, v134
    v_mfma_f32_16x16x32_bf16 v[84:87], a[148:151], v[148:151], v[84:87]
    buffer_load_dwordx4 v253, s[4:7], s49 offen offset:3072 lds
    s_add_u32 s49, s49, 36864
    v_mfma_f32_16x16x32_bf16 v[100:103], a[152:155], v[148:151], v[100:103]
    v_exp_f32 v135, v135
    v_mfma_f32_16x16x32_bf16 v[116:119], a[156:159], v[148:151], v[116:119]
    v_cvt_pk_bf16_f32 v147, v134, v135
    v_mfma_f32_16x16x32_bf16 v[204:207], v[216:219], v[148:151], v[204:207]
    s_waitcnt vmcnt(40) lgkmcnt(0)
    s_barrier
    s_add_u32 m0, s35, 49152
    v_mfma_f32_16x16x32_bf16 v[128:131], a[96:99], a[0:3], v[152:155]
    v_exp_f32 v136, v136
    v_mfma_f32_16x16x32_bf16 v[128:131], a[100:103], a[4:7], v[128:131]
    ds_read_b128 a[64:67], v176 offset:0
    v_mfma_f32_16x16x32_bf16 v[128:131], a[104:107], a[8:11], v[128:131]
    v_exp_f32 v137, v137
    v_mfma_f32_16x16x32_bf16 v[128:131], a[108:111], a[12:15], v[128:131]
    ds_read_b128 a[68:71], v177 offset:0
    v_cvt_pk_bf16_f32 v148, v136, v137
    v_mfma_f32_16x16x32_bf16 v[132:135], a[112:115], a[0:3], v[152:155]
    v_exp_f32 v138, v138
    v_mfma_f32_16x16x32_bf16 v[132:135], a[116:119], a[4:7], v[132:135]
    ds_read_b128 a[72:75], v178 offset:0
    v_mfma_f32_16x16x32_bf16 v[132:135], a[120:123], a[8:11], v[132:135]
    v_exp_f32 v139, v139
    v_mfma_f32_16x16x32_bf16 v[132:135], a[124:127], a[12:15], v[132:135]
    v_cvt_pk_bf16_f32 v149, v138, v139
    v_mfma_f32_16x16x32_bf16 v[8:11], a[128:131], v[144:147], v[8:11]
    v_exp_f32 v140, v140
    v_mfma_f32_16x16x32_bf16 v[24:27], a[132:135], v[144:147], v[24:27]
    ds_read_b128 a[76:79], v179 offset:0
    v_mfma_f32_16x16x32_bf16 v[40:43], a[136:139], v[144:147], v[40:43]
    v_exp_f32 v141, v141
    v_mfma_f32_16x16x32_bf16 v[56:59], a[140:143], v[144:147], v[56:59]
    ds_read_b128 a[80:83], v176 offset:8192
    v_cvt_pk_bf16_f32 v150, v140, v141
    v_mfma_f32_16x16x32_bf16 v[72:75], a[144:147], v[144:147], v[72:75]
    v_exp_f32 v142, v142
    v_mfma_f32_16x16x32_bf16 v[88:91], a[148:151], v[144:147], v[88:91]
    ds_read_b128 a[84:87], v177 offset:8192
    v_mfma_f32_16x16x32_bf16 v[104:107], a[152:155], v[144:147], v[104:107]
    v_exp_f32 v143, v143
    v_mfma_f32_16x16x32_bf16 v[120:123], a[156:159], v[144:147], v[120:123]
    v_cvt_pk_bf16_f32 v151, v142, v143
    v_mfma_f32_16x16x32_bf16 v[208:211], v[216:219], v[144:147], v[208:211]
    buffer_load_dwordx4 v250, s[4:7], s49 offen offset:0 lds
    v_mfma_f32_16x16x32_bf16 v[136:139], a[96:99], a[16:19], v[156:159]
    v_exp_f32 v128, v128
    v_mfma_f32_16x16x32_bf16 v[136:139], a[100:103], a[20:23], v[136:139]
    ds_read_b128 a[88:91], v178 offset:8192
    v_mfma_f32_16x16x32_bf16 v[136:139], a[104:107], a[24:27], v[136:139]
    v_exp_f32 v129, v129
    v_mfma_f32_16x16x32_bf16 v[136:139], a[108:111], a[28:31], v[136:139]
    v_cvt_pk_bf16_f32 v144, v128, v129
    v_mfma_f32_16x16x32_bf16 v[140:143], a[112:115], a[16:19], v[156:159]
    v_exp_f32 v130, v130
    v_mfma_f32_16x16x32_bf16 v[140:143], a[116:119], a[20:23], v[140:143]
    ds_read_b128 a[92:95], v179 offset:8192
    v_mfma_f32_16x16x32_bf16 v[140:143], a[120:123], a[24:27], v[140:143]
    v_exp_f32 v131, v131
    v_mfma_f32_16x16x32_bf16 v[140:143], a[124:127], a[28:31], v[140:143]
    v_cvt_pk_bf16_f32 v145, v130, v131
    v_mfma_f32_16x16x32_bf16 v[12:15], a[128:131], v[148:151], v[12:15]
    v_exp_f32 v132, v132
    v_mfma_f32_16x16x32_bf16 v[28:31], a[132:135], v[148:151], v[28:31]
    ds_read_b64_tr_b16 a[128:129], v188 offset:0
    v_mfma_f32_16x16x32_bf16 v[44:47], a[136:139], v[148:151], v[44:47]
    v_exp_f32 v133, v133
    v_mfma_f32_16x16x32_bf16 v[60:63], a[140:143], v[148:151], v[60:63]
    ds_read_b64_tr_b16 a[130:131], v188 offset:8192
    v_cvt_pk_bf16_f32 v146, v132, v133
    v_mfma_f32_16x16x32_bf16 v[76:79], a[144:147], v[148:151], v[76:79]
    v_exp_f32 v134, v134
    v_mfma_f32_16x16x32_bf16 v[92:95], a[148:151], v[148:151], v[92:95]
    ds_read_b64_tr_b16 a[132:133], v189 offset:0
    v_mfma_f32_16x16x32_bf16 v[108:111], a[152:155], v[148:151], v[108:111]
    v_exp_f32 v135, v135
    v_mfma_f32_16x16x32_bf16 v[124:127], a[156:159], v[148:151], v[124:127]
    ds_read_b64_tr_b16 a[134:135], v189 offset:8192
    v_cvt_pk_bf16_f32 v147, v134, v135
    v_mfma_f32_16x16x32_bf16 v[212:215], v[216:219], v[148:151], v[212:215]
    buffer_load_dwordx4 v251, s[4:7], s49 offen offset:1024 lds
    v_mfma_f32_16x16x32_bf16 v[128:131], a[96:99], a[32:35], v[160:163]
    v_exp_f32 v136, v136
    v_mfma_f32_16x16x32_bf16 v[128:131], a[100:103], a[36:39], v[128:131]
    ds_read_b64_tr_b16 a[136:137], v190 offset:0
    v_mfma_f32_16x16x32_bf16 v[128:131], a[104:107], a[40:43], v[128:131]
    v_exp_f32 v137, v137
    v_mfma_f32_16x16x32_bf16 v[128:131], a[108:111], a[44:47], v[128:131]
    ds_read_b64_tr_b16 a[138:139], v190 offset:8192
    v_cvt_pk_bf16_f32 v148, v136, v137
    v_mfma_f32_16x16x32_bf16 v[132:135], a[112:115], a[32:35], v[160:163]
    v_exp_f32 v138, v138
    v_mfma_f32_16x16x32_bf16 v[132:135], a[116:119], a[36:39], v[132:135]
    ds_read_b64_tr_b16 a[140:141], v191 offset:0
    v_mfma_f32_16x16x32_bf16 v[132:135], a[120:123], a[40:43], v[132:135]
    v_exp_f32 v139, v139
    v_mfma_f32_16x16x32_bf16 v[132:135], a[124:127], a[44:47], v[132:135]
    v_cvt_pk_bf16_f32 v149, v138, v139
    v_mfma_f32_16x16x32_bf16 v[0:3], a[160:163], v[144:147], v[0:3]
    v_exp_f32 v140, v140
    v_mfma_f32_16x16x32_bf16 v[16:19], a[164:167], v[144:147], v[16:19]
    ds_read_b64_tr_b16 a[142:143], v191 offset:8192
    v_mfma_f32_16x16x32_bf16 v[32:35], a[168:171], v[144:147], v[32:35]
    v_exp_f32 v141, v141
    v_mfma_f32_16x16x32_bf16 v[48:51], a[172:175], v[144:147], v[48:51]
    ds_read_b64_tr_b16 a[144:145], v192 offset:0
    v_cvt_pk_bf16_f32 v150, v140, v141
    v_mfma_f32_16x16x32_bf16 v[64:67], a[176:179], v[144:147], v[64:67]
    v_exp_f32 v142, v142
    v_mfma_f32_16x16x32_bf16 v[80:83], a[180:183], v[144:147], v[80:83]
    ds_read_b64_tr_b16 a[146:147], v192 offset:8192
    v_mfma_f32_16x16x32_bf16 v[96:99], a[184:187], v[144:147], v[96:99]
    v_exp_f32 v143, v143
    v_mfma_f32_16x16x32_bf16 v[112:115], a[188:191], v[144:147], v[112:115]
    v_cvt_pk_bf16_f32 v151, v142, v143
    v_mfma_f32_16x16x32_bf16 v[200:203], v[216:219], v[144:147], v[200:203]
    buffer_load_dwordx4 v252, s[4:7], s49 offen offset:2048 lds
    v_mfma_f32_16x16x32_bf16 v[136:139], a[96:99], a[48:51], v[164:167]
    v_exp_f32 v128, v128
    v_mfma_f32_16x16x32_bf16 v[136:139], a[100:103], a[52:55], v[136:139]
    ds_read_b64_tr_b16 a[148:149], v193 offset:0
    v_mfma_f32_16x16x32_bf16 v[136:139], a[104:107], a[56:59], v[136:139]
    v_exp_f32 v129, v129
    v_mfma_f32_16x16x32_bf16 v[136:139], a[108:111], a[60:63], v[136:139]
    ds_read_b64_tr_b16 a[150:151], v193 offset:8192
    v_cvt_pk_bf16_f32 v144, v128, v129
    v_mfma_f32_16x16x32_bf16 v[140:143], a[112:115], a[48:51], v[164:167]
    v_exp_f32 v130, v130
    v_mfma_f32_16x16x32_bf16 v[140:143], a[116:119], a[52:55], v[140:143]
    ds_read_b64_tr_b16 a[152:153], v194 offset:0
    v_mfma_f32_16x16x32_bf16 v[140:143], a[120:123], a[56:59], v[140:143]
    v_exp_f32 v131, v131
    v_mfma_f32_16x16x32_bf16 v[140:143], a[124:127], a[60:63], v[140:143]
    ds_read_b64_tr_b16 a[154:155], v194 offset:8192
    v_cvt_pk_bf16_f32 v145, v130, v131
    v_mfma_f32_16x16x32_bf16 v[4:7], a[160:163], v[148:151], v[4:7]
    v_exp_f32 v132, v132
    v_mfma_f32_16x16x32_bf16 v[20:23], a[164:167], v[148:151], v[20:23]
    ds_read_b64_tr_b16 a[156:157], v195 offset:0
    v_mfma_f32_16x16x32_bf16 v[36:39], a[168:171], v[148:151], v[36:39]
    v_exp_f32 v133, v133
    v_mfma_f32_16x16x32_bf16 v[52:55], a[172:175], v[148:151], v[52:55]
    ds_read_b64_tr_b16 a[158:159], v195 offset:8192
    v_cvt_pk_bf16_f32 v146, v132, v133
    v_mfma_f32_16x16x32_bf16 v[68:71], a[176:179], v[148:151], v[68:71]
    v_exp_f32 v134, v134
    v_mfma_f32_16x16x32_bf16 v[84:87], a[180:183], v[148:151], v[84:87]
    buffer_load_dwordx4 v253, s[4:7], s49 offen offset:3072 lds
    s_add_u32 s49, s49, 36864
    v_mfma_f32_16x16x32_bf16 v[100:103], a[184:187], v[148:151], v[100:103]
    v_exp_f32 v135, v135
    v_mfma_f32_16x16x32_bf16 v[116:119], a[188:191], v[148:151], v[116:119]
    v_cvt_pk_bf16_f32 v147, v134, v135
    v_mfma_f32_16x16x32_bf16 v[204:207], v[216:219], v[148:151], v[204:207]
    s_waitcnt vmcnt(40) lgkmcnt(0)
    s_barrier
    s_add_u32 m0, s35, 65536
    v_mfma_f32_16x16x32_bf16 v[128:131], a[64:67], a[0:3], v[152:155]
    v_exp_f32 v136, v136
    v_mfma_f32_16x16x32_bf16 v[128:131], a[68:71], a[4:7], v[128:131]
    ds_read_b128 a[96:99], v176 offset:16384
    v_mfma_f32_16x16x32_bf16 v[128:131], a[72:75], a[8:11], v[128:131]
    v_exp_f32 v137, v137
    v_mfma_f32_16x16x32_bf16 v[128:131], a[76:79], a[12:15], v[128:131]
    ds_read_b128 a[100:103], v177 offset:16384
    v_cvt_pk_bf16_f32 v148, v136, v137
    v_mfma_f32_16x16x32_bf16 v[132:135], a[80:83], a[0:3], v[152:155]
    v_exp_f32 v138, v138
    v_mfma_f32_16x16x32_bf16 v[132:135], a[84:87], a[4:7], v[132:135]
    ds_read_b128 a[104:107], v178 offset:16384
    v_mfma_f32_16x16x32_bf16 v[132:135], a[88:91], a[8:11], v[132:135]
    v_exp_f32 v139, v139
    v_mfma_f32_16x16x32_bf16 v[132:135], a[92:95], a[12:15], v[132:135]
    v_cvt_pk_bf16_f32 v149, v138, v139
    v_mfma_f32_16x16x32_bf16 v[8:11], a[160:163], v[144:147], v[8:11]
    v_exp_f32 v140, v140
    v_mfma_f32_16x16x32_bf16 v[24:27], a[164:167], v[144:147], v[24:27]
    ds_read_b128 a[108:111], v179 offset:16384
    v_mfma_f32_16x16x32_bf16 v[40:43], a[168:171], v[144:147], v[40:43]
    v_exp_f32 v141, v141
    v_mfma_f32_16x16x32_bf16 v[56:59], a[172:175], v[144:147], v[56:59]
    ds_read_b128 a[112:115], v176 offset:24576
    v_cvt_pk_bf16_f32 v150, v140, v141
    v_mfma_f32_16x16x32_bf16 v[72:75], a[176:179], v[144:147], v[72:75]
    v_exp_f32 v142, v142
    v_mfma_f32_16x16x32_bf16 v[88:91], a[180:183], v[144:147], v[88:91]
    ds_read_b128 a[116:119], v177 offset:24576
    v_mfma_f32_16x16x32_bf16 v[104:107], a[184:187], v[144:147], v[104:107]
    v_exp_f32 v143, v143
    v_mfma_f32_16x16x32_bf16 v[120:123], a[188:191], v[144:147], v[120:123]
    v_cvt_pk_bf16_f32 v151, v142, v143
    v_mfma_f32_16x16x32_bf16 v[208:211], v[216:219], v[144:147], v[208:211]
    buffer_load_dwordx4 v250, s[4:7], s49 offen offset:0 lds
    v_mfma_f32_16x16x32_bf16 v[136:139], a[64:67], a[16:19], v[156:159]
    v_exp_f32 v128, v128
    v_mfma_f32_16x16x32_bf16 v[136:139], a[68:71], a[20:23], v[136:139]
    ds_read_b128 a[120:123], v178 offset:24576
    v_mfma_f32_16x16x32_bf16 v[136:139], a[72:75], a[24:27], v[136:139]
    v_exp_f32 v129, v129
    v_mfma_f32_16x16x32_bf16 v[136:139], a[76:79], a[28:31], v[136:139]
    v_cvt_pk_bf16_f32 v144, v128, v129
    v_mfma_f32_16x16x32_bf16 v[140:143], a[80:83], a[16:19], v[156:159]
    v_exp_f32 v130, v130
    v_mfma_f32_16x16x32_bf16 v[140:143], a[84:87], a[20:23], v[140:143]
    ds_read_b128 a[124:127], v179 offset:24576
    v_mfma_f32_16x16x32_bf16 v[140:143], a[88:91], a[24:27], v[140:143]
    v_exp_f32 v131, v131
    v_mfma_f32_16x16x32_bf16 v[140:143], a[92:95], a[28:31], v[140:143]
    v_cvt_pk_bf16_f32 v145, v130, v131
    v_mfma_f32_16x16x32_bf16 v[12:15], a[160:163], v[148:151], v[12:15]
    v_exp_f32 v132, v132
    v_mfma_f32_16x16x32_bf16 v[28:31], a[164:167], v[148:151], v[28:31]
    ds_read_b64_tr_b16 a[160:161], v188 offset:16384
    v_mfma_f32_16x16x32_bf16 v[44:47], a[168:171], v[148:151], v[44:47]
    v_exp_f32 v133, v133
    v_mfma_f32_16x16x32_bf16 v[60:63], a[172:175], v[148:151], v[60:63]
    ds_read_b64_tr_b16 a[162:163], v188 offset:24576
    v_cvt_pk_bf16_f32 v146, v132, v133
    v_mfma_f32_16x16x32_bf16 v[76:79], a[176:179], v[148:151], v[76:79]
    v_exp_f32 v134, v134
    v_mfma_f32_16x16x32_bf16 v[92:95], a[180:183], v[148:151], v[92:95]
    ds_read_b64_tr_b16 a[164:165], v189 offset:16384
    v_mfma_f32_16x16x32_bf16 v[108:111], a[184:187], v[148:151], v[108:111]
    v_exp_f32 v135, v135
    v_mfma_f32_16x16x32_bf16 v[124:127], a[188:191], v[148:151], v[124:127]
    ds_read_b64_tr_b16 a[166:167], v189 offset:24576
    v_cvt_pk_bf16_f32 v147, v134, v135
    v_mfma_f32_16x16x32_bf16 v[212:215], v[216:219], v[148:151], v[212:215]
    buffer_load_dwordx4 v251, s[4:7], s49 offen offset:1024 lds
    v_mfma_f32_16x16x32_bf16 v[128:131], a[64:67], a[32:35], v[160:163]
    v_exp_f32 v136, v136
    v_mfma_f32_16x16x32_bf16 v[128:131], a[68:71], a[36:39], v[128:131]
    ds_read_b64_tr_b16 a[168:169], v190 offset:16384
    v_mfma_f32_16x16x32_bf16 v[128:131], a[72:75], a[40:43], v[128:131]
    v_exp_f32 v137, v137
    v_mfma_f32_16x16x32_bf16 v[128:131], a[76:79], a[44:47], v[128:131]
    ds_read_b64_tr_b16 a[170:171], v190 offset:24576
    v_cvt_pk_bf16_f32 v148, v136, v137
    v_mfma_f32_16x16x32_bf16 v[132:135], a[80:83], a[32:35], v[160:163]
    v_exp_f32 v138, v138
    v_mfma_f32_16x16x32_bf16 v[132:135], a[84:87], a[36:39], v[132:135]
    ds_read_b64_tr_b16 a[172:173], v191 offset:16384
    v_mfma_f32_16x16x32_bf16 v[132:135], a[88:91], a[40:43], v[132:135]
    v_exp_f32 v139, v139
    v_mfma_f32_16x16x32_bf16 v[132:135], a[92:95], a[44:47], v[132:135]
    v_cvt_pk_bf16_f32 v149, v138, v139
    v_mfma_f32_16x16x32_bf16 v[0:3], a[128:131], v[144:147], v[0:3]
    v_exp_f32 v140, v140
    v_mfma_f32_16x16x32_bf16 v[16:19], a[132:135], v[144:147], v[16:19]
    ds_read_b64_tr_b16 a[174:175], v191 offset:24576
    v_mfma_f32_16x16x32_bf16 v[32:35], a[136:139], v[144:147], v[32:35]
    v_exp_f32 v141, v141
    v_mfma_f32_16x16x32_bf16 v[48:51], a[140:143], v[144:147], v[48:51]
    ds_read_b64_tr_b16 a[176:177], v192 offset:16384
    v_cvt_pk_bf16_f32 v150, v140, v141
    v_mfma_f32_16x16x32_bf16 v[64:67], a[144:147], v[144:147], v[64:67]
    v_exp_f32 v142, v142
    v_mfma_f32_16x16x32_bf16 v[80:83], a[148:151], v[144:147], v[80:83]
    ds_read_b64_tr_b16 a[178:179], v192 offset:24576
    v_mfma_f32_16x16x32_bf16 v[96:99], a[152:155], v[144:147], v[96:99]
    v_exp_f32 v143, v143
    v_mfma_f32_16x16x32_bf16 v[112:115], a[156:159], v[144:147], v[112:115]
    v_cvt_pk_bf16_f32 v151, v142, v143
    v_mfma_f32_16x16x32_bf16 v[200:203], v[216:219], v[144:147], v[200:203]
    buffer_load_dwordx4 v252, s[4:7], s49 offen offset:2048 lds
    v_mfma_f32_16x16x32_bf16 v[136:139], a[64:67], a[48:51], v[164:167]
    v_exp_f32 v128, v128
    v_mfma_f32_16x16x32_bf16 v[136:139], a[68:71], a[52:55], v[136:139]
    ds_read_b64_tr_b16 a[180:181], v193 offset:16384
    v_mfma_f32_16x16x32_bf16 v[136:139], a[72:75], a[56:59], v[136:139]
    v_exp_f32 v129, v129
    v_mfma_f32_16x16x32_bf16 v[136:139], a[76:79], a[60:63], v[136:139]
    ds_read_b64_tr_b16 a[182:183], v193 offset:24576
    v_cvt_pk_bf16_f32 v144, v128, v129
    v_mfma_f32_16x16x32_bf16 v[140:143], a[80:83], a[48:51], v[164:167]
    v_exp_f32 v130, v130
    v_mfma_f32_16x16x32_bf16 v[140:143], a[84:87], a[52:55], v[140:143]
    ds_read_b64_tr_b16 a[184:185], v194 offset:16384
    v_mfma_f32_16x16x32_bf16 v[140:143], a[88:91], a[56:59], v[140:143]
    v_exp_f32 v131, v131
    v_mfma_f32_16x16x32_bf16 v[140:143], a[92:95], a[60:63], v[140:143]
    ds_read_b64_tr_b16 a[186:187], v194 offset:24576
    v_cvt_pk_bf16_f32 v145, v130, v131
    v_mfma_f32_16x16x32_bf16 v[4:7], a[128:131], v[148:151], v[4:7]
    v_exp_f32 v132, v132
    v_mfma_f32_16x16x32_bf16 v[20:23], a[132:135], v[148:151], v[20:23]
    ds_read_b64_tr_b16 a[188:189], v195 offset:16384
    v_mfma_f32_16x16x32_bf16 v[36:39], a[136:139], v[148:151], v[36:39]
    v_exp_f32 v133, v133
    v_mfma_f32_16x16x32_bf16 v[52:55], a[140:143], v[148:151], v[52:55]
    ds_read_b64_tr_b16 a[190:191], v195 offset:24576
    v_cvt_pk_bf16_f32 v146, v132, v133
    v_mfma_f32_16x16x32_bf16 v[68:71], a[144:147], v[148:151], v[68:71]
    v_exp_f32 v134, v134
    v_mfma_f32_16x16x32_bf16 v[84:87], a[148:151], v[148:151], v[84:87]
    buffer_load_dwordx4 v253, s[4:7], s49 offen offset:3072 lds
    s_add_u32 s49, s49, 36864
    v_mfma_f32_16x16x32_bf16 v[100:103], a[152:155], v[148:151], v[100:103]
    v_exp_f32 v135, v135
    v_mfma_f32_16x16x32_bf16 v[116:119], a[156:159], v[148:151], v[116:119]
    v_cvt_pk_bf16_f32 v147, v134, v135
    v_mfma_f32_16x16x32_bf16 v[204:207], v[216:219], v[148:151], v[204:207]
    s_waitcnt vmcnt(20) lgkmcnt(0)
    s_barrier
    s_add_u32 m0, s35, 81920
    v_mfma_f32_16x16x32_bf16 v[128:131], a[96:99], a[0:3], v[152:155]
    v_exp_f32 v136, v136
    v_mfma_f32_16x16x32_bf16 v[128:131], a[100:103], a[4:7], v[128:131]
    v_mfma_f32_16x16x32_bf16 v[128:131], a[104:107], a[8:11], v[128:131]
    v_exp_f32 v137, v137
    v_mfma_f32_16x16x32_bf16 v[128:131], a[108:111], a[12:15], v[128:131]
    v_cvt_pk_bf16_f32 v148, v136, v137
    v_mfma_f32_16x16x32_bf16 v[132:135], a[112:115], a[0:3], v[152:155]
    v_exp_f32 v138, v138
    v_mfma_f32_16x16x32_bf16 v[132:135], a[116:119], a[4:7], v[132:135]
    buffer_load_dwordx4 a[64:67], v250, s[4:7], s46 offen offset:0
    v_mfma_f32_16x16x32_bf16 v[132:135], a[120:123], a[8:11], v[132:135]
    v_exp_f32 v139, v139
    v_mfma_f32_16x16x32_bf16 v[132:135], a[124:127], a[12:15], v[132:135]
    v_cvt_pk_bf16_f32 v149, v138, v139
    v_mfma_f32_16x16x32_bf16 v[8:11], a[128:131], v[144:147], v[8:11]
    v_exp_f32 v140, v140
    v_mfma_f32_16x16x32_bf16 v[24:27], a[132:135], v[144:147], v[24:27]
    buffer_load_dwordx4 a[68:71], v251, s[4:7], s46 offen offset:1024
    v_mfma_f32_16x16x32_bf16 v[40:43], a[136:139], v[144:147], v[40:43]
    v_exp_f32 v141, v141
    v_mfma_f32_16x16x32_bf16 v[56:59], a[140:143], v[144:147], v[56:59]
    v_cvt_pk_bf16_f32 v150, v140, v141
    v_mfma_f32_16x16x32_bf16 v[72:75], a[144:147], v[144:147], v[72:75]
    v_exp_f32 v142, v142
    v_mfma_f32_16x16x32_bf16 v[88:91], a[148:151], v[144:147], v[88:91]
    v_mfma_f32_16x16x32_bf16 v[104:107], a[152:155], v[144:147], v[104:107]
    v_exp_f32 v143, v143
    v_mfma_f32_16x16x32_bf16 v[120:123], a[156:159], v[144:147], v[120:123]
    v_cvt_pk_bf16_f32 v151, v142, v143
    v_mfma_f32_16x16x32_bf16 v[208:211], v[216:219], v[144:147], v[208:211]
    buffer_load_dwordx4 v250, s[4:7], s49 offen offset:0 lds
    v_mfma_f32_16x16x32_bf16 v[136:139], a[96:99], a[16:19], v[156:159]
    v_exp_f32 v128, v128
    v_mfma_f32_16x16x32_bf16 v[136:139], a[100:103], a[20:23], v[136:139]
    v_mfma_f32_16x16x32_bf16 v[136:139], a[104:107], a[24:27], v[136:139]
    v_exp_f32 v129, v129
    v_mfma_f32_16x16x32_bf16 v[136:139], a[108:111], a[28:31], v[136:139]
    v_cvt_pk_bf16_f32 v144, v128, v129
    v_mfma_f32_16x16x32_bf16 v[140:143], a[112:115], a[16:19], v[156:159]
    v_exp_f32 v130, v130
    v_mfma_f32_16x16x32_bf16 v[140:143], a[116:119], a[20:23], v[140:143]
    buffer_load_dwordx4 a[72:75], v252, s[4:7], s46 offen offset:2048
    v_mfma_f32_16x16x32_bf16 v[140:143], a[120:123], a[24:27], v[140:143]
    v_exp_f32 v131, v131
    v_mfma_f32_16x16x32_bf16 v[140:143], a[124:127], a[28:31], v[140:143]
    v_cvt_pk_bf16_f32 v145, v130, v131
    v_mfma_f32_16x16x32_bf16 v[12:15], a[128:131], v[148:151], v[12:15]
    v_exp_f32 v132, v132
    v_mfma_f32_16x16x32_bf16 v[28:31], a[132:135], v[148:151], v[28:31]
    buffer_load_dwordx4 a[76:79], v253, s[4:7], s46 offen offset:3072
    s_add_u32 s46, s46, 36864
    v_mfma_f32_16x16x32_bf16 v[44:47], a[136:139], v[148:151], v[44:47]
    v_exp_f32 v133, v133
    v_mfma_f32_16x16x32_bf16 v[60:63], a[140:143], v[148:151], v[60:63]
    v_cvt_pk_bf16_f32 v146, v132, v133
    v_mfma_f32_16x16x32_bf16 v[76:79], a[144:147], v[148:151], v[76:79]
    v_exp_f32 v134, v134
    v_mfma_f32_16x16x32_bf16 v[92:95], a[148:151], v[148:151], v[92:95]
    v_mfma_f32_16x16x32_bf16 v[108:111], a[152:155], v[148:151], v[108:111]
    v_exp_f32 v135, v135
    v_mfma_f32_16x16x32_bf16 v[124:127], a[156:159], v[148:151], v[124:127]
    v_cvt_pk_bf16_f32 v147, v134, v135
    v_mfma_f32_16x16x32_bf16 v[212:215], v[216:219], v[148:151], v[212:215]
    buffer_load_dwordx4 v251, s[4:7], s49 offen offset:1024 lds
    v_mfma_f32_16x16x32_bf16 v[128:131], a[96:99], a[32:35], v[160:163]
    v_exp_f32 v136, v136
    v_mfma_f32_16x16x32_bf16 v[128:131], a[100:103], a[36:39], v[128:131]
    v_mfma_f32_16x16x32_bf16 v[128:131], a[104:107], a[40:43], v[128:131]
    v_exp_f32 v137, v137
    v_mfma_f32_16x16x32_bf16 v[128:131], a[108:111], a[44:47], v[128:131]
    v_cvt_pk_bf16_f32 v148, v136, v137
    v_mfma_f32_16x16x32_bf16 v[132:135], a[112:115], a[32:35], v[160:163]
    v_exp_f32 v138, v138
    v_mfma_f32_16x16x32_bf16 v[132:135], a[116:119], a[36:39], v[132:135]
    buffer_load_dwordx4 a[80:83], v250, s[4:7], s46 offen offset:0
    v_mfma_f32_16x16x32_bf16 v[132:135], a[120:123], a[40:43], v[132:135]
    v_exp_f32 v139, v139
    v_mfma_f32_16x16x32_bf16 v[132:135], a[124:127], a[44:47], v[132:135]
    v_cvt_pk_bf16_f32 v149, v138, v139
    v_mfma_f32_16x16x32_bf16 v[0:3], a[160:163], v[144:147], v[0:3]
    v_exp_f32 v140, v140
    v_mfma_f32_16x16x32_bf16 v[16:19], a[164:167], v[144:147], v[16:19]
    buffer_load_dwordx4 a[84:87], v251, s[4:7], s46 offen offset:1024
    v_mfma_f32_16x16x32_bf16 v[32:35], a[168:171], v[144:147], v[32:35]
    v_exp_f32 v141, v141
    v_mfma_f32_16x16x32_bf16 v[48:51], a[172:175], v[144:147], v[48:51]
    v_cvt_pk_bf16_f32 v150, v140, v141
    v_mfma_f32_16x16x32_bf16 v[64:67], a[176:179], v[144:147], v[64:67]
    v_exp_f32 v142, v142
    v_mfma_f32_16x16x32_bf16 v[80:83], a[180:183], v[144:147], v[80:83]
    v_mfma_f32_16x16x32_bf16 v[96:99], a[184:187], v[144:147], v[96:99]
    v_exp_f32 v143, v143
    v_mfma_f32_16x16x32_bf16 v[112:115], a[188:191], v[144:147], v[112:115]
    v_cvt_pk_bf16_f32 v151, v142, v143
    v_mfma_f32_16x16x32_bf16 v[200:203], v[216:219], v[144:147], v[200:203]
    buffer_load_dwordx4 v252, s[4:7], s49 offen offset:2048 lds
    v_mfma_f32_16x16x32_bf16 v[136:139], a[96:99], a[48:51], v[164:167]
    v_exp_f32 v128, v128
    v_mfma_f32_16x16x32_bf16 v[136:139], a[100:103], a[52:55], v[136:139]
    v_mfma_f32_16x16x32_bf16 v[136:139], a[104:107], a[56:59], v[136:139]
    v_exp_f32 v129, v129
    v_mfma_f32_16x16x32_bf16 v[136:139], a[108:111], a[60:63], v[136:139]
    v_cvt_pk_bf16_f32 v144, v128, v129
    v_mfma_f32_16x16x32_bf16 v[140:143], a[112:115], a[48:51], v[164:167]
    v_exp_f32 v130, v130
    v_mfma_f32_16x16x32_bf16 v[140:143], a[116:119], a[52:55], v[140:143]
    buffer_load_dwordx4 a[88:91], v252, s[4:7], s46 offen offset:2048
    v_mfma_f32_16x16x32_bf16 v[140:143], a[120:123], a[56:59], v[140:143]
    v_exp_f32 v131, v131
    v_mfma_f32_16x16x32_bf16 v[140:143], a[124:127], a[60:63], v[140:143]
    v_cvt_pk_bf16_f32 v145, v130, v131
    v_mfma_f32_16x16x32_bf16 v[4:7], a[160:163], v[148:151], v[4:7]
    v_exp_f32 v132, v132
    v_mfma_f32_16x16x32_bf16 v[20:23], a[164:167], v[148:151], v[20:23]
    buffer_load_dwordx4 a[92:95], v253, s[4:7], s46 offen offset:3072
    s_add_u32 s46, s46, 36864
    v_mfma_f32_16x16x32_bf16 v[36:39], a[168:171], v[148:151], v[36:39]
    v_exp_f32 v133, v133
    v_mfma_f32_16x16x32_bf16 v[52:55], a[172:175], v[148:151], v[52:55]
    v_cvt_pk_bf16_f32 v146, v132, v133
    v_mfma_f32_16x16x32_bf16 v[68:71], a[176:179], v[148:151], v[68:71]
    v_exp_f32 v134, v134
    v_mfma_f32_16x16x32_bf16 v[84:87], a[180:183], v[148:151], v[84:87]
    buffer_load_dwordx4 v253, s[4:7], s49 offen offset:3072 lds
    s_add_u32 s49, s49, 36864
    v_mfma_f32_16x16x32_bf16 v[100:103], a[184:187], v[148:151], v[100:103]
    v_exp_f32 v135, v135
    v_mfma_f32_16x16x32_bf16 v[116:119], a[188:191], v[148:151], v[116:119]
    v_cvt_pk_bf16_f32 v147, v134, v135
    v_mfma_f32_16x16x32_bf16 v[204:207], v[216:219], v[148:151], v[204:207]
    s_add_u32 m0, s35, 131072
    s_nop 0
    buffer_load_dwordx4 v250, s[4:7], s49 offen offset:0 lds
    buffer_load_dwordx4 v251, s[4:7], s49 offen offset:1024 lds
    buffer_load_dwordx4 v252, s[4:7], s49 offen offset:2048 lds
    buffer_load_dwordx4 v253, s[4:7], s49 offen offset:3072 lds
    s_add_u32 s49, s49, 36864
    s_nop 0
    v_exp_f32 v136, v136
    s_nop 0
    buffer_load_dwordx4 a[128:131], v250, s[4:7], s46 offen offset:0
    s_nop 0
    v_exp_f32 v137, v137
    s_nop 0
    v_cvt_pk_bf16_f32 v148, v136, v137
    s_nop 0
    v_exp_f32 v138, v138
    s_nop 0
    buffer_load_dwordx4 a[132:135], v251, s[4:7], s46 offen offset:1024
    s_nop 0
    v_exp_f32 v139, v139
    s_nop 0
    v_cvt_pk_bf16_f32 v149, v138, v139
    v_mfma_f32_16x16x32_bf16 v[8:11], a[160:163], v[144:147], v[8:11]
    v_exp_f32 v140, v140
    v_mfma_f32_16x16x32_bf16 v[24:27], a[164:167], v[144:147], v[24:27]
    buffer_load_dwordx4 a[136:139], v252, s[4:7], s46 offen offset:2048
    v_mfma_f32_16x16x32_bf16 v[40:43], a[168:171], v[144:147], v[40:43]
    v_exp_f32 v141, v141
    v_mfma_f32_16x16x32_bf16 v[56:59], a[172:175], v[144:147], v[56:59]
    v_cvt_pk_bf16_f32 v150, v140, v141
    v_mfma_f32_16x16x32_bf16 v[72:75], a[176:179], v[144:147], v[72:75]
    v_exp_f32 v142, v142
    v_mfma_f32_16x16x32_bf16 v[88:91], a[180:183], v[144:147], v[88:91]
    buffer_load_dwordx4 a[140:143], v253, s[4:7], s46 offen offset:3072
    s_add_u32 s46, s46, 36864
    v_mfma_f32_16x16x32_bf16 v[104:107], a[184:187], v[144:147], v[104:107]
    v_exp_f32 v143, v143
    v_mfma_f32_16x16x32_bf16 v[120:123], a[188:191], v[144:147], v[120:123]
    v_cvt_pk_bf16_f32 v151, v142, v143
    v_mfma_f32_16x16x32_bf16 v[208:211], v[216:219], v[144:147], v[208:211]
    s_nop 1
    v_mfma_f32_16x16x32_bf16 v[12:15], a[160:163], v[148:151], v[12:15]
    buffer_load_dwordx4 a[144:147], v250, s[4:7], s46 offen offset:0
    v_mfma_f32_16x16x32_bf16 v[28:31], a[164:167], v[148:151], v[28:31]
    v_mfma_f32_16x16x32_bf16 v[44:47], a[168:171], v[148:151], v[44:47]
    buffer_load_dwordx4 a[148:151], v251, s[4:7], s46 offen offset:1024
    v_mfma_f32_16x16x32_bf16 v[60:63], a[172:175], v[148:151], v[60:63]
    v_mfma_f32_16x16x32_bf16 v[76:79], a[176:179], v[148:151], v[76:79]
    buffer_load_dwordx4 a[152:155], v252, s[4:7], s46 offen offset:2048
    v_mfma_f32_16x16x32_bf16 v[92:95], a[180:183], v[148:151], v[92:95]
    v_mfma_f32_16x16x32_bf16 v[108:111], a[184:187], v[148:151], v[108:111]
    buffer_load_dwordx4 a[156:159], v253, s[4:7], s46 offen offset:3072
    s_add_u32 s46, s46, 36864
    v_mfma_f32_16x16x32_bf16 v[124:127], a[188:191], v[148:151], v[124:127]
    v_mfma_f32_16x16x32_bf16 v[212:215], v[216:219], v[148:151], v[212:215]
L_join:
    s_waitcnt vmcnt(47)
    s_nop 7
    v_mov_b32 v168, v200
    v_mov_b32 v169, v204
    v_mov_b32 v170, v208
    v_mov_b32 v171, v212
    s_mov_b32 s38, 0x53800000
    v_max_f32 v228, v168, v169
    v_cmp_ngt_f32 vcc, s38, v168
    v_cmp_ngt_f32 s[62:63], s38, v169
    s_nop 1
    s_or_b64 s[62:63], vcc, s[62:63]
    v_cmp_ngt_f32 vcc, s38, v170
    s_nop 3
    s_or_b64 s[62:63], vcc, s[62:63]
    v_cmp_ngt_f32 vcc, s38, v171
    v_mov_b32 v229, s24
    v_lshlrev_b32 v229, 2, v229
    v_add_u32 v229, 147456, v229
    s_or_b64 vcc, vcc, s[62:63]
    s_cmp_lg_u64 vcc, 0
    s_cselect_b32 s38, 1, 0
    v_mov_b32 v228, s38
    ds_write_b32 v229, v228
    v_rcp_f32 v168, v168
    v_rcp_f32 v169, v169
    v_rcp_f32 v170, v170
    v_rcp_f32 v171, v171
    v_lshlrev_b32 v236, 4, v227
    s_lshl_b32 s38, s24, 19
    v_pk_mul_f32 v[0:1], v[0:1], v[168:169] op_sel_hi:[1,0]
    v_pk_mul_f32 v[2:3], v[2:3], v[168:169] op_sel_hi:[1,0]
    v_pk_mul_f32 v[16:17], v[16:17], v[168:169] op_sel_hi:[1,0]
    v_pk_mul_f32 v[18:19], v[18:19], v[168:169] op_sel_hi:[1,0]
    v_cvt_pk_bf16_f32 v128, v0, v1
    v_cvt_pk_bf16_f32 v129, v2, v3
    v_cvt_pk_bf16_f32 v130, v16, v17
    v_cvt_pk_bf16_f32 v131, v18, v19
    buffer_store_dwordx4 v[128:131], v236, s[20:23], s38 offen offset:0 sc1
    v_pk_mul_f32 v[32:33], v[32:33], v[168:169] op_sel_hi:[1,0]
    v_pk_mul_f32 v[34:35], v[34:35], v[168:169] op_sel_hi:[1,0]
    v_pk_mul_f32 v[48:49], v[48:49], v[168:169] op_sel_hi:[1,0]
    v_pk_mul_f32 v[50:51], v[50:51], v[168:169] op_sel_hi:[1,0]
    v_cvt_pk_bf16_f32 v132, v32, v33
    v_cvt_pk_bf16_f32 v133, v34, v35
    v_cvt_pk_bf16_f32 v134, v48, v49
    v_cvt_pk_bf16_f32 v135, v50, v51
    buffer_store_dwordx4 v[132:135], v236, s[20:23], s38 offen offset:1024 sc1
    v_pk_mul_f32 v[64:65], v[64:65], v[168:169] op_sel_hi:[1,0]
    v_pk_mul_f32 v[66:67], v[66:67], v[168:169] op_sel_hi:[1,0]
    v_pk_mul_f32 v[80:81], v[80:81], v[168:169] op_sel_hi:[1,0]
    v_pk_mul_f32 v[82:83], v[82:83], v[168:169] op_sel_hi:[1,0]
    v_cvt_pk_bf16_f32 v136, v64, v65
    v_cvt_pk_bf16_f32 v137, v66, v67
    v_cvt_pk_bf16_f32 v138, v80, v81
    v_cvt_pk_bf16_f32 v139, v82, v83
    buffer_store_dwordx4 v[136:139], v236, s[20:23], s38 offen offset:2048 sc1
    v_pk_mul_f32 v[96:97], v[96:97], v[168:169] op_sel_hi:[1,0]
    v_pk_mul_f32 v[98:99], v[98:99], v[168:169] op_sel_hi:[1,0]
    v_pk_mul_f32 v[112:113], v[112:113], v[168:169] op_sel_hi:[1,0]
    v_pk_mul_f32 v[114:115], v[114:115], v[168:169] op_sel_hi:[1,0]
    v_cvt_pk_bf16_f32 v140, v96, v97
    v_cvt_pk_bf16_f32 v141, v98, v99
    v_cvt_pk_bf16_f32 v142, v112, v113
    v_cvt_pk_bf16_f32 v143, v114, v115
    buffer_store_dwordx4 v[140:143], v236, s[20:23], s38 offen offset:3072 sc1
    s_add_u32 s38, s38, 0x20000
    v_pk_mul_f32 v[4:5], v[4:5], v[168:169] op_sel:[0,1] op_sel_hi:[1,1]
    v_pk_mul_f32 v[6:7], v[6:7], v[168:169] op_sel:[0,1] op_sel_hi:[1,1]
    v_pk_mul_f32 v[20:21], v[20:21], v[168:169] op_sel:[0,1] op_sel_hi:[1,1]
    v_pk_mul_f32 v[22:23], v[22:23], v[168:169] op_sel:[0,1] op_sel_hi:[1,1]
    v_cvt_pk_bf16_f32 v144, v4, v5
    v_cvt_pk_bf16_f32 v145, v6, v7
    v_cvt_pk_bf16_f32 v146, v20, v21
    v_cvt_pk_bf16_f32 v147, v22, v23
    buffer_store_dwordx4 v[144:147], v236, s[20:23], s38 offen offset:0 sc1
    v_pk_mul_f32 v[36:37], v[36:37], v[168:169] op_sel:[0,1] op_sel_hi:[1,1]
    v_pk_mul_f32 v[38:39], v[38:39], v[168:169] op_sel:[0,1] op_sel_hi:[1,1]
    v_pk_mul_f32 v[52:53], v[52:53], v[168:169] op_sel:[0,1] op_sel_hi:[1,1]
    v_pk_mul_f32 v[54:55], v[54:55], v[168:169] op_sel:[0,1] op_sel_hi:[1,1]
    v_cvt_pk_bf16_f32 v148, v36, v37
    v_cvt_pk_bf16_f32 v149, v38, v39
    v_cvt_pk_bf16_f32 v150, v52, v53
    v_cvt_pk_bf16_f32 v151, v54, v55
    buffer_store_dwordx4 v[148:151], v236, s[20:23], s38 offen offset:1024 sc1
    v_pk_mul_f32 v[68:69], v[68:69], v[168:169] op_sel:[0,1] op_sel_hi:[1,1]
    v_pk_mul_f32 v[70:71], v[70:71], v[168:169] op_sel:[0,1] op_sel_hi:[1,1]
    v_pk_mul_f32 v[84:85], v[84:85], v[168:169] op_sel:[0,1] op_sel_hi:[1,1]
    v_pk_mul_f32 v[86:87], v[86:87], v[168:169] op_sel:[0,1] op_sel_hi:[1,1]
    v_cvt_pk_bf16_f32 v152, v68, v69
    v_cvt_pk_bf16_f32 v153, v70, v71
    v_cvt_pk_bf16_f32 v154, v84, v85
    v_cvt_pk_bf16_f32 v155, v86, v87
    buffer_store_dwordx4 v[152:155], v236, s[20:23], s38 offen offset:2048 sc1
    v_pk_mul_f32 v[100:101], v[100:101], v[168:169] op_sel:[0,1] op_sel_hi:[1,1]
    v_pk_mul_f32 v[102:103], v[102:103], v[168:169] op_sel:[0,1] op_sel_hi:[1,1]
    v_pk_mul_f32 v[116:117], v[116:117], v[168:169] op_sel:[0,1] op_sel_hi:[1,1]
    v_pk_mul_f32 v[118:119], v[118:119], v[168:169] op_sel:[0,1] op_sel_hi:[1,1]
    v_cvt_pk_bf16_f32 v156, v100, v101
    v_cvt_pk_bf16_f32 v157, v102, v103
    v_cvt_pk_bf16_f32 v158, v116, v117
    v_cvt_pk_bf16_f32 v159, v118, v119
    buffer_store_dwordx4 v[156:159], v236, s[20:23], s38 offen offset:3072 sc1
    s_add_u32 s38, s38, 0x20000
    v_pk_mul_f32 v[8:9], v[8:9], v[170:171] op_sel_hi:[1,0]
    v_pk_mul_f32 v[10:11], v[10:11], v[170:171] op_sel_hi:[1,0]
    v_pk_mul_f32 v[24:25], v[24:25], v[170:171] op_sel_hi:[1,0]
    v_pk_mul_f32 v[26:27], v[26:27], v[170:171] op_sel_hi:[1,0]
    v_cvt_pk_bf16_f32 v128, v8, v9
    v_cvt_pk_bf16_f32 v129, v10, v11
    v_cvt_pk_bf16_f32 v130, v24, v25
    v_cvt_pk_bf16_f32 v131, v26, v27
    buffer_store_dwordx4 v[128:131], v236, s[20:23], s38 offen offset:0 sc1
    v_pk_mul_f32 v[40:41], v[40:41], v[170:171] op_sel_hi:[1,0]
    v_pk_mul_f32 v[42:43], v[42:43], v[170:171] op_sel_hi:[1,0]
    v_pk_mul_f32 v[56:57], v[56:57], v[170:171] op_sel_hi:[1,0]
    v_pk_mul_f32 v[58:59], v[58:59], v[170:171] op_sel_hi:[1,0]
    v_cvt_pk_bf16_f32 v132, v40, v41
    v_cvt_pk_bf16_f32 v133, v42, v43
    v_cvt_pk_bf16_f32 v134, v56, v57
    v_cvt_pk_bf16_f32 v135, v58, v59
    buffer_store_dwordx4 v[132:135], v236, s[20:23], s38 offen offset:1024 sc1
    v_pk_mul_f32 v[72:73], v[72:73], v[170:171] op_sel_hi:[1,0]
    v_pk_mul_f32 v[74:75], v[74:75], v[170:171] op_sel_hi:[1,0]
    v_pk_mul_f32 v[88:89], v[88:89], v[170:171] op_sel_hi:[1,0]
    v_pk_mul_f32 v[90:91], v[90:91], v[170:171] op_sel_hi:[1,0]
    v_cvt_pk_bf16_f32 v136, v72, v73
    v_cvt_pk_bf16_f32 v137, v74, v75
    v_cvt_pk_bf16_f32 v138, v88, v89
    v_cvt_pk_bf16_f32 v139, v90, v91
    buffer_store_dwordx4 v[136:139], v236, s[20:23], s38 offen offset:2048 sc1
    v_pk_mul_f32 v[104:105], v[104:105], v[170:171] op_sel_hi:[1,0]
    v_pk_mul_f32 v[106:107], v[106:107], v[170:171] op_sel_hi:[1,0]
    v_pk_mul_f32 v[120:121], v[120:121], v[170:171] op_sel_hi:[1,0]
    v_pk_mul_f32 v[122:123], v[122:123], v[170:171] op_sel_hi:[1,0]
    v_cvt_pk_bf16_f32 v140, v104, v105
    v_cvt_pk_bf16_f32 v141, v106, v107
    v_cvt_pk_bf16_f32 v142, v120, v121
    v_cvt_pk_bf16_f32 v143, v122, v123
    buffer_store_dwordx4 v[140:143], v236, s[20:23], s38 offen offset:3072 sc1
    s_add_u32 s38, s38, 0x20000
    v_pk_mul_f32 v[12:13], v[12:13], v[170:171] op_sel:[0,1] op_sel_hi:[1,1]
    v_pk_mul_f32 v[14:15], v[14:15], v[170:171] op_sel:[0,1] op_sel_hi:[1,1]
    v_pk_mul_f32 v[28:29], v[28:29], v[170:171] op_sel:[0,1] op_sel_hi:[1,1]
    v_pk_mul_f32 v[30:31], v[30:31], v[170:171] op_sel:[0,1] op_sel_hi:[1,1]
    v_cvt_pk_bf16_f32 v144, v12, v13
    v_cvt_pk_bf16_f32 v145, v14, v15
    v_cvt_pk_bf16_f32 v146, v28, v29
    v_cvt_pk_bf16_f32 v147, v30, v31
    buffer_store_dwordx4 v[144:147], v236, s[20:23], s38 offen offset:0 sc1
    v_pk_mul_f32 v[44:45], v[44:45], v[170:171] op_sel:[0,1] op_sel_hi:[1,1]
    v_pk_mul_f32 v[46:47], v[46:47], v[170:171] op_sel:[0,1] op_sel_hi:[1,1]
    v_pk_mul_f32 v[60:61], v[60:61], v[170:171] op_sel:[0,1] op_sel_hi:[1,1]
    v_pk_mul_f32 v[62:63], v[62:63], v[170:171] op_sel:[0,1] op_sel_hi:[1,1]
    v_cvt_pk_bf16_f32 v148, v44, v45
    v_cvt_pk_bf16_f32 v149, v46, v47
    v_cvt_pk_bf16_f32 v150, v60, v61
    v_cvt_pk_bf16_f32 v151, v62, v63
    buffer_store_dwordx4 v[148:151], v236, s[20:23], s38 offen offset:1024 sc1
    v_pk_mul_f32 v[76:77], v[76:77], v[170:171] op_sel:[0,1] op_sel_hi:[1,1]
    v_pk_mul_f32 v[78:79], v[78:79], v[170:171] op_sel:[0,1] op_sel_hi:[1,1]
    v_pk_mul_f32 v[92:93], v[92:93], v[170:171] op_sel:[0,1] op_sel_hi:[1,1]
    v_pk_mul_f32 v[94:95], v[94:95], v[170:171] op_sel:[0,1] op_sel_hi:[1,1]
    v_cvt_pk_bf16_f32 v152, v76, v77
    v_cvt_pk_bf16_f32 v153, v78, v79
    v_cvt_pk_bf16_f32 v154, v92, v93
    v_cvt_pk_bf16_f32 v155, v94, v95
    buffer_store_dwordx4 v[152:155], v236, s[20:23], s38 offen offset:2048 sc1
    v_pk_mul_f32 v[108:109], v[108:109], v[170:171] op_sel:[0,1] op_sel_hi:[1,1]
    v_pk_mul_f32 v[110:111], v[110:111], v[170:171] op_sel:[0,1] op_sel_hi:[1,1]
    v_pk_mul_f32 v[124:125], v[124:125], v[170:171] op_sel:[0,1] op_sel_hi:[1,1]
    v_pk_mul_f32 v[126:127], v[126:127], v[170:171] op_sel:[0,1] op_sel_hi:[1,1]
    v_cvt_pk_bf16_f32 v156, v108, v109
    v_cvt_pk_bf16_f32 v157, v110, v111
    v_cvt_pk_bf16_f32 v158, v124, v125
    v_cvt_pk_bf16_f32 v159, v126, v127
    buffer_store_dwordx4 v[156:159], v236, s[20:23], s38 offen offset:3072 sc1
    s_waitcnt lgkmcnt(0)
    s_waitcnt vmcnt(0)
    s_barrier
    s_cmp_lg_u32 s37, 0
    s_cbranch_scc1 L_checked
    v_mov_b32 v229, 147456
    ds_read_b128 v[232:235], v229
    s_waitcnt lgkmcnt(0)
    v_or_b32 v232, v232, v233
    v_or_b32 v234, v234, v235
    v_or_b32 v232, v232, v234
    s_nop 0
    v_readfirstlane_b32 s38, v232
    s_nop 3
    s_cmp_lg_u32 s38, 0
    s_cbranch_scc1 L_fallback
L_checked:
    s_cmp_lg_u32 s24, 0
    s_cbranch_scc1 L_pub_done
    v_mov_b32 v132, s51
    v_mov_b32 v133, 1
    s_mov_b64 s[62:63], exec
    s_mov_b64 exec, 1
    global_store_dword v132, v133, s[66:67] sc1
    s_mov_b64 exec, s[62:63]
L_pub_done:
    s_cmp_ge_u32 s48, 27
    s_cbranch_scc1 L_done
    buffer_load_dwordx4 a[96:99], v250, s[4:7], s46 offen offset:0
    buffer_load_dwordx4 a[100:103], v251, s[4:7], s46 offen offset:1024
    buffer_load_dwordx4 a[104:107], v252, s[4:7], s46 offen offset:2048
    buffer_load_dwordx4 a[108:111], v253, s[4:7], s46 offen offset:3072
    s_add_u32 s46, s46, 36864
    buffer_load_dwordx4 a[112:115], v250, s[4:7], s46 offen offset:0
    buffer_load_dwordx4 a[116:119], v251, s[4:7], s46 offen offset:1024
    buffer_load_dwordx4 a[120:123], v252, s[4:7], s46 offen offset:2048
    buffer_load_dwordx4 a[124:127], v253, s[4:7], s46 offen offset:3072
    s_add_u32 s46, s46, 36864
    buffer_load_dwordx4 a[160:163], v250, s[4:7], s46 offen offset:0
    buffer_load_dwordx4 a[164:167], v251, s[4:7], s46 offen offset:1024
    buffer_load_dwordx4 a[168:171], v252, s[4:7], s46 offen offset:2048
    buffer_load_dwordx4 a[172:175], v253, s[4:7], s46 offen offset:3072
    s_add_u32 s46, s46, 36864
    buffer_load_dwordx4 a[176:179], v250, s[4:7], s46 offen offset:0
    buffer_load_dwordx4 a[180:183], v251, s[4:7], s46 offen offset:1024
    buffer_load_dwordx4 a[184:187], v252, s[4:7], s46 offen offset:2048
    buffer_load_dwordx4 a[188:191], v253, s[4:7], s46 offen offset:3072
    s_add_u32 s46, s46, 36864
    v_lshlrev_b32 v132, 4, v227
    s_lshr_b32 s38, s44, 4
    s_lshl_b32 s38, s38, 17
    v_add_u32 v112, s38, v132
    s_add_u32 s38, s38, 0x20000
    v_add_u32 v113, s38, v132
    s_add_u32 s38, s38, 0x20000
    v_add_u32 v114, s38, v132
    s_add_u32 s38, s38, 0x20000
    v_add_u32 v115, s38, v132
    s_add_u32 s38, s38, 0x20000
    v_add_u32 v116, s38, v132
    v_lshrrev_b32 v133, 4, v227
    v_bfe_u32 v136, v227, 2, 2
    v_and_b32 v137, 3, v227
    v_lshl_add_u32 v138, v133, 2, v136
    v_bfe_u32 v136, v138, 1, 2
    v_xor_b32 v132, 0, v136
    v_lshlrev_b32 v132, 5, v132
    v_lshl_add_u32 v132, v138, 7, v132
    v_lshl_add_u32 v132, v137, 3, v132
    v_add_u32 v120, s35, v132
    v_add_u32 v124, 65536, v120
    v_add_u32 v128, 131072, v120
    v_xor_b32 v132, 1, v136
    v_lshlrev_b32 v132, 5, v132
    v_lshl_add_u32 v132, v138, 7, v132
    v_lshl_add_u32 v132, v137, 3, v132
    v_add_u32 v121, s35, v132
    v_add_u32 v125, 65536, v121
    v_add_u32 v129, 131072, v121
    v_xor_b32 v132, 2, v136
    v_lshlrev_b32 v132, 5, v132
    v_lshl_add_u32 v132, v138, 7, v132
    v_lshl_add_u32 v132, v137, 3, v132
    v_add_u32 v122, s35, v132
    v_add_u32 v126, 65536, v122
    v_add_u32 v130, 131072, v122
    v_xor_b32 v132, 3, v136
    v_lshlrev_b32 v132, 5, v132
    v_lshl_add_u32 v132, v138, 7, v132
    v_lshl_add_u32 v132, v137, 3, v132
    v_add_u32 v123, s35, v132
    v_add_u32 v127, 65536, v123
    v_add_u32 v131, 131072, v123
    v_lshlrev_b32 v117, 4, v227
    v_add_u32 v117, s35, v117
    v_add_u32 v118, 65536, v117
    v_add_u32 v119, 131072, v117
    s_lshl_b32 s50, s24, 15
    s_cmp_lg_u32 s24, 0
    s_cbranch_scc1 L_poll_done
    s_lshl_b32 s38, s47, 5
    v_mov_b32 v132, s38
    v_and_b32 v134, 31, v227
    v_lshlrev_b32 v134, 2, v134
    s_lshl_b32 s38, s47, 7
    s_add_u32 s38, s38, 0x2000000
    v_add_u32 v134, s38, v134
    s_mov_b32 s39, 0
    v_readfirstlane_b32 s38, v220
    s_nop 3
    s_cmp_ge_u32 s38, 32
    s_cbranch_scc1 L_poll
L_poll0:
    global_load_dword v133, v132, s[64:65] sc1
    s_waitcnt vmcnt(0)
    v_readfirstlane_b32 s38, v133
    s_add_u32 s39, s39, 1
    s_cmp_ge_u32 s38, 32
    s_cbranch_scc1 L_poll
    s_cmp_ge_u32 s39, 0x40000
    s_cbranch_scc1 L_poll_done
    s_branch L_poll0
L_poll:
    global_load_dword v133, v134, s[66:67] sc1
    s_waitcnt vmcnt(0)
    v_cmp_ne_u32 vcc, 1, v133
    s_add_u32 s39, s39, 1
    s_nop 2
    s_cmp_eq_u64 vcc, 0
    s_cbranch_scc1 L_poll_done
    s_cmp_ge_u32 s39, 0x40000
    s_cbranch_scc1 L_poll_done
    s_branch L_poll
L_poll_done:
    s_barrier
    s_add_u32 m0, s35, 147456
    s_nop 0
    buffer_load_dwordx4 v250, s[4:7], s49 offen offset:0 lds
    buffer_load_dwordx4 v251, s[4:7], s49 offen offset:1024 lds
    buffer_load_dwordx4 v252, s[4:7], s49 offen offset:2048 lds
    buffer_load_dwordx4 v253, s[4:7], s49 offen offset:3072 lds
    s_add_u32 s49, s49, 36864
    s_mov_b32 s49, s46
    buffer_load_dwordx4 a[0:3], v112, s[8:11], s50 offen sc1
    buffer_load_dwordx4 a[4:7], v113, s[8:11], s50 offen sc1
    buffer_load_dwordx4 a[8:11], v114, s[8:11], s50 offen sc1
    buffer_load_dwordx4 a[12:15], v115, s[8:11], s50 offen sc1
    buffer_load_dwordx4 a[16:19], v116, s[8:11], s50 offen sc1
    s_add_u32 s50, s50, 1024
    buffer_load_dwordx4 a[20:23], v112, s[8:11], s50 offen sc1
    buffer_load_dwordx4 a[24:27], v113, s[8:11], s50 offen sc1
    buffer_load_dwordx4 a[28:31], v114, s[8:11], s50 offen sc1
    buffer_load_dwordx4 a[32:35], v115, s[8:11], s50 offen sc1
    buffer_load_dwordx4 a[36:39], v116, s[8:11], s50 offen sc1
    s_add_u32 s50, s50, 1024
    ds_read_b64_tr_b16 v[80:81], v124 offset:32768
    ds_read_b64_tr_b16 v[82:83], v124 offset:34816
    ds_read_b64_tr_b16 v[84:85], v125 offset:32768
    ds_read_b64_tr_b16 v[86:87], v125 offset:34816
    ds_read_b64_tr_b16 v[88:89], v126 offset:32768
    ds_read_b64_tr_b16 v[90:91], v126 offset:34816
    ds_read_b64_tr_b16 v[92:93], v127 offset:32768
    ds_read_b64_tr_b16 v[94:95], v127 offset:34816
    s_waitcnt lgkmcnt(0)
    s_waitcnt vmcnt(5)
    v_mfma_f32_16x16x32_bf16 v[0:3], v[80:83], a[0:3], 0
    ds_read_b64_tr_b16 v[96:97], v124 offset:49152
    v_mfma_f32_16x16x32_bf16 v[4:7], v[80:83], a[4:7], 0
    ds_read_b64_tr_b16 v[98:99], v124 offset:51200
    buffer_load_dwordx4 a[40:43], v112, s[8:11], s50 offen sc1
    v_mfma_f32_16x16x32_bf16 v[8:11], v[80:83], a[8:11], 0
    ds_read_b64_tr_b16 v[100:101], v125 offset:49152
    v_mfma_f32_16x16x32_bf16 v[12:15], v[80:83], a[12:15], 0
    ds_read_b64_tr_b16 v[102:103], v125 offset:51200
    buffer_load_dwordx4 a[44:47], v113, s[8:11], s50 offen sc1
    v_mfma_f32_16x16x32_bf16 v[16:19], v[80:83], a[16:19], 0
    ds_read_b64_tr_b16 v[104:105], v126 offset:49152
    v_mfma_f32_16x16x32_bf16 v[20:23], v[84:87], a[0:3], 0
    ds_read_b64_tr_b16 v[106:107], v126 offset:51200
    buffer_load_dwordx4 a[48:51], v114, s[8:11], s50 offen sc1
    v_mfma_f32_16x16x32_bf16 v[24:27], v[84:87], a[4:7], 0
    ds_read_b64_tr_b16 v[108:109], v127 offset:49152
    v_mfma_f32_16x16x32_bf16 v[28:31], v[84:87], a[8:11], 0
    ds_read_b64_tr_b16 v[110:111], v127 offset:51200
    buffer_load_dwordx4 a[52:55], v115, s[8:11], s50 offen sc1
    v_mfma_f32_16x16x32_bf16 v[32:35], v[84:87], a[12:15], 0
    ds_write_b128 v118, a[192:195] offset:32768
    v_mfma_f32_16x16x32_bf16 v[36:39], v[84:87], a[16:19], 0
    buffer_load_dwordx4 a[56:59], v116, s[8:11], s50 offen sc1
    s_add_u32 s50, s50, 1024
    v_mfma_f32_16x16x32_bf16 v[40:43], v[88:91], a[0:3], 0
    ds_write_b128 v118, a[196:199] offset:33792
    v_mfma_f32_16x16x32_bf16 v[44:47], v[88:91], a[4:7], 0
    v_mfma_f32_16x16x32_bf16 v[48:51], v[88:91], a[8:11], 0
    ds_write_b128 v118, a[200:203] offset:34816
    v_mfma_f32_16x16x32_bf16 v[52:55], v[88:91], a[12:15], 0
    v_mfma_f32_16x16x32_bf16 v[56:59], v[88:91], a[16:19], 0
    ds_write_b128 v118, a[204:207] offset:35840
    v_mfma_f32_16x16x32_bf16 v[60:63], v[92:95], a[0:3], 0
    v_mfma_f32_16x16x32_bf16 v[64:67], v[92:95], a[4:7], 0
    v_mfma_f32_16x16x32_bf16 v[68:71], v[92:95], a[8:11], 0
    v_mfma_f32_16x16x32_bf16 v[72:75], v[92:95], a[12:15], 0
    v_mfma_f32_16x16x32_bf16 v[76:79], v[92:95], a[16:19], 0
    s_waitcnt lgkmcnt(4)
    s_waitcnt vmcnt(5)
    v_mfma_f32_16x16x32_bf16 v[0:3], v[96:99], a[20:23], v[0:3]
    ds_read_b64_tr_b16 v[80:81], v120 offset:0
    v_mfma_f32_16x16x32_bf16 v[4:7], v[96:99], a[24:27], v[4:7]
    ds_read_b64_tr_b16 v[82:83], v120 offset:2048
    buffer_load_dwordx4 a[0:3], v112, s[8:11], s50 offen sc1
    v_mfma_f32_16x16x32_bf16 v[8:11], v[96:99], a[28:31], v[8:11]
    ds_read_b64_tr_b16 v[84:85], v121 offset:0
    v_mfma_f32_16x16x32_bf16 v[12:15], v[96:99], a[32:35], v[12:15]
    ds_read_b64_tr_b16 v[86:87], v121 offset:2048
    buffer_load_dwordx4 a[4:7], v113, s[8:11], s50 offen sc1
    v_mfma_f32_16x16x32_bf16 v[16:19], v[96:99], a[36:39], v[16:19]
    ds_read_b64_tr_b16 v[88:89], v122 offset:0
    v_mfma_f32_16x16x32_bf16 v[20:23], v[100:103], a[20:23], v[20:23]
    ds_read_b64_tr_b16 v[90:91], v122 offset:2048
    buffer_load_dwordx4 a[8:11], v114, s[8:11], s50 offen sc1
    v_mfma_f32_16x16x32_bf16 v[24:27], v[100:103], a[24:27], v[24:27]
    ds_read_b64_tr_b16 v[92:93], v123 offset:0
    v_mfma_f32_16x16x32_bf16 v[28:31], v[100:103], a[28:31], v[28:31]
    ds_read_b64_tr_b16 v[94:95], v123 offset:2048
    buffer_load_dwordx4 a[12:15], v115, s[8:11], s50 offen sc1
    v_mfma_f32_16x16x32_bf16 v[32:35], v[100:103], a[32:35], v[32:35]
    ds_write_b128 v118, a[208:211] offset:49152
    v_mfma_f32_16x16x32_bf16 v[36:39], v[100:103], a[36:39], v[36:39]
    buffer_load_dwordx4 a[16:19], v116, s[8:11], s50 offen sc1
    s_add_u32 s50, s50, 1024
    v_mfma_f32_16x16x32_bf16 v[40:43], v[104:107], a[20:23], v[40:43]
    ds_write_b128 v118, a[212:215] offset:50176
    v_mfma_f32_16x16x32_bf16 v[44:47], v[104:107], a[24:27], v[44:47]
    v_mfma_f32_16x16x32_bf16 v[48:51], v[104:107], a[28:31], v[48:51]
    ds_write_b128 v118, a[216:219] offset:51200
    v_mfma_f32_16x16x32_bf16 v[52:55], v[104:107], a[32:35], v[52:55]
    v_mfma_f32_16x16x32_bf16 v[56:59], v[104:107], a[36:39], v[56:59]
    ds_write_b128 v118, a[220:223] offset:52224
    v_mfma_f32_16x16x32_bf16 v[60:63], v[108:111], a[20:23], v[60:63]
    v_mfma_f32_16x16x32_bf16 v[64:67], v[108:111], a[24:27], v[64:67]
    v_mfma_f32_16x16x32_bf16 v[68:71], v[108:111], a[28:31], v[68:71]
    v_mfma_f32_16x16x32_bf16 v[72:75], v[108:111], a[32:35], v[72:75]
    v_mfma_f32_16x16x32_bf16 v[76:79], v[108:111], a[36:39], v[76:79]
    s_waitcnt lgkmcnt(4)
    s_waitcnt vmcnt(5)
    v_mfma_f32_16x16x32_bf16 v[0:3], v[80:83], a[40:43], v[0:3]
    ds_read_b64_tr_b16 v[96:97], v120 offset:16384
    v_mfma_f32_16x16x32_bf16 v[4:7], v[80:83], a[44:47], v[4:7]
    ds_read_b64_tr_b16 v[98:99], v120 offset:18432
    buffer_load_dwordx4 a[20:23], v112, s[8:11], s50 offen sc1
    v_mfma_f32_16x16x32_bf16 v[8:11], v[80:83], a[48:51], v[8:11]
    ds_read_b64_tr_b16 v[100:101], v121 offset:16384
    v_mfma_f32_16x16x32_bf16 v[12:15], v[80:83], a[52:55], v[12:15]
    ds_read_b64_tr_b16 v[102:103], v121 offset:18432
    buffer_load_dwordx4 a[24:27], v113, s[8:11], s50 offen sc1
    v_mfma_f32_16x16x32_bf16 v[16:19], v[80:83], a[56:59], v[16:19]
    ds_read_b64_tr_b16 v[104:105], v122 offset:16384
    v_mfma_f32_16x16x32_bf16 v[20:23], v[84:87], a[40:43], v[20:23]
    ds_read_b64_tr_b16 v[106:107], v122 offset:18432
    buffer_load_dwordx4 a[28:31], v114, s[8:11], s50 offen sc1
    v_mfma_f32_16x16x32_bf16 v[24:27], v[84:87], a[44:47], v[24:27]
    ds_read_b64_tr_b16 v[108:109], v123 offset:16384
    v_mfma_f32_16x16x32_bf16 v[28:31], v[84:87], a[48:51], v[28:31]
    ds_read_b64_tr_b16 v[110:111], v123 offset:18432
    buffer_load_dwordx4 a[32:35], v115, s[8:11], s50 offen sc1
    v_mfma_f32_16x16x32_bf16 v[32:35], v[84:87], a[52:55], v[32:35]
    ds_write_b128 v117, a[224:227] offset:0
    v_mfma_f32_16x16x32_bf16 v[36:39], v[84:87], a[56:59], v[36:39]
    buffer_load_dwordx4 a[36:39], v116, s[8:11], s50 offen sc1
    s_add_u32 s50, s50, 1024
    v_mfma_f32_16x16x32_bf16 v[40:43], v[88:91], a[40:43], v[40:43]
    ds_write_b128 v117, a[228:231] offset:1024
    v_mfma_f32_16x16x32_bf16 v[44:47], v[88:91], a[44:47], v[44:47]
    v_mfma_f32_16x16x32_bf16 v[48:51], v[88:91], a[48:51], v[48:51]
    ds_write_b128 v117, a[232:235] offset:2048
    v_mfma_f32_16x16x32_bf16 v[52:55], v[88:91], a[52:55], v[52:55]
    v_mfma_f32_16x16x32_bf16 v[56:59], v[88:91], a[56:59], v[56:59]
    ds_write_b128 v117, a[236:239] offset:3072
    v_mfma_f32_16x16x32_bf16 v[60:63], v[92:95], a[40:43], v[60:63]
    v_mfma_f32_16x16x32_bf16 v[64:67], v[92:95], a[44:47], v[64:67]
    v_mfma_f32_16x16x32_bf16 v[68:71], v[92:95], a[48:51], v[68:71]
    v_mfma_f32_16x16x32_bf16 v[72:75], v[92:95], a[52:55], v[72:75]
    v_mfma_f32_16x16x32_bf16 v[76:79], v[92:95], a[56:59], v[76:79]
    s_waitcnt lgkmcnt(4)
    s_waitcnt vmcnt(5)
    v_mfma_f32_16x16x32_bf16 v[0:3], v[96:99], a[0:3], v[0:3]
    ds_read_b64_tr_b16 v[80:81], v120 offset:32768
    v_mfma_f32_16x16x32_bf16 v[4:7], v[96:99], a[4:7], v[4:7]
    ds_read_b64_tr_b16 v[82:83], v120 offset:34816
    buffer_load_dwordx4 a[40:43], v112, s[8:11], s50 offen sc1
    v_mfma_f32_16x16x32_bf16 v[8:11], v[96:99], a[8:11], v[8:11]
    ds_read_b64_tr_b16 v[84:85], v121 offset:32768
    v_mfma_f32_16x16x32_bf16 v[12:15], v[96:99], a[12:15], v[12:15]
    ds_read_b64_tr_b16 v[86:87], v121 offset:34816
    buffer_load_dwordx4 a[44:47], v113, s[8:11], s50 offen sc1
    v_mfma_f32_16x16x32_bf16 v[16:19], v[96:99], a[16:19], v[16:19]
    ds_read_b64_tr_b16 v[88:89], v122 offset:32768
    v_mfma_f32_16x16x32_bf16 v[20:23], v[100:103], a[0:3], v[20:23]
    ds_read_b64_tr_b16 v[90:91], v122 offset:34816
    buffer_load_dwordx4 a[48:51], v114, s[8:11], s50 offen sc1
    v_mfma_f32_16x16x32_bf16 v[24:27], v[100:103], a[4:7], v[24:27]
    ds_read_b64_tr_b16 v[92:93], v123 offset:32768
    v_mfma_f32_16x16x32_bf16 v[28:31], v[100:103], a[8:11], v[28:31]
    ds_read_b64_tr_b16 v[94:95], v123 offset:34816
    buffer_load_dwordx4 a[52:55], v115, s[8:11], s50 offen sc1
    v_mfma_f32_16x16x32_bf16 v[32:35], v[100:103], a[12:15], v[32:35]
    ds_write_b128 v117, a[240:243] offset:16384
    v_mfma_f32_16x16x32_bf16 v[36:39], v[100:103], a[16:19], v[36:39]
    buffer_load_dwordx4 a[56:59], v116, s[8:11], s50 offen sc1
    s_add_u32 s50, s50, 1024
    v_mfma_f32_16x16x32_bf16 v[40:43], v[104:107], a[0:3], v[40:43]
    ds_write_b128 v117, a[244:247] offset:17408
    v_mfma_f32_16x16x32_bf16 v[44:47], v[104:107], a[4:7], v[44:47]
    v_mfma_f32_16x16x32_bf16 v[48:51], v[104:107], a[8:11], v[48:51]
    ds_write_b128 v117, a[248:251] offset:18432
    v_mfma_f32_16x16x32_bf16 v[52:55], v[104:107], a[12:15], v[52:55]
    v_mfma_f32_16x16x32_bf16 v[56:59], v[104:107], a[16:19], v[56:59]
    ds_write_b128 v117, a[252:255] offset:19456
    v_mfma_f32_16x16x32_bf16 v[60:63], v[108:111], a[0:3], v[60:63]
    v_mfma_f32_16x16x32_bf16 v[64:67], v[108:111], a[4:7], v[64:67]
    v_mfma_f32_16x16x32_bf16 v[68:71], v[108:111], a[8:11], v[68:71]
    v_mfma_f32_16x16x32_bf16 v[72:75], v[108:111], a[12:15], v[72:75]
    v_mfma_f32_16x16x32_bf16 v[76:79], v[108:111], a[16:19], v[76:79]
    s_waitcnt lgkmcnt(4)
    s_waitcnt vmcnt(5)
    v_mfma_f32_16x16x32_bf16 v[0:3], v[80:83], a[20:23], v[0:3]
    ds_read_b64_tr_b16 v[96:97], v120 offset:49152
    v_mfma_f32_16x16x32_bf16 v[4:7], v[80:83], a[24:27], v[4:7]
    ds_read_b64_tr_b16 v[98:99], v120 offset:51200
    buffer_load_dwordx4 a[0:3], v112, s[8:11], s50 offen sc1
    v_mfma_f32_16x16x32_bf16 v[8:11], v[80:83], a[28:31], v[8:11]
    ds_read_b64_tr_b16 v[100:101], v121 offset:49152
    v_mfma_f32_16x16x32_bf16 v[12:15], v[80:83], a[32:35], v[12:15]
    ds_read_b64_tr_b16 v[102:103], v121 offset:51200
    buffer_load_dwordx4 a[4:7], v113, s[8:11], s50 offen sc1
    v_mfma_f32_16x16x32_bf16 v[16:19], v[80:83], a[36:39], v[16:19]
    ds_read_b64_tr_b16 v[104:105], v122 offset:49152
    v_mfma_f32_16x16x32_bf16 v[20:23], v[84:87], a[20:23], v[20:23]
    ds_read_b64_tr_b16 v[106:107], v122 offset:51200
    buffer_load_dwordx4 a[8:11], v114, s[8:11], s50 offen sc1
    v_mfma_f32_16x16x32_bf16 v[24:27], v[84:87], a[24:27], v[24:27]
    ds_read_b64_tr_b16 v[108:109], v123 offset:49152
    v_mfma_f32_16x16x32_bf16 v[28:31], v[84:87], a[28:31], v[28:31]
    ds_read_b64_tr_b16 v[110:111], v123 offset:51200
    buffer_load_dwordx4 a[12:15], v115, s[8:11], s50 offen sc1
    v_mfma_f32_16x16x32_bf16 v[32:35], v[84:87], a[32:35], v[32:35]
    ds_write_b128 v117, a[64:67] offset:32768
    v_mfma_f32_16x16x32_bf16 v[36:39], v[84:87], a[36:39], v[36:39]
    buffer_load_dwordx4 a[16:19], v116, s[8:11], s50 offen sc1
    s_add_u32 s50, s50, 1024
    v_mfma_f32_16x16x32_bf16 v[40:43], v[88:91], a[20:23], v[40:43]
    ds_write_b128 v117, a[68:71] offset:33792
    v_mfma_f32_16x16x32_bf16 v[44:47], v[88:91], a[24:27], v[44:47]
    v_mfma_f32_16x16x32_bf16 v[48:51], v[88:91], a[28:31], v[48:51]
    ds_write_b128 v117, a[72:75] offset:34816
    v_mfma_f32_16x16x32_bf16 v[52:55], v[88:91], a[32:35], v[52:55]
    v_mfma_f32_16x16x32_bf16 v[56:59], v[88:91], a[36:39], v[56:59]
    ds_write_b128 v117, a[76:79] offset:35840
    v_mfma_f32_16x16x32_bf16 v[60:63], v[92:95], a[20:23], v[60:63]
    v_mfma_f32_16x16x32_bf16 v[64:67], v[92:95], a[24:27], v[64:67]
    v_mfma_f32_16x16x32_bf16 v[68:71], v[92:95], a[28:31], v[68:71]
    v_mfma_f32_16x16x32_bf16 v[72:75], v[92:95], a[32:35], v[72:75]
    v_mfma_f32_16x16x32_bf16 v[76:79], v[92:95], a[36:39], v[76:79]
    s_waitcnt lgkmcnt(4)
    s_waitcnt vmcnt(5)
    v_mfma_f32_16x16x32_bf16 v[0:3], v[96:99], a[40:43], v[0:3]
    ds_read_b64_tr_b16 v[80:81], v124 offset:0
    v_mfma_f32_16x16x32_bf16 v[4:7], v[96:99], a[44:47], v[4:7]
    ds_read_b64_tr_b16 v[82:83], v124 offset:2048
    buffer_load_dwordx4 a[20:23], v112, s[8:11], s50 offen sc1
    v_mfma_f32_16x16x32_bf16 v[8:11], v[96:99], a[48:51], v[8:11]
    ds_read_b64_tr_b16 v[84:85], v125 offset:0
    v_mfma_f32_16x16x32_bf16 v[12:15], v[96:99], a[52:55], v[12:15]
    ds_read_b64_tr_b16 v[86:87], v125 offset:2048
    buffer_load_dwordx4 a[24:27], v113, s[8:11], s50 offen sc1
    v_mfma_f32_16x16x32_bf16 v[16:19], v[96:99], a[56:59], v[16:19]
    ds_read_b64_tr_b16 v[88:89], v126 offset:0
    v_mfma_f32_16x16x32_bf16 v[20:23], v[100:103], a[40:43], v[20:23]
    ds_read_b64_tr_b16 v[90:91], v126 offset:2048
    buffer_load_dwordx4 a[28:31], v114, s[8:11], s50 offen sc1
    v_mfma_f32_16x16x32_bf16 v[24:27], v[100:103], a[44:47], v[24:27]
    ds_read_b64_tr_b16 v[92:93], v127 offset:0
    v_mfma_f32_16x16x32_bf16 v[28:31], v[100:103], a[48:51], v[28:31]
    ds_read_b64_tr_b16 v[94:95], v127 offset:2048
    buffer_load_dwordx4 a[32:35], v115, s[8:11], s50 offen sc1
    v_mfma_f32_16x16x32_bf16 v[32:35], v[100:103], a[52:55], v[32:35]
    ds_write_b128 v117, a[80:83] offset:49152
    v_mfma_f32_16x16x32_bf16 v[36:39], v[100:103], a[56:59], v[36:39]
    buffer_load_dwordx4 a[36:39], v116, s[8:11], s50 offen sc1
    s_add_u32 s50, s50, 1024
    v_mfma_f32_16x16x32_bf16 v[40:43], v[104:107], a[40:43], v[40:43]
    ds_write_b128 v117, a[84:87] offset:50176
    v_mfma_f32_16x16x32_bf16 v[44:47], v[104:107], a[44:47], v[44:47]
    v_mfma_f32_16x16x32_bf16 v[48:51], v[104:107], a[48:51], v[48:51]
    ds_write_b128 v117, a[88:91] offset:51200
    v_mfma_f32_16x16x32_bf16 v[52:55], v[104:107], a[52:55], v[52:55]
    v_mfma_f32_16x16x32_bf16 v[56:59], v[104:107], a[56:59], v[56:59]
    ds_write_b128 v117, a[92:95] offset:52224
    v_mfma_f32_16x16x32_bf16 v[60:63], v[108:111], a[40:43], v[60:63]
    v_mfma_f32_16x16x32_bf16 v[64:67], v[108:111], a[44:47], v[64:67]
    v_mfma_f32_16x16x32_bf16 v[68:71], v[108:111], a[48:51], v[68:71]
    v_mfma_f32_16x16x32_bf16 v[72:75], v[108:111], a[52:55], v[72:75]
    v_mfma_f32_16x16x32_bf16 v[76:79], v[108:111], a[56:59], v[76:79]
    s_waitcnt lgkmcnt(4)
    s_waitcnt vmcnt(5)
    v_mfma_f32_16x16x32_bf16 v[0:3], v[80:83], a[0:3], v[0:3]
    ds_read_b64_tr_b16 v[96:97], v124 offset:16384
    v_mfma_f32_16x16x32_bf16 v[4:7], v[80:83], a[4:7], v[4:7]
    ds_read_b64_tr_b16 v[98:99], v124 offset:18432
    buffer_load_dwordx4 a[40:43], v112, s[8:11], s50 offen sc1
    v_mfma_f32_16x16x32_bf16 v[8:11], v[80:83], a[8:11], v[8:11]
    ds_read_b64_tr_b16 v[100:101], v125 offset:16384
    v_mfma_f32_16x16x32_bf16 v[12:15], v[80:83], a[12:15], v[12:15]
    ds_read_b64_tr_b16 v[102:103], v125 offset:18432
    buffer_load_dwordx4 a[44:47], v113, s[8:11], s50 offen sc1
    v_mfma_f32_16x16x32_bf16 v[16:19], v[80:83], a[16:19], v[16:19]
    ds_read_b64_tr_b16 v[104:105], v126 offset:16384
    v_mfma_f32_16x16x32_bf16 v[20:23], v[84:87], a[0:3], v[20:23]
    ds_read_b64_tr_b16 v[106:107], v126 offset:18432
    buffer_load_dwordx4 a[48:51], v114, s[8:11], s50 offen sc1
    v_mfma_f32_16x16x32_bf16 v[24:27], v[84:87], a[4:7], v[24:27]
    ds_read_b64_tr_b16 v[108:109], v127 offset:16384
    v_mfma_f32_16x16x32_bf16 v[28:31], v[84:87], a[8:11], v[28:31]
    ds_read_b64_tr_b16 v[110:111], v127 offset:18432
    buffer_load_dwordx4 a[52:55], v115, s[8:11], s50 offen sc1
    v_mfma_f32_16x16x32_bf16 v[32:35], v[84:87], a[12:15], v[32:35]
    ds_write_b128 v118, a[128:131] offset:0
    v_mfma_f32_16x16x32_bf16 v[36:39], v[84:87], a[16:19], v[36:39]
    buffer_load_dwordx4 a[56:59], v116, s[8:11], s50 offen sc1
    s_add_u32 s50, s50, 1024
    v_mfma_f32_16x16x32_bf16 v[40:43], v[88:91], a[0:3], v[40:43]
    ds_write_b128 v118, a[132:135] offset:1024
    v_mfma_f32_16x16x32_bf16 v[44:47], v[88:91], a[4:7], v[44:47]
    v_mfma_f32_16x16x32_bf16 v[48:51], v[88:91], a[8:11], v[48:51]
    ds_write_b128 v118, a[136:139] offset:2048
    v_mfma_f32_16x16x32_bf16 v[52:55], v[88:91], a[12:15], v[52:55]
    v_mfma_f32_16x16x32_bf16 v[56:59], v[88:91], a[16:19], v[56:59]
    ds_write_b128 v118, a[140:143] offset:3072
    v_mfma_f32_16x16x32_bf16 v[60:63], v[92:95], a[0:3], v[60:63]
    v_mfma_f32_16x16x32_bf16 v[64:67], v[92:95], a[4:7], v[64:67]
    v_mfma_f32_16x16x32_bf16 v[68:71], v[92:95], a[8:11], v[68:71]
    v_mfma_f32_16x16x32_bf16 v[72:75], v[92:95], a[12:15], v[72:75]
    v_mfma_f32_16x16x32_bf16 v[76:79], v[92:95], a[16:19], v[76:79]
    s_waitcnt lgkmcnt(4)
    s_waitcnt vmcnt(5)
    v_mfma_f32_16x16x32_bf16 v[0:3], v[96:99], a[20:23], v[0:3]
    ds_read_b64_tr_b16 v[80:81], v128 offset:0
    v_mfma_f32_16x16x32_bf16 v[4:7], v[96:99], a[24:27], v[4:7]
    ds_read_b64_tr_b16 v[82:83], v128 offset:2048
    buffer_load_dwordx4 a[0:3], v112, s[8:11], s50 offen sc1
    v_mfma_f32_16x16x32_bf16 v[8:11], v[96:99], a[28:31], v[8:11]
    ds_read_b64_tr_b16 v[84:85], v129 offset:0
    v_mfma_f32_16x16x32_bf16 v[12:15], v[96:99], a[32:35], v[12:15]
    ds_read_b64_tr_b16 v[86:87], v129 offset:2048
    buffer_load_dwordx4 a[4:7], v113, s[8:11], s50 offen sc1
    v_mfma_f32_16x16x32_bf16 v[16:19], v[96:99], a[36:39], v[16:19]
    ds_read_b64_tr_b16 v[88:89], v130 offset:0
    v_mfma_f32_16x16x32_bf16 v[20:23], v[100:103], a[20:23], v[20:23]
    ds_read_b64_tr_b16 v[90:91], v130 offset:2048
    buffer_load_dwordx4 a[8:11], v114, s[8:11], s50 offen sc1
    v_mfma_f32_16x16x32_bf16 v[24:27], v[100:103], a[24:27], v[24:27]
    ds_read_b64_tr_b16 v[92:93], v131 offset:0
    v_mfma_f32_16x16x32_bf16 v[28:31], v[100:103], a[28:31], v[28:31]
    ds_read_b64_tr_b16 v[94:95], v131 offset:2048
    buffer_load_dwordx4 a[12:15], v115, s[8:11], s50 offen sc1
    v_mfma_f32_16x16x32_bf16 v[32:35], v[100:103], a[32:35], v[32:35]
    ds_write_b128 v118, a[144:147] offset:16384
    v_mfma_f32_16x16x32_bf16 v[36:39], v[100:103], a[36:39], v[36:39]
    buffer_load_dwordx4 a[16:19], v116, s[8:11], s50 offen sc1
    s_add_u32 s50, s50, 1024
    v_mfma_f32_16x16x32_bf16 v[40:43], v[104:107], a[20:23], v[40:43]
    ds_write_b128 v118, a[148:151] offset:17408
    v_mfma_f32_16x16x32_bf16 v[44:47], v[104:107], a[24:27], v[44:47]
    v_mfma_f32_16x16x32_bf16 v[48:51], v[104:107], a[28:31], v[48:51]
    ds_write_b128 v118, a[152:155] offset:18432
    v_mfma_f32_16x16x32_bf16 v[52:55], v[104:107], a[32:35], v[52:55]
    v_mfma_f32_16x16x32_bf16 v[56:59], v[104:107], a[36:39], v[56:59]
    ds_write_b128 v118, a[156:159] offset:19456
    v_mfma_f32_16x16x32_bf16 v[60:63], v[108:111], a[20:23], v[60:63]
    v_mfma_f32_16x16x32_bf16 v[64:67], v[108:111], a[24:27], v[64:67]
    v_mfma_f32_16x16x32_bf16 v[68:71], v[108:111], a[28:31], v[68:71]
    v_mfma_f32_16x16x32_bf16 v[72:75], v[108:111], a[32:35], v[72:75]
    v_mfma_f32_16x16x32_bf16 v[76:79], v[108:111], a[36:39], v[76:79]
    s_waitcnt lgkmcnt(4)
    s_waitcnt vmcnt(5)
    v_mfma_f32_16x16x32_bf16 v[0:3], v[80:83], a[40:43], v[0:3]
    ds_read_b64_tr_b16 v[96:97], v128 offset:16384
    v_mfma_f32_16x16x32_bf16 v[4:7], v[80:83], a[44:47], v[4:7]
    ds_read_b64_tr_b16 v[98:99], v128 offset:18432
    buffer_load_dwordx4 a[20:23], v112, s[8:11], s50 offen sc1
    v_mfma_f32_16x16x32_bf16 v[8:11], v[80:83], a[48:51], v[8:11]
    ds_read_b64_tr_b16 v[100:101], v129 offset:16384
    v_mfma_f32_16x16x32_bf16 v[12:15], v[80:83], a[52:55], v[12:15]
    ds_read_b64_tr_b16 v[102:103], v129 offset:18432
    buffer_load_dwordx4 a[24:27], v113, s[8:11], s50 offen sc1
    v_mfma_f32_16x16x32_bf16 v[16:19], v[80:83], a[56:59], v[16:19]
    ds_read_b64_tr_b16 v[104:105], v130 offset:16384
    v_mfma_f32_16x16x32_bf16 v[20:23], v[84:87], a[40:43], v[20:23]
    ds_read_b64_tr_b16 v[106:107], v130 offset:18432
    buffer_load_dwordx4 a[28:31], v114, s[8:11], s50 offen sc1
    v_mfma_f32_16x16x32_bf16 v[24:27], v[84:87], a[44:47], v[24:27]
    ds_read_b64_tr_b16 v[108:109], v131 offset:16384
    v_mfma_f32_16x16x32_bf16 v[28:31], v[84:87], a[48:51], v[28:31]
    ds_read_b64_tr_b16 v[110:111], v131 offset:18432
    buffer_load_dwordx4 a[32:35], v115, s[8:11], s50 offen sc1
    v_mfma_f32_16x16x32_bf16 v[32:35], v[84:87], a[52:55], v[32:35]
    ds_write_b128 v119, a[96:99] offset:0
    v_mfma_f32_16x16x32_bf16 v[36:39], v[84:87], a[56:59], v[36:39]
    buffer_load_dwordx4 a[36:39], v116, s[8:11], s50 offen sc1
    s_add_u32 s50, s50, 1024
    v_mfma_f32_16x16x32_bf16 v[40:43], v[88:91], a[40:43], v[40:43]
    ds_write_b128 v119, a[100:103] offset:1024
    v_mfma_f32_16x16x32_bf16 v[44:47], v[88:91], a[44:47], v[44:47]
    v_mfma_f32_16x16x32_bf16 v[48:51], v[88:91], a[48:51], v[48:51]
    ds_write_b128 v119, a[104:107] offset:2048
    v_mfma_f32_16x16x32_bf16 v[52:55], v[88:91], a[52:55], v[52:55]
    v_mfma_f32_16x16x32_bf16 v[56:59], v[88:91], a[56:59], v[56:59]
    ds_write_b128 v119, a[108:111] offset:3072
    v_mfma_f32_16x16x32_bf16 v[60:63], v[92:95], a[40:43], v[60:63]
    v_mfma_f32_16x16x32_bf16 v[64:67], v[92:95], a[44:47], v[64:67]
    v_mfma_f32_16x16x32_bf16 v[68:71], v[92:95], a[48:51], v[68:71]
    v_mfma_f32_16x16x32_bf16 v[72:75], v[92:95], a[52:55], v[72:75]
    v_mfma_f32_16x16x32_bf16 v[76:79], v[92:95], a[56:59], v[76:79]
    s_waitcnt lgkmcnt(4)
    s_waitcnt vmcnt(5)
    v_mfma_f32_16x16x32_bf16 v[0:3], v[96:99], a[0:3], v[0:3]
    ds_read_b64_tr_b16 v[80:81], v124 offset:32768
    v_mfma_f32_16x16x32_bf16 v[4:7], v[96:99], a[4:7], v[4:7]
    ds_read_b64_tr_b16 v[82:83], v124 offset:34816
    buffer_load_dwordx4 a[40:43], v112, s[8:11], s50 offen sc1
    v_mfma_f32_16x16x32_bf16 v[8:11], v[96:99], a[8:11], v[8:11]
    ds_read_b64_tr_b16 v[84:85], v125 offset:32768
    v_mfma_f32_16x16x32_bf16 v[12:15], v[96:99], a[12:15], v[12:15]
    ds_read_b64_tr_b16 v[86:87], v125 offset:34816
    buffer_load_dwordx4 a[44:47], v113, s[8:11], s50 offen sc1
    v_mfma_f32_16x16x32_bf16 v[16:19], v[96:99], a[16:19], v[16:19]
    ds_read_b64_tr_b16 v[88:89], v126 offset:32768
    v_mfma_f32_16x16x32_bf16 v[20:23], v[100:103], a[0:3], v[20:23]
    ds_read_b64_tr_b16 v[90:91], v126 offset:34816
    buffer_load_dwordx4 a[48:51], v114, s[8:11], s50 offen sc1
    v_mfma_f32_16x16x32_bf16 v[24:27], v[100:103], a[4:7], v[24:27]
    ds_read_b64_tr_b16 v[92:93], v127 offset:32768
    v_mfma_f32_16x16x32_bf16 v[28:31], v[100:103], a[8:11], v[28:31]
    ds_read_b64_tr_b16 v[94:95], v127 offset:34816
    buffer_load_dwordx4 a[52:55], v115, s[8:11], s50 offen sc1
    v_mfma_f32_16x16x32_bf16 v[32:35], v[100:103], a[12:15], v[32:35]
    ds_write_b128 v119, a[112:115] offset:16384
    v_mfma_f32_16x16x32_bf16 v[36:39], v[100:103], a[16:19], v[36:39]
    buffer_load_dwordx4 a[56:59], v116, s[8:11], s50 offen sc1
    s_add_u32 s50, s50, 1024
    v_mfma_f32_16x16x32_bf16 v[40:43], v[104:107], a[0:3], v[40:43]
    ds_write_b128 v119, a[116:119] offset:17408
    v_mfma_f32_16x16x32_bf16 v[44:47], v[104:107], a[4:7], v[44:47]
    v_mfma_f32_16x16x32_bf16 v[48:51], v[104:107], a[8:11], v[48:51]
    ds_write_b128 v119, a[120:123] offset:18432
    v_mfma_f32_16x16x32_bf16 v[52:55], v[104:107], a[12:15], v[52:55]
    v_mfma_f32_16x16x32_bf16 v[56:59], v[104:107], a[16:19], v[56:59]
    ds_write_b128 v119, a[124:127] offset:19456
    v_mfma_f32_16x16x32_bf16 v[60:63], v[108:111], a[0:3], v[60:63]
    v_mfma_f32_16x16x32_bf16 v[64:67], v[108:111], a[4:7], v[64:67]
    v_mfma_f32_16x16x32_bf16 v[68:71], v[108:111], a[8:11], v[68:71]
    v_mfma_f32_16x16x32_bf16 v[72:75], v[108:111], a[12:15], v[72:75]
    v_mfma_f32_16x16x32_bf16 v[76:79], v[108:111], a[16:19], v[76:79]
    s_waitcnt lgkmcnt(4)
    s_waitcnt vmcnt(5)
    v_mfma_f32_16x16x32_bf16 v[0:3], v[80:83], a[20:23], v[0:3]
    ds_read_b64_tr_b16 v[96:97], v124 offset:49152
    v_mfma_f32_16x16x32_bf16 v[4:7], v[80:83], a[24:27], v[4:7]
    ds_read_b64_tr_b16 v[98:99], v124 offset:51200
    buffer_load_dwordx4 a[0:3], v112, s[8:11], s50 offen sc1
    v_mfma_f32_16x16x32_bf16 v[8:11], v[80:83], a[28:31], v[8:11]
    ds_read_b64_tr_b16 v[100:101], v125 offset:49152
    v_mfma_f32_16x16x32_bf16 v[12:15], v[80:83], a[32:35], v[12:15]
    ds_read_b64_tr_b16 v[102:103], v125 offset:51200
    buffer_load_dwordx4 a[4:7], v113, s[8:11], s50 offen sc1
    v_mfma_f32_16x16x32_bf16 v[16:19], v[80:83], a[36:39], v[16:19]
    ds_read_b64_tr_b16 v[104:105], v126 offset:49152
    v_mfma_f32_16x16x32_bf16 v[20:23], v[84:87], a[20:23], v[20:23]
    ds_read_b64_tr_b16 v[106:107], v126 offset:51200
    buffer_load_dwordx4 a[8:11], v114, s[8:11], s50 offen sc1
    v_mfma_f32_16x16x32_bf16 v[24:27], v[84:87], a[24:27], v[24:27]
    ds_read_b64_tr_b16 v[108:109], v127 offset:49152
    v_mfma_f32_16x16x32_bf16 v[28:31], v[84:87], a[28:31], v[28:31]
    ds_read_b64_tr_b16 v[110:111], v127 offset:51200
    buffer_load_dwordx4 a[12:15], v115, s[8:11], s50 offen sc1
    v_mfma_f32_16x16x32_bf16 v[32:35], v[84:87], a[32:35], v[32:35]
    ds_write_b128 v118, a[160:163] offset:32768
    v_mfma_f32_16x16x32_bf16 v[36:39], v[84:87], a[36:39], v[36:39]
    buffer_load_dwordx4 a[16:19], v116, s[8:11], s50 offen sc1
    s_add_u32 s50, s50, 1024
    v_mfma_f32_16x16x32_bf16 v[40:43], v[88:91], a[20:23], v[40:43]
    ds_write_b128 v118, a[164:167] offset:33792
    v_mfma_f32_16x16x32_bf16 v[44:47], v[88:91], a[24:27], v[44:47]
    v_mfma_f32_16x16x32_bf16 v[48:51], v[88:91], a[28:31], v[48:51]
    ds_write_b128 v118, a[168:171] offset:34816
    v_mfma_f32_16x16x32_bf16 v[52:55], v[88:91], a[32:35], v[52:55]
    v_mfma_f32_16x16x32_bf16 v[56:59], v[88:91], a[36:39], v[56:59]
    ds_write_b128 v118, a[172:175] offset:35840
    v_mfma_f32_16x16x32_bf16 v[60:63], v[92:95], a[20:23], v[60:63]
    v_mfma_f32_16x16x32_bf16 v[64:67], v[92:95], a[24:27], v[64:67]
    v_mfma_f32_16x16x32_bf16 v[68:71], v[92:95], a[28:31], v[68:71]
    v_mfma_f32_16x16x32_bf16 v[72:75], v[92:95], a[32:35], v[72:75]
    v_mfma_f32_16x16x32_bf16 v[76:79], v[92:95], a[36:39], v[76:79]
    s_waitcnt lgkmcnt(4)
    s_waitcnt vmcnt(5)
    v_mfma_f32_16x16x32_bf16 v[0:3], v[96:99], a[40:43], v[0:3]
    ds_read_b64_tr_b16 v[80:81], v120 offset:0
    v_mfma_f32_16x16x32_bf16 v[4:7], v[96:99], a[44:47], v[4:7]
    ds_read_b64_tr_b16 v[82:83], v120 offset:2048
    buffer_load_dwordx4 a[20:23], v112, s[8:11], s50 offen sc1
    v_mfma_f32_16x16x32_bf16 v[8:11], v[96:99], a[48:51], v[8:11]
    ds_read_b64_tr_b16 v[84:85], v121 offset:0
    v_mfma_f32_16x16x32_bf16 v[12:15], v[96:99], a[52:55], v[12:15]
    ds_read_b64_tr_b16 v[86:87], v121 offset:2048
    buffer_load_dwordx4 a[24:27], v113, s[8:11], s50 offen sc1
    v_mfma_f32_16x16x32_bf16 v[16:19], v[96:99], a[56:59], v[16:19]
    ds_read_b64_tr_b16 v[88:89], v122 offset:0
    v_mfma_f32_16x16x32_bf16 v[20:23], v[100:103], a[40:43], v[20:23]
    ds_read_b64_tr_b16 v[90:91], v122 offset:2048
    buffer_load_dwordx4 a[28:31], v114, s[8:11], s50 offen sc1
    v_mfma_f32_16x16x32_bf16 v[24:27], v[100:103], a[44:47], v[24:27]
    ds_read_b64_tr_b16 v[92:93], v123 offset:0
    v_mfma_f32_16x16x32_bf16 v[28:31], v[100:103], a[48:51], v[28:31]
    ds_read_b64_tr_b16 v[94:95], v123 offset:2048
    buffer_load_dwordx4 a[32:35], v115, s[8:11], s50 offen sc1
    v_mfma_f32_16x16x32_bf16 v[32:35], v[100:103], a[52:55], v[32:35]
    ds_write_b128 v118, a[176:179] offset:49152
    v_mfma_f32_16x16x32_bf16 v[36:39], v[100:103], a[56:59], v[36:39]
    buffer_load_dwordx4 a[36:39], v116, s[8:11], s50 offen sc1
    s_add_u32 s50, s50, 1024
    v_mfma_f32_16x16x32_bf16 v[40:43], v[104:107], a[40:43], v[40:43]
    ds_write_b128 v118, a[180:183] offset:50176
    v_mfma_f32_16x16x32_bf16 v[44:47], v[104:107], a[44:47], v[44:47]
    v_mfma_f32_16x16x32_bf16 v[48:51], v[104:107], a[48:51], v[48:51]
    ds_write_b128 v118, a[184:187] offset:51200
    v_mfma_f32_16x16x32_bf16 v[52:55], v[104:107], a[52:55], v[52:55]
    v_mfma_f32_16x16x32_bf16 v[56:59], v[104:107], a[56:59], v[56:59]
    ds_write_b128 v118, a[188:191] offset:52224
    v_mfma_f32_16x16x32_bf16 v[60:63], v[108:111], a[40:43], v[60:63]
    v_mfma_f32_16x16x32_bf16 v[64:67], v[108:111], a[44:47], v[64:67]
    v_mfma_f32_16x16x32_bf16 v[68:71], v[108:111], a[48:51], v[68:71]
    v_mfma_f32_16x16x32_bf16 v[72:75], v[108:111], a[52:55], v[72:75]
    v_mfma_f32_16x16x32_bf16 v[76:79], v[108:111], a[56:59], v[76:79]
    s_waitcnt lgkmcnt(4)
    s_waitcnt vmcnt(5)
    v_mfma_f32_16x16x32_bf16 v[0:3], v[80:83], a[0:3], v[0:3]
    ds_read_b64_tr_b16 v[96:97], v120 offset:16384
    v_mfma_f32_16x16x32_bf16 v[4:7], v[80:83], a[4:7], v[4:7]
    ds_read_b64_tr_b16 v[98:99], v120 offset:18432
    buffer_load_dwordx4 a[40:43], v112, s[8:11], s50 offen sc1
    v_mfma_f32_16x16x32_bf16 v[8:11], v[80:83], a[8:11], v[8:11]
    ds_read_b64_tr_b16 v[100:101], v121 offset:16384
    v_mfma_f32_16x16x32_bf16 v[12:15], v[80:83], a[12:15], v[12:15]
    ds_read_b64_tr_b16 v[102:103], v121 offset:18432
    buffer_load_dwordx4 a[44:47], v113, s[8:11], s50 offen sc1
    v_mfma_f32_16x16x32_bf16 v[16:19], v[80:83], a[16:19], v[16:19]
    ds_read_b64_tr_b16 v[104:105], v122 offset:16384
    v_mfma_f32_16x16x32_bf16 v[20:23], v[84:87], a[0:3], v[20:23]
    ds_read_b64_tr_b16 v[106:107], v122 offset:18432
    buffer_load_dwordx4 a[48:51], v114, s[8:11], s50 offen sc1
    v_mfma_f32_16x16x32_bf16 v[24:27], v[84:87], a[4:7], v[24:27]
    ds_read_b64_tr_b16 v[108:109], v123 offset:16384
    v_mfma_f32_16x16x32_bf16 v[28:31], v[84:87], a[8:11], v[28:31]
    ds_read_b64_tr_b16 v[110:111], v123 offset:18432
    buffer_load_dwordx4 a[52:55], v115, s[8:11], s50 offen sc1
    v_mfma_f32_16x16x32_bf16 v[32:35], v[84:87], a[12:15], v[32:35]
    v_mfma_f32_16x16x32_bf16 v[36:39], v[84:87], a[16:19], v[36:39]
    buffer_load_dwordx4 a[56:59], v116, s[8:11], s50 offen sc1
    s_add_u32 s50, s50, 1024
    v_mfma_f32_16x16x32_bf16 v[40:43], v[88:91], a[0:3], v[40:43]
    v_mfma_f32_16x16x32_bf16 v[44:47], v[88:91], a[4:7], v[44:47]
    s_add_u32 m0, s35, 0
    s_nop 0
    buffer_load_dwordx4 v250, s[4:7], s49 offen offset:0 lds
    v_mfma_f32_16x16x32_bf16 v[48:51], v[88:91], a[8:11], v[48:51]
    v_mfma_f32_16x16x32_bf16 v[52:55], v[88:91], a[12:15], v[52:55]
    buffer_load_dwordx4 v251, s[4:7], s49 offen offset:1024 lds
    v_mfma_f32_16x16x32_bf16 v[56:59], v[88:91], a[16:19], v[56:59]
    v_mfma_f32_16x16x32_bf16 v[60:63], v[92:95], a[0:3], v[60:63]
    buffer_load_dwordx4 v252, s[4:7], s49 offen offset:2048 lds
    v_mfma_f32_16x16x32_bf16 v[64:67], v[92:95], a[4:7], v[64:67]
    v_mfma_f32_16x16x32_bf16 v[68:71], v[92:95], a[8:11], v[68:71]
    buffer_load_dwordx4 v253, s[4:7], s49 offen offset:3072 lds
    s_add_u32 s49, s49, 36864
    v_mfma_f32_16x16x32_bf16 v[72:75], v[92:95], a[12:15], v[72:75]
    v_mfma_f32_16x16x32_bf16 v[76:79], v[92:95], a[16:19], v[76:79]
    s_waitcnt lgkmcnt(0)
    s_waitcnt vmcnt(9)
    v_mfma_f32_16x16x32_bf16 v[0:3], v[96:99], a[20:23], v[0:3]
    ds_read_b64_tr_b16 v[80:81], v120 offset:32768
    v_mfma_f32_16x16x32_bf16 v[4:7], v[96:99], a[24:27], v[4:7]
    ds_read_b64_tr_b16 v[82:83], v120 offset:34816
    buffer_load_dwordx4 a[0:3], v112, s[8:11], s50 offen sc1
    v_mfma_f32_16x16x32_bf16 v[8:11], v[96:99], a[28:31], v[8:11]
    ds_read_b64_tr_b16 v[84:85], v121 offset:32768
    v_mfma_f32_16x16x32_bf16 v[12:15], v[96:99], a[32:35], v[12:15]
    ds_read_b64_tr_b16 v[86:87], v121 offset:34816
    buffer_load_dwordx4 a[4:7], v113, s[8:11], s50 offen sc1
    v_mfma_f32_16x16x32_bf16 v[16:19], v[96:99], a[36:39], v[16:19]
    ds_read_b64_tr_b16 v[88:89], v122 offset:32768
    v_mfma_f32_16x16x32_bf16 v[20:23], v[100:103], a[20:23], v[20:23]
    ds_read_b64_tr_b16 v[90:91], v122 offset:34816
    buffer_load_dwordx4 a[8:11], v114, s[8:11], s50 offen sc1
    v_mfma_f32_16x16x32_bf16 v[24:27], v[100:103], a[24:27], v[24:27]
    ds_read_b64_tr_b16 v[92:93], v123 offset:32768
    v_mfma_f32_16x16x32_bf16 v[28:31], v[100:103], a[28:31], v[28:31]
    ds_read_b64_tr_b16 v[94:95], v123 offset:34816
    buffer_load_dwordx4 a[12:15], v115, s[8:11], s50 offen sc1
    v_mfma_f32_16x16x32_bf16 v[32:35], v[100:103], a[32:35], v[32:35]
    v_mfma_f32_16x16x32_bf16 v[36:39], v[100:103], a[36:39], v[36:39]
    buffer_load_dwordx4 a[16:19], v116, s[8:11], s50 offen sc1
    s_add_u32 s50, s50, 1024
    v_mfma_f32_16x16x32_bf16 v[40:43], v[104:107], a[20:23], v[40:43]
    v_mfma_f32_16x16x32_bf16 v[44:47], v[104:107], a[24:27], v[44:47]
    s_add_u32 m0, s35, 16384
    s_nop 0
    buffer_load_dwordx4 v250, s[4:7], s49 offen offset:0 lds
    v_mfma_f32_16x16x32_bf16 v[48:51], v[104:107], a[28:31], v[48:51]
    v_mfma_f32_16x16x32_bf16 v[52:55], v[104:107], a[32:35], v[52:55]
    buffer_load_dwordx4 v251, s[4:7], s49 offen offset:1024 lds
    v_mfma_f32_16x16x32_bf16 v[56:59], v[104:107], a[36:39], v[56:59]
    v_mfma_f32_16x16x32_bf16 v[60:63], v[108:111], a[20:23], v[60:63]
    buffer_load_dwordx4 v252, s[4:7], s49 offen offset:2048 lds
    v_mfma_f32_16x16x32_bf16 v[64:67], v[108:111], a[24:27], v[64:67]
    v_mfma_f32_16x16x32_bf16 v[68:71], v[108:111], a[28:31], v[68:71]
    buffer_load_dwordx4 v253, s[4:7], s49 offen offset:3072 lds
    s_add_u32 s49, s49, 36864
    v_mfma_f32_16x16x32_bf16 v[72:75], v[108:111], a[32:35], v[72:75]
    v_mfma_f32_16x16x32_bf16 v[76:79], v[108:111], a[36:39], v[76:79]
    s_waitcnt lgkmcnt(0)
    s_waitcnt vmcnt(13)
    v_mfma_f32_16x16x32_bf16 v[0:3], v[80:83], a[40:43], v[0:3]
    ds_read_b64_tr_b16 v[96:97], v120 offset:49152
    v_mfma_f32_16x16x32_bf16 v[4:7], v[80:83], a[44:47], v[4:7]
    ds_read_b64_tr_b16 v[98:99], v120 offset:51200
    buffer_load_dwordx4 a[20:23], v112, s[8:11], s50 offen sc1
    v_mfma_f32_16x16x32_bf16 v[8:11], v[80:83], a[48:51], v[8:11]
    ds_read_b64_tr_b16 v[100:101], v121 offset:49152
    v_mfma_f32_16x16x32_bf16 v[12:15], v[80:83], a[52:55], v[12:15]
    ds_read_b64_tr_b16 v[102:103], v121 offset:51200
    buffer_load_dwordx4 a[24:27], v113, s[8:11], s50 offen sc1
    v_mfma_f32_16x16x32_bf16 v[16:19], v[80:83], a[56:59], v[16:19]
    ds_read_b64_tr_b16 v[104:105], v122 offset:49152
    v_mfma_f32_16x16x32_bf16 v[20:23], v[84:87], a[40:43], v[20:23]
    ds_read_b64_tr_b16 v[106:107], v122 offset:51200
    buffer_load_dwordx4 a[28:31], v114, s[8:11], s50 offen sc1
    v_mfma_f32_16x16x32_bf16 v[24:27], v[84:87], a[44:47], v[24:27]
    ds_read_b64_tr_b16 v[108:109], v123 offset:49152
    v_mfma_f32_16x16x32_bf16 v[28:31], v[84:87], a[48:51], v[28:31]
    ds_read_b64_tr_b16 v[110:111], v123 offset:51200
    buffer_load_dwordx4 a[32:35], v115, s[8:11], s50 offen sc1
    v_mfma_f32_16x16x32_bf16 v[32:35], v[84:87], a[52:55], v[32:35]
    v_mfma_f32_16x16x32_bf16 v[36:39], v[84:87], a[56:59], v[36:39]
    buffer_load_dwordx4 a[36:39], v116, s[8:11], s50 offen sc1
    s_add_u32 s50, s50, 1024
    v_mfma_f32_16x16x32_bf16 v[40:43], v[88:91], a[40:43], v[40:43]
    v_mfma_f32_16x16x32_bf16 v[44:47], v[88:91], a[44:47], v[44:47]
    s_add_u32 m0, s35, 32768
    s_nop 0
    buffer_load_dwordx4 v250, s[4:7], s49 offen offset:0 lds
    v_mfma_f32_16x16x32_bf16 v[48:51], v[88:91], a[48:51], v[48:51]
    v_mfma_f32_16x16x32_bf16 v[52:55], v[88:91], a[52:55], v[52:55]
    buffer_load_dwordx4 v251, s[4:7], s49 offen offset:1024 lds
    v_mfma_f32_16x16x32_bf16 v[56:59], v[88:91], a[56:59], v[56:59]
    v_mfma_f32_16x16x32_bf16 v[60:63], v[92:95], a[40:43], v[60:63]
    buffer_load_dwordx4 v252, s[4:7], s49 offen offset:2048 lds
    v_mfma_f32_16x16x32_bf16 v[64:67], v[92:95], a[44:47], v[64:67]
    v_mfma_f32_16x16x32_bf16 v[68:71], v[92:95], a[48:51], v[68:71]
    buffer_load_dwordx4 v253, s[4:7], s49 offen offset:3072 lds
    s_add_u32 s49, s49, 36864
    v_mfma_f32_16x16x32_bf16 v[72:75], v[92:95], a[52:55], v[72:75]
    v_mfma_f32_16x16x32_bf16 v[76:79], v[92:95], a[56:59], v[76:79]
    s_waitcnt lgkmcnt(0)
    s_waitcnt vmcnt(13)
    v_mfma_f32_16x16x32_bf16 v[0:3], v[96:99], a[0:3], v[0:3]
    ds_read_b64_tr_b16 v[80:81], v124 offset:0
    v_mfma_f32_16x16x32_bf16 v[4:7], v[96:99], a[4:7], v[4:7]
    ds_read_b64_tr_b16 v[82:83], v124 offset:2048
    buffer_load_dwordx4 a[40:43], v112, s[8:11], s50 offen sc1
    v_mfma_f32_16x16x32_bf16 v[8:11], v[96:99], a[8:11], v[8:11]
    ds_read_b64_tr_b16 v[84:85], v125 offset:0
    v_mfma_f32_16x16x32_bf16 v[12:15], v[96:99], a[12:15], v[12:15]
    ds_read_b64_tr_b16 v[86:87], v125 offset:2048
    buffer_load_dwordx4 a[44:47], v113, s[8:11], s50 offen sc1
    v_mfma_f32_16x16x32_bf16 v[16:19], v[96:99], a[16:19], v[16:19]
    ds_read_b64_tr_b16 v[88:89], v126 offset:0
    v_mfma_f32_16x16x32_bf16 v[20:23], v[100:103], a[0:3], v[20:23]
    ds_read_b64_tr_b16 v[90:91], v126 offset:2048
    buffer_load_dwordx4 a[48:51], v114, s[8:11], s50 offen sc1
    v_mfma_f32_16x16x32_bf16 v[24:27], v[100:103], a[4:7], v[24:27]
    ds_read_b64_tr_b16 v[92:93], v127 offset:0
    v_mfma_f32_16x16x32_bf16 v[28:31], v[100:103], a[8:11], v[28:31]
    ds_read_b64_tr_b16 v[94:95], v127 offset:2048
    buffer_load_dwordx4 a[52:55], v115, s[8:11], s50 offen sc1
    v_mfma_f32_16x16x32_bf16 v[32:35], v[100:103], a[12:15], v[32:35]
    v_mfma_f32_16x16x32_bf16 v[36:39], v[100:103], a[16:19], v[36:39]
    buffer_load_dwordx4 a[56:59], v116, s[8:11], s50 offen sc1
    s_add_u32 s50, s50, 1024
    v_mfma_f32_16x16x32_bf16 v[40:43], v[104:107], a[0:3], v[40:43]
    v_mfma_f32_16x16x32_bf16 v[44:47], v[104:107], a[4:7], v[44:47]
    s_add_u32 m0, s35, 49152
    s_nop 0
    buffer_load_dwordx4 v250, s[4:7], s49 offen offset:0 lds
    v_mfma_f32_16x16x32_bf16 v[48:51], v[104:107], a[8:11], v[48:51]
    v_mfma_f32_16x16x32_bf16 v[52:55], v[104:107], a[12:15], v[52:55]
    buffer_load_dwordx4 v251, s[4:7], s49 offen offset:1024 lds
    v_mfma_f32_16x16x32_bf16 v[56:59], v[104:107], a[16:19], v[56:59]
    v_mfma_f32_16x16x32_bf16 v[60:63], v[108:111], a[0:3], v[60:63]
    buffer_load_dwordx4 v252, s[4:7], s49 offen offset:2048 lds
    v_mfma_f32_16x16x32_bf16 v[64:67], v[108:111], a[4:7], v[64:67]
    v_mfma_f32_16x16x32_bf16 v[68:71], v[108:111], a[8:11], v[68:71]
    buffer_load_dwordx4 v253, s[4:7], s49 offen offset:3072 lds
    s_add_u32 s49, s49, 36864
    v_mfma_f32_16x16x32_bf16 v[72:75], v[108:111], a[12:15], v[72:75]
    v_mfma_f32_16x16x32_bf16 v[76:79], v[108:111], a[16:19], v[76:79]
    s_waitcnt lgkmcnt(0)
    s_waitcnt vmcnt(13)
    v_mfma_f32_16x16x32_bf16 v[0:3], v[80:83], a[20:23], v[0:3]
    ds_read_b64_tr_b16 v[96:97], v124 offset:16384
    v_mfma_f32_16x16x32_bf16 v[4:7], v[80:83], a[24:27], v[4:7]
    ds_read_b64_tr_b16 v[98:99], v124 offset:18432
    buffer_load_dwordx4 a[0:3], v112, s[8:11], s50 offen sc1
    v_mfma_f32_16x16x32_bf16 v[8:11], v[80:83], a[28:31], v[8:11]
    ds_read_b64_tr_b16 v[100:101], v125 offset:16384
    v_mfma_f32_16x16x32_bf16 v[12:15], v[80:83], a[32:35], v[12:15]
    ds_read_b64_tr_b16 v[102:103], v125 offset:18432
    buffer_load_dwordx4 a[4:7], v113, s[8:11], s50 offen sc1
    v_mfma_f32_16x16x32_bf16 v[16:19], v[80:83], a[36:39], v[16:19]
    ds_read_b64_tr_b16 v[104:105], v126 offset:16384
    v_mfma_f32_16x16x32_bf16 v[20:23], v[84:87], a[20:23], v[20:23]
    ds_read_b64_tr_b16 v[106:107], v126 offset:18432
    buffer_load_dwordx4 a[8:11], v114, s[8:11], s50 offen sc1
    v_mfma_f32_16x16x32_bf16 v[24:27], v[84:87], a[24:27], v[24:27]
    ds_read_b64_tr_b16 v[108:109], v127 offset:16384
    v_mfma_f32_16x16x32_bf16 v[28:31], v[84:87], a[28:31], v[28:31]
    ds_read_b64_tr_b16 v[110:111], v127 offset:18432
    buffer_load_dwordx4 a[12:15], v115, s[8:11], s50 offen sc1
    v_mfma_f32_16x16x32_bf16 v[32:35], v[84:87], a[32:35], v[32:35]
    v_mfma_f32_16x16x32_bf16 v[36:39], v[84:87], a[36:39], v[36:39]
    buffer_load_dwordx4 a[16:19], v116, s[8:11], s50 offen sc1
    s_add_u32 s50, s50, 1024
    v_mfma_f32_16x16x32_bf16 v[40:43], v[88:91], a[20:23], v[40:43]
    v_mfma_f32_16x16x32_bf16 v[44:47], v[88:91], a[24:27], v[44:47]
    s_add_u32 m0, s35, 65536
    s_nop 0
    buffer_load_dwordx4 v250, s[4:7], s49 offen offset:0 lds
    v_mfma_f32_16x16x32_bf16 v[48:51], v[88:91], a[28:31], v[48:51]
    v_mfma_f32_16x16x32_bf16 v[52:55], v[88:91], a[32:35], v[52:55]
    buffer_load_dwordx4 v251, s[4:7], s49 offen offset:1024 lds
    v_mfma_f32_16x16x32_bf16 v[56:59], v[88:91], a[36:39], v[56:59]
    v_mfma_f32_16x16x32_bf16 v[60:63], v[92:95], a[20:23], v[60:63]
    buffer_load_dwordx4 v252, s[4:7], s49 offen offset:2048 lds
    v_mfma_f32_16x16x32_bf16 v[64:67], v[92:95], a[24:27], v[64:67]
    v_mfma_f32_16x16x32_bf16 v[68:71], v[92:95], a[28:31], v[68:71]
    buffer_load_dwordx4 v253, s[4:7], s49 offen offset:3072 lds
    s_add_u32 s49, s49, 36864
    v_mfma_f32_16x16x32_bf16 v[72:75], v[92:95], a[32:35], v[72:75]
    v_mfma_f32_16x16x32_bf16 v[76:79], v[92:95], a[36:39], v[76:79]
    s_waitcnt lgkmcnt(0)
    s_waitcnt vmcnt(13)
    v_mfma_f32_16x16x32_bf16 v[0:3], v[96:99], a[40:43], v[0:3]
    ds_read_b64_tr_b16 v[80:81], v128 offset:0
    v_mfma_f32_16x16x32_bf16 v[4:7], v[96:99], a[44:47], v[4:7]
    ds_read_b64_tr_b16 v[82:83], v128 offset:2048
    buffer_load_dwordx4 a[20:23], v112, s[8:11], s50 offen sc1
    v_mfma_f32_16x16x32_bf16 v[8:11], v[96:99], a[48:51], v[8:11]
    ds_read_b64_tr_b16 v[84:85], v129 offset:0
    v_mfma_f32_16x16x32_bf16 v[12:15], v[96:99], a[52:55], v[12:15]
    ds_read_b64_tr_b16 v[86:87], v129 offset:2048
    buffer_load_dwordx4 a[24:27], v113, s[8:11], s50 offen sc1
    v_mfma_f32_16x16x32_bf16 v[16:19], v[96:99], a[56:59], v[16:19]
    ds_read_b64_tr_b16 v[88:89], v130 offset:0
    v_mfma_f32_16x16x32_bf16 v[20:23], v[100:103], a[40:43], v[20:23]
    ds_read_b64_tr_b16 v[90:91], v130 offset:2048
    buffer_load_dwordx4 a[28:31], v114, s[8:11], s50 offen sc1
    v_mfma_f32_16x16x32_bf16 v[24:27], v[100:103], a[44:47], v[24:27]
    ds_read_b64_tr_b16 v[92:93], v131 offset:0
    v_mfma_f32_16x16x32_bf16 v[28:31], v[100:103], a[48:51], v[28:31]
    ds_read_b64_tr_b16 v[94:95], v131 offset:2048
    buffer_load_dwordx4 a[32:35], v115, s[8:11], s50 offen sc1
    v_mfma_f32_16x16x32_bf16 v[32:35], v[100:103], a[52:55], v[32:35]
    v_mfma_f32_16x16x32_bf16 v[36:39], v[100:103], a[56:59], v[36:39]
    buffer_load_dwordx4 a[36:39], v116, s[8:11], s50 offen sc1
    s_add_u32 s50, s50, 1024
    v_mfma_f32_16x16x32_bf16 v[40:43], v[104:107], a[40:43], v[40:43]
    v_mfma_f32_16x16x32_bf16 v[44:47], v[104:107], a[44:47], v[44:47]
    s_add_u32 m0, s35, 81920
    s_nop 0
    buffer_load_dwordx4 v250, s[4:7], s49 offen offset:0 lds
    v_mfma_f32_16x16x32_bf16 v[48:51], v[104:107], a[48:51], v[48:51]
    v_mfma_f32_16x16x32_bf16 v[52:55], v[104:107], a[52:55], v[52:55]
    buffer_load_dwordx4 v251, s[4:7], s49 offen offset:1024 lds
    v_mfma_f32_16x16x32_bf16 v[56:59], v[104:107], a[56:59], v[56:59]
    v_mfma_f32_16x16x32_bf16 v[60:63], v[108:111], a[40:43], v[60:63]
    buffer_load_dwordx4 v252, s[4:7], s49 offen offset:2048 lds
    v_mfma_f32_16x16x32_bf16 v[64:67], v[108:111], a[44:47], v[64:67]
    v_mfma_f32_16x16x32_bf16 v[68:71], v[108:111], a[48:51], v[68:71]
    buffer_load_dwordx4 v253, s[4:7], s49 offen offset:3072 lds
    s_add_u32 s49, s49, 36864
    v_mfma_f32_16x16x32_bf16 v[72:75], v[108:111], a[52:55], v[72:75]
    v_mfma_f32_16x16x32_bf16 v[76:79], v[108:111], a[56:59], v[76:79]
    s_waitcnt lgkmcnt(0)
    s_waitcnt vmcnt(13)
    v_mfma_f32_16x16x32_bf16 v[0:3], v[80:83], a[0:3], v[0:3]
    ds_read_b64_tr_b16 v[96:97], v128 offset:16384
    v_mfma_f32_16x16x32_bf16 v[4:7], v[80:83], a[4:7], v[4:7]
    ds_read_b64_tr_b16 v[98:99], v128 offset:18432
    buffer_load_dwordx4 a[40:43], v112, s[8:11], s50 offen sc1
    v_mfma_f32_16x16x32_bf16 v[8:11], v[80:83], a[8:11], v[8:11]
    ds_read_b64_tr_b16 v[100:101], v129 offset:16384
    v_mfma_f32_16x16x32_bf16 v[12:15], v[80:83], a[12:15], v[12:15]
    ds_read_b64_tr_b16 v[102:103], v129 offset:18432
    buffer_load_dwordx4 a[44:47], v113, s[8:11], s50 offen sc1
    v_mfma_f32_16x16x32_bf16 v[16:19], v[80:83], a[16:19], v[16:19]
    ds_read_b64_tr_b16 v[104:105], v130 offset:16384
    v_mfma_f32_16x16x32_bf16 v[20:23], v[84:87], a[0:3], v[20:23]
    ds_read_b64_tr_b16 v[106:107], v130 offset:18432
    buffer_load_dwordx4 a[48:51], v114, s[8:11], s50 offen sc1
    v_mfma_f32_16x16x32_bf16 v[24:27], v[84:87], a[4:7], v[24:27]
    ds_read_b64_tr_b16 v[108:109], v131 offset:16384
    v_mfma_f32_16x16x32_bf16 v[28:31], v[84:87], a[8:11], v[28:31]
    ds_read_b64_tr_b16 v[110:111], v131 offset:18432
    buffer_load_dwordx4 a[52:55], v115, s[8:11], s50 offen sc1
    v_mfma_f32_16x16x32_bf16 v[32:35], v[84:87], a[12:15], v[32:35]
    v_mfma_f32_16x16x32_bf16 v[36:39], v[84:87], a[16:19], v[36:39]
    buffer_load_dwordx4 a[56:59], v116, s[8:11], s50 offen sc1
    s_add_u32 s50, s50, 1024
    v_mfma_f32_16x16x32_bf16 v[40:43], v[88:91], a[0:3], v[40:43]
    v_mfma_f32_16x16x32_bf16 v[44:47], v[88:91], a[4:7], v[44:47]
    s_add_u32 m0, s35, 131072
    s_nop 0
    buffer_load_dwordx4 v250, s[4:7], s49 offen offset:0 lds
    v_mfma_f32_16x16x32_bf16 v[48:51], v[88:91], a[8:11], v[48:51]
    v_mfma_f32_16x16x32_bf16 v[52:55], v[88:91], a[12:15], v[52:55]
    buffer_load_dwordx4 v251, s[4:7], s49 offen offset:1024 lds
    v_mfma_f32_16x16x32_bf16 v[56:59], v[88:91], a[16:19], v[56:59]
    v_mfma_f32_16x16x32_bf16 v[60:63], v[92:95], a[0:3], v[60:63]
    buffer_load_dwordx4 v252, s[4:7], s49 offen offset:2048 lds
    v_mfma_f32_16x16x32_bf16 v[64:67], v[92:95], a[4:7], v[64:67]
    v_mfma_f32_16x16x32_bf16 v[68:71], v[92:95], a[8:11], v[68:71]
    buffer_load_dwordx4 v253, s[4:7], s49 offen offset:3072 lds
    s_add_u32 s49, s49, 36864
    v_mfma_f32_16x16x32_bf16 v[72:75], v[92:95], a[12:15], v[72:75]
    v_mfma_f32_16x16x32_bf16 v[76:79], v[92:95], a[16:19], v[76:79]
    s_waitcnt lgkmcnt(0)
    s_waitcnt vmcnt(13)
    v_mfma_f32_16x16x32_bf16 v[0:3], v[96:99], a[20:23], v[0:3]
    ds_read_b64_tr_b16 v[80:81], v124 offset:32768
    v_mfma_f32_16x16x32_bf16 v[4:7], v[96:99], a[24:27], v[4:7]
    ds_read_b64_tr_b16 v[82:83], v124 offset:34816
    buffer_load_dwordx4 a[0:3], v112, s[8:11], s50 offen sc1
    v_mfma_f32_16x16x32_bf16 v[8:11], v[96:99], a[28:31], v[8:11]
    ds_read_b64_tr_b16 v[84:85], v125 offset:32768
    v_mfma_f32_16x16x32_bf16 v[12:15], v[96:99], a[32:35], v[12:15]
    ds_read_b64_tr_b16 v[86:87], v125 offset:34816
    buffer_load_dwordx4 a[4:7], v113, s[8:11], s50 offen sc1
    v_mfma_f32_16x16x32_bf16 v[16:19], v[96:99], a[36:39], v[16:19]
    ds_read_b64_tr_b16 v[88:89], v126 offset:32768
    v_mfma_f32_16x16x32_bf16 v[20:23], v[100:103], a[20:23], v[20:23]
    ds_read_b64_tr_b16 v[90:91], v126 offset:34816
    buffer_load_dwordx4 a[8:11], v114, s[8:11], s50 offen sc1
    v_mfma_f32_16x16x32_bf16 v[24:27], v[100:103], a[24:27], v[24:27]
    ds_read_b64_tr_b16 v[92:93], v127 offset:32768
    v_mfma_f32_16x16x32_bf16 v[28:31], v[100:103], a[28:31], v[28:31]
    ds_read_b64_tr_b16 v[94:95], v127 offset:34816
    buffer_load_dwordx4 a[12:15], v115, s[8:11], s50 offen sc1
    v_mfma_f32_16x16x32_bf16 v[32:35], v[100:103], a[32:35], v[32:35]
    v_mfma_f32_16x16x32_bf16 v[36:39], v[100:103], a[36:39], v[36:39]
    buffer_load_dwordx4 a[16:19], v116, s[8:11], s50 offen sc1
    s_add_u32 s50, s50, 1024
    v_mfma_f32_16x16x32_bf16 v[40:43], v[104:107], a[20:23], v[40:43]
    v_mfma_f32_16x16x32_bf16 v[44:47], v[104:107], a[24:27], v[44:47]
    s_add_u32 m0, s35, 147456
    s_nop 0
    buffer_load_dwordx4 v250, s[4:7], s49 offen offset:0 lds
    v_mfma_f32_16x16x32_bf16 v[48:51], v[104:107], a[28:31], v[48:51]
    v_mfma_f32_16x16x32_bf16 v[52:55], v[104:107], a[32:35], v[52:55]
    buffer_load_dwordx4 v251, s[4:7], s49 offen offset:1024 lds
    v_mfma_f32_16x16x32_bf16 v[56:59], v[104:107], a[36:39], v[56:59]
    v_mfma_f32_16x16x32_bf16 v[60:63], v[108:111], a[20:23], v[60:63]
    buffer_load_dwordx4 v252, s[4:7], s49 offen offset:2048 lds
    v_mfma_f32_16x16x32_bf16 v[64:67], v[108:111], a[24:27], v[64:67]
    v_mfma_f32_16x16x32_bf16 v[68:71], v[108:111], a[28:31], v[68:71]
    buffer_load_dwordx4 v253, s[4:7], s49 offen offset:3072 lds
    s_add_u32 s49, s49, 36864
    v_mfma_f32_16x16x32_bf16 v[72:75], v[108:111], a[32:35], v[72:75]
    v_mfma_f32_16x16x32_bf16 v[76:79], v[108:111], a[36:39], v[76:79]
    s_waitcnt lgkmcnt(0)
    s_waitcnt vmcnt(13)
    v_mfma_f32_16x16x32_bf16 v[0:3], v[80:83], a[40:43], v[0:3]
    ds_read_b64_tr_b16 v[96:97], v124 offset:49152
    v_mfma_f32_16x16x32_bf16 v[4:7], v[80:83], a[44:47], v[4:7]
    ds_read_b64_tr_b16 v[98:99], v124 offset:51200
    buffer_load_dwordx4 a[20:23], v112, s[8:11], s50 offen sc1
    v_mfma_f32_16x16x32_bf16 v[8:11], v[80:83], a[48:51], v[8:11]
    ds_read_b64_tr_b16 v[100:101], v125 offset:49152
    v_mfma_f32_16x16x32_bf16 v[12:15], v[80:83], a[52:55], v[12:15]
    ds_read_b64_tr_b16 v[102:103], v125 offset:51200
    buffer_load_dwordx4 a[24:27], v113, s[8:11], s50 offen sc1
    v_mfma_f32_16x16x32_bf16 v[16:19], v[80:83], a[56:59], v[16:19]
    ds_read_b64_tr_b16 v[104:105], v126 offset:49152
    v_mfma_f32_16x16x32_bf16 v[20:23], v[84:87], a[40:43], v[20:23]
    ds_read_b64_tr_b16 v[106:107], v126 offset:51200
    buffer_load_dwordx4 a[28:31], v114, s[8:11], s50 offen sc1
    v_mfma_f32_16x16x32_bf16 v[24:27], v[84:87], a[44:47], v[24:27]
    ds_read_b64_tr_b16 v[108:109], v127 offset:49152
    v_mfma_f32_16x16x32_bf16 v[28:31], v[84:87], a[48:51], v[28:31]
    ds_read_b64_tr_b16 v[110:111], v127 offset:51200
    buffer_load_dwordx4 a[32:35], v115, s[8:11], s50 offen sc1
    v_mfma_f32_16x16x32_bf16 v[32:35], v[84:87], a[52:55], v[32:35]
    v_mfma_f32_16x16x32_bf16 v[36:39], v[84:87], a[56:59], v[36:39]
    buffer_load_dwordx4 a[36:39], v116, s[8:11], s50 offen sc1
    s_add_u32 s50, s50, 1024
    v_mfma_f32_16x16x32_bf16 v[40:43], v[88:91], a[40:43], v[40:43]
    v_mfma_f32_16x16x32_bf16 v[44:47], v[88:91], a[44:47], v[44:47]
    s_add_u32 m0, s35, 98304
    s_nop 0
    buffer_load_dwordx4 v250, s[4:7], s49 offen offset:0 lds
    v_mfma_f32_16x16x32_bf16 v[48:51], v[88:91], a[48:51], v[48:51]
    v_mfma_f32_16x16x32_bf16 v[52:55], v[88:91], a[52:55], v[52:55]
    buffer_load_dwordx4 v251, s[4:7], s49 offen offset:1024 lds
    v_mfma_f32_16x16x32_bf16 v[56:59], v[88:91], a[56:59], v[56:59]
    v_mfma_f32_16x16x32_bf16 v[60:63], v[92:95], a[40:43], v[60:63]
    buffer_load_dwordx4 v252, s[4:7], s49 offen offset:2048 lds
    v_mfma_f32_16x16x32_bf16 v[64:67], v[92:95], a[44:47], v[64:67]
    v_mfma_f32_16x16x32_bf16 v[68:71], v[92:95], a[48:51], v[68:71]
    buffer_load_dwordx4 v253, s[4:7], s49 offen offset:3072 lds
    s_add_u32 s49, s49, 36864
    v_mfma_f32_16x16x32_bf16 v[72:75], v[92:95], a[52:55], v[72:75]
    v_mfma_f32_16x16x32_bf16 v[76:79], v[92:95], a[56:59], v[76:79]
    s_waitcnt lgkmcnt(0)
    s_waitcnt vmcnt(13)
    v_mfma_f32_16x16x32_bf16 v[0:3], v[96:99], a[0:3], v[0:3]
    ds_read_b64_tr_b16 v[80:81], v120 offset:0
    v_mfma_f32_16x16x32_bf16 v[4:7], v[96:99], a[4:7], v[4:7]
    ds_read_b64_tr_b16 v[82:83], v120 offset:2048
    buffer_load_dwordx4 a[40:43], v112, s[8:11], s50 offen sc1
    v_mfma_f32_16x16x32_bf16 v[8:11], v[96:99], a[8:11], v[8:11]
    ds_read_b64_tr_b16 v[84:85], v121 offset:0
    v_mfma_f32_16x16x32_bf16 v[12:15], v[96:99], a[12:15], v[12:15]
    ds_read_b64_tr_b16 v[86:87], v121 offset:2048
    buffer_load_dwordx4 a[44:47], v113, s[8:11], s50 offen sc1
    v_mfma_f32_16x16x32_bf16 v[16:19], v[96:99], a[16:19], v[16:19]
    ds_read_b64_tr_b16 v[88:89], v122 offset:0
    v_mfma_f32_16x16x32_bf16 v[20:23], v[100:103], a[0:3], v[20:23]
    ds_read_b64_tr_b16 v[90:91], v122 offset:2048
    buffer_load_dwordx4 a[48:51], v114, s[8:11], s50 offen sc1
    v_mfma_f32_16x16x32_bf16 v[24:27], v[100:103], a[4:7], v[24:27]
    ds_read_b64_tr_b16 v[92:93], v123 offset:0
    v_mfma_f32_16x16x32_bf16 v[28:31], v[100:103], a[8:11], v[28:31]
    ds_read_b64_tr_b16 v[94:95], v123 offset:2048
    buffer_load_dwordx4 a[52:55], v115, s[8:11], s50 offen sc1
    v_mfma_f32_16x16x32_bf16 v[32:35], v[100:103], a[12:15], v[32:35]
    v_mfma_f32_16x16x32_bf16 v[36:39], v[100:103], a[16:19], v[36:39]
    buffer_load_dwordx4 a[56:59], v116, s[8:11], s50 offen sc1
    s_add_u32 s50, s50, 1024
    v_mfma_f32_16x16x32_bf16 v[40:43], v[104:107], a[0:3], v[40:43]
    v_mfma_f32_16x16x32_bf16 v[44:47], v[104:107], a[4:7], v[44:47]
    s_add_u32 m0, s35, 114688
    s_nop 0
    buffer_load_dwordx4 v250, s[4:7], s49 offen offset:0 lds
    v_mfma_f32_16x16x32_bf16 v[48:51], v[104:107], a[8:11], v[48:51]
    v_mfma_f32_16x16x32_bf16 v[52:55], v[104:107], a[12:15], v[52:55]
    buffer_load_dwordx4 v251, s[4:7], s49 offen offset:1024 lds
    v_mfma_f32_16x16x32_bf16 v[56:59], v[104:107], a[16:19], v[56:59]
    v_mfma_f32_16x16x32_bf16 v[60:63], v[108:111], a[0:3], v[60:63]
    buffer_load_dwordx4 v252, s[4:7], s49 offen offset:2048 lds
    v_mfma_f32_16x16x32_bf16 v[64:67], v[108:111], a[4:7], v[64:67]
    v_mfma_f32_16x16x32_bf16 v[68:71], v[108:111], a[8:11], v[68:71]
    buffer_load_dwordx4 v253, s[4:7], s49 offen offset:3072 lds
    s_add_u32 s49, s49, 36864
    v_mfma_f32_16x16x32_bf16 v[72:75], v[108:111], a[12:15], v[72:75]
    v_mfma_f32_16x16x32_bf16 v[76:79], v[108:111], a[16:19], v[76:79]
    s_waitcnt lgkmcnt(0)
    s_waitcnt vmcnt(13)
    v_mfma_f32_16x16x32_bf16 v[0:3], v[80:83], a[20:23], v[0:3]
    ds_read_b64_tr_b16 v[96:97], v120 offset:16384
    v_mfma_f32_16x16x32_bf16 v[4:7], v[80:83], a[24:27], v[4:7]
    ds_read_b64_tr_b16 v[98:99], v120 offset:18432
    buffer_load_dwordx4 a[0:3], v112, s[8:11], s50 offen sc1
    v_mfma_f32_16x16x32_bf16 v[8:11], v[80:83], a[28:31], v[8:11]
    ds_read_b64_tr_b16 v[100:101], v121 offset:16384
    v_mfma_f32_16x16x32_bf16 v[12:15], v[80:83], a[32:35], v[12:15]
    ds_read_b64_tr_b16 v[102:103], v121 offset:18432
    buffer_load_dwordx4 a[4:7], v113, s[8:11], s50 offen sc1
    v_mfma_f32_16x16x32_bf16 v[16:19], v[80:83], a[36:39], v[16:19]
    ds_read_b64_tr_b16 v[104:105], v122 offset:16384
    v_mfma_f32_16x16x32_bf16 v[20:23], v[84:87], a[20:23], v[20:23]
    ds_read_b64_tr_b16 v[106:107], v122 offset:18432
    buffer_load_dwordx4 a[8:11], v114, s[8:11], s50 offen sc1
    v_mfma_f32_16x16x32_bf16 v[24:27], v[84:87], a[24:27], v[24:27]
    ds_read_b64_tr_b16 v[108:109], v123 offset:16384
    v_mfma_f32_16x16x32_bf16 v[28:31], v[84:87], a[28:31], v[28:31]
    ds_read_b64_tr_b16 v[110:111], v123 offset:18432
    buffer_load_dwordx4 a[12:15], v115, s[8:11], s50 offen sc1
    v_mfma_f32_16x16x32_bf16 v[32:35], v[84:87], a[32:35], v[32:35]
    v_mfma_f32_16x16x32_bf16 v[36:39], v[84:87], a[36:39], v[36:39]
    buffer_load_dwordx4 a[16:19], v116, s[8:11], s50 offen sc1
    s_add_u32 s50, s50, 1024
    v_mfma_f32_16x16x32_bf16 v[40:43], v[88:91], a[20:23], v[40:43]
    v_mfma_f32_16x16x32_bf16 v[44:47], v[88:91], a[24:27], v[44:47]
    v_mfma_f32_16x16x32_bf16 v[48:51], v[88:91], a[28:31], v[48:51]
    v_mfma_f32_16x16x32_bf16 v[52:55], v[88:91], a[32:35], v[52:55]
    v_mfma_f32_16x16x32_bf16 v[56:59], v[88:91], a[36:39], v[56:59]
    v_mfma_f32_16x16x32_bf16 v[60:63], v[92:95], a[20:23], v[60:63]
    v_mfma_f32_16x16x32_bf16 v[64:67], v[92:95], a[24:27], v[64:67]
    v_mfma_f32_16x16x32_bf16 v[68:71], v[92:95], a[28:31], v[68:71]
    v_mfma_f32_16x16x32_bf16 v[72:75], v[92:95], a[32:35], v[72:75]
    v_mfma_f32_16x16x32_bf16 v[76:79], v[92:95], a[36:39], v[76:79]
    s_waitcnt lgkmcnt(0)
    s_waitcnt vmcnt(9)
    v_mfma_f32_16x16x32_bf16 v[0:3], v[96:99], a[40:43], v[0:3]
    ds_read_b64_tr_b16 v[80:81], v120 offset:32768
    v_mfma_f32_16x16x32_bf16 v[4:7], v[96:99], a[44:47], v[4:7]
    ds_read_b64_tr_b16 v[82:83], v120 offset:34816
    buffer_load_dwordx4 a[20:23], v112, s[8:11], s50 offen sc1
    v_mfma_f32_16x16x32_bf16 v[8:11], v[96:99], a[48:51], v[8:11]
    ds_read_b64_tr_b16 v[84:85], v121 offset:32768
    v_mfma_f32_16x16x32_bf16 v[12:15], v[96:99], a[52:55], v[12:15]
    ds_read_b64_tr_b16 v[86:87], v121 offset:34816
    buffer_load_dwordx4 a[24:27], v113, s[8:11], s50 offen sc1
    v_mfma_f32_16x16x32_bf16 v[16:19], v[96:99], a[56:59], v[16:19]
    ds_read_b64_tr_b16 v[88:89], v122 offset:32768
    v_mfma_f32_16x16x32_bf16 v[20:23], v[100:103], a[40:43], v[20:23]
    ds_read_b64_tr_b16 v[90:91], v122 offset:34816
    buffer_load_dwordx4 a[28:31], v114, s[8:11], s50 offen sc1
    v_mfma_f32_16x16x32_bf16 v[24:27], v[100:103], a[44:47], v[24:27]
    ds_read_b64_tr_b16 v[92:93], v123 offset:32768
    v_mfma_f32_16x16x32_bf16 v[28:31], v[100:103], a[48:51], v[28:31]
    ds_read_b64_tr_b16 v[94:95], v123 offset:34816
    buffer_load_dwordx4 a[32:35], v115, s[8:11], s50 offen sc1
    v_mfma_f32_16x16x32_bf16 v[32:35], v[100:103], a[52:55], v[32:35]
    v_mfma_f32_16x16x32_bf16 v[36:39], v[100:103], a[56:59], v[36:39]
    buffer_load_dwordx4 a[36:39], v116, s[8:11], s50 offen sc1
    s_add_u32 s50, s50, 1024
    v_mfma_f32_16x16x32_bf16 v[40:43], v[104:107], a[40:43], v[40:43]
    v_mfma_f32_16x16x32_bf16 v[44:47], v[104:107], a[44:47], v[44:47]
    v_mfma_f32_16x16x32_bf16 v[48:51], v[104:107], a[48:51], v[48:51]
    v_mfma_f32_16x16x32_bf16 v[52:55], v[104:107], a[52:55], v[52:55]
    v_mfma_f32_16x16x32_bf16 v[56:59], v[104:107], a[56:59], v[56:59]
    v_mfma_f32_16x16x32_bf16 v[60:63], v[108:111], a[40:43], v[60:63]
    v_mfma_f32_16x16x32_bf16 v[64:67], v[108:111], a[44:47], v[64:67]
    v_mfma_f32_16x16x32_bf16 v[68:71], v[108:111], a[48:51], v[68:71]
    v_mfma_f32_16x16x32_bf16 v[72:75], v[108:111], a[52:55], v[72:75]
    v_mfma_f32_16x16x32_bf16 v[76:79], v[108:111], a[56:59], v[76:79]
    s_waitcnt lgkmcnt(0)
    s_waitcnt vmcnt(5)
    v_mfma_f32_16x16x32_bf16 v[0:3], v[80:83], a[0:3], v[0:3]
    ds_read_b64_tr_b16 v[96:97], v120 offset:49152
    v_mfma_f32_16x16x32_bf16 v[4:7], v[80:83], a[4:7], v[4:7]
    ds_read_b64_tr_b16 v[98:99], v120 offset:51200
    buffer_load_dwordx4 a[40:43], v112, s[8:11], s50 offen sc1
    v_mfma_f32_16x16x32_bf16 v[8:11], v[80:83], a[8:11], v[8:11]
    ds_read_b64_tr_b16 v[100:101], v121 offset:49152
    v_mfma_f32_16x16x32_bf16 v[12:15], v[80:83], a[12:15], v[12:15]
    ds_read_b64_tr_b16 v[102:103], v121 offset:51200
    buffer_load_dwordx4 a[44:47], v113, s[8:11], s50 offen sc1
    v_mfma_f32_16x16x32_bf16 v[16:19], v[80:83], a[16:19], v[16:19]
    ds_read_b64_tr_b16 v[104:105], v122 offset:49152
    v_mfma_f32_16x16x32_bf16 v[20:23], v[84:87], a[0:3], v[20:23]
    ds_read_b64_tr_b16 v[106:107], v122 offset:51200
    buffer_load_dwordx4 a[48:51], v114, s[8:11], s50 offen sc1
    v_mfma_f32_16x16x32_bf16 v[24:27], v[84:87], a[4:7], v[24:27]
    ds_read_b64_tr_b16 v[108:109], v123 offset:49152
    v_mfma_f32_16x16x32_bf16 v[28:31], v[84:87], a[8:11], v[28:31]
    ds_read_b64_tr_b16 v[110:111], v123 offset:51200
    buffer_load_dwordx4 a[52:55], v115, s[8:11], s50 offen sc1
    v_mfma_f32_16x16x32_bf16 v[32:35], v[84:87], a[12:15], v[32:35]
    v_mfma_f32_16x16x32_bf16 v[36:39], v[84:87], a[16:19], v[36:39]
    buffer_load_dwordx4 a[56:59], v116, s[8:11], s50 offen sc1
    s_add_u32 s50, s50, 1024
    v_mfma_f32_16x16x32_bf16 v[40:43], v[88:91], a[0:3], v[40:43]
    v_mfma_f32_16x16x32_bf16 v[44:47], v[88:91], a[4:7], v[44:47]
    v_mfma_f32_16x16x32_bf16 v[48:51], v[88:91], a[8:11], v[48:51]
    v_mfma_f32_16x16x32_bf16 v[52:55], v[88:91], a[12:15], v[52:55]
    v_mfma_f32_16x16x32_bf16 v[56:59], v[88:91], a[16:19], v[56:59]
    v_mfma_f32_16x16x32_bf16 v[60:63], v[92:95], a[0:3], v[60:63]
    v_mfma_f32_16x16x32_bf16 v[64:67], v[92:95], a[4:7], v[64:67]
    v_mfma_f32_16x16x32_bf16 v[68:71], v[92:95], a[8:11], v[68:71]
    v_mfma_f32_16x16x32_bf16 v[72:75], v[92:95], a[12:15], v[72:75]
    v_mfma_f32_16x16x32_bf16 v[76:79], v[92:95], a[16:19], v[76:79]
    s_waitcnt lgkmcnt(0)
    s_waitcnt vmcnt(5)
    v_mfma_f32_16x16x32_bf16 v[0:3], v[96:99], a[20:23], v[0:3]
    ds_read_b64_tr_b16 v[80:81], v124 offset:0
    v_mfma_f32_16x16x32_bf16 v[4:7], v[96:99], a[24:27], v[4:7]
    ds_read_b64_tr_b16 v[82:83], v124 offset:2048
    buffer_load_dwordx4 a[0:3], v112, s[8:11], s50 offen sc1
    v_mfma_f32_16x16x32_bf16 v[8:11], v[96:99], a[28:31], v[8:11]
    ds_read_b64_tr_b16 v[84:85], v125 offset:0
    v_mfma_f32_16x16x32_bf16 v[12:15], v[96:99], a[32:35], v[12:15]
    ds_read_b64_tr_b16 v[86:87], v125 offset:2048
    buffer_load_dwordx4 a[4:7], v113, s[8:11], s50 offen sc1
    v_mfma_f32_16x16x32_bf16 v[16:19], v[96:99], a[36:39], v[16:19]
    ds_read_b64_tr_b16 v[88:89], v126 offset:0
    v_mfma_f32_16x16x32_bf16 v[20:23], v[100:103], a[20:23], v[20:23]
    ds_read_b64_tr_b16 v[90:91], v126 offset:2048
    buffer_load_dwordx4 a[8:11], v114, s[8:11], s50 offen sc1
    v_mfma_f32_16x16x32_bf16 v[24:27], v[100:103], a[24:27], v[24:27]
    ds_read_b64_tr_b16 v[92:93], v127 offset:0
    v_mfma_f32_16x16x32_bf16 v[28:31], v[100:103], a[28:31], v[28:31]
    ds_read_b64_tr_b16 v[94:95], v127 offset:2048
    buffer_load_dwordx4 a[12:15], v115, s[8:11], s50 offen sc1
    v_mfma_f32_16x16x32_bf16 v[32:35], v[100:103], a[32:35], v[32:35]
    v_mfma_f32_16x16x32_bf16 v[36:39], v[100:103], a[36:39], v[36:39]
    buffer_load_dwordx4 a[16:19], v116, s[8:11], s50 offen sc1
    s_add_u32 s50, s50, 1024
    v_mfma_f32_16x16x32_bf16 v[40:43], v[104:107], a[20:23], v[40:43]
    v_mfma_f32_16x16x32_bf16 v[44:47], v[104:107], a[24:27], v[44:47]
    v_mfma_f32_16x16x32_bf16 v[48:51], v[104:107], a[28:31], v[48:51]
    v_mfma_f32_16x16x32_bf16 v[52:55], v[104:107], a[32:35], v[52:55]
    v_mfma_f32_16x16x32_bf16 v[56:59], v[104:107], a[36:39], v[56:59]
    v_mfma_f32_16x16x32_bf16 v[60:63], v[108:111], a[20:23], v[60:63]
    v_mfma_f32_16x16x32_bf16 v[64:67], v[108:111], a[24:27], v[64:67]
    v_mfma_f32_16x16x32_bf16 v[68:71], v[108:111], a[28:31], v[68:71]
    v_mfma_f32_16x16x32_bf16 v[72:75], v[108:111], a[32:35], v[72:75]
    v_mfma_f32_16x16x32_bf16 v[76:79], v[108:111], a[36:39], v[76:79]
    s_waitcnt lgkmcnt(0)
    s_waitcnt vmcnt(5)
    v_mfma_f32_16x16x32_bf16 v[0:3], v[80:83], a[40:43], v[0:3]
    ds_read_b64_tr_b16 v[96:97], v124 offset:16384
    v_mfma_f32_16x16x32_bf16 v[4:7], v[80:83], a[44:47], v[4:7]
    ds_read_b64_tr_b16 v[98:99], v124 offset:18432
    buffer_load_dwordx4 a[20:23], v112, s[8:11], s50 offen sc1
    v_mfma_f32_16x16x32_bf16 v[8:11], v[80:83], a[48:51], v[8:11]
    ds_read_b64_tr_b16 v[100:101], v125 offset:16384
    v_mfma_f32_16x16x32_bf16 v[12:15], v[80:83], a[52:55], v[12:15]
    ds_read_b64_tr_b16 v[102:103], v125 offset:18432
    buffer_load_dwordx4 a[24:27], v113, s[8:11], s50 offen sc1
    v_mfma_f32_16x16x32_bf16 v[16:19], v[80:83], a[56:59], v[16:19]
    ds_read_b64_tr_b16 v[104:105], v126 offset:16384
    v_mfma_f32_16x16x32_bf16 v[20:23], v[84:87], a[40:43], v[20:23]
    ds_read_b64_tr_b16 v[106:107], v126 offset:18432
    buffer_load_dwordx4 a[28:31], v114, s[8:11], s50 offen sc1
    v_mfma_f32_16x16x32_bf16 v[24:27], v[84:87], a[44:47], v[24:27]
    ds_read_b64_tr_b16 v[108:109], v127 offset:16384
    v_mfma_f32_16x16x32_bf16 v[28:31], v[84:87], a[48:51], v[28:31]
    ds_read_b64_tr_b16 v[110:111], v127 offset:18432
    buffer_load_dwordx4 a[32:35], v115, s[8:11], s50 offen sc1
    v_mfma_f32_16x16x32_bf16 v[32:35], v[84:87], a[52:55], v[32:35]
    v_mfma_f32_16x16x32_bf16 v[36:39], v[84:87], a[56:59], v[36:39]
    buffer_load_dwordx4 a[36:39], v116, s[8:11], s50 offen sc1
    s_add_u32 s50, s50, 1024
    v_mfma_f32_16x16x32_bf16 v[40:43], v[88:91], a[40:43], v[40:43]
    v_mfma_f32_16x16x32_bf16 v[44:47], v[88:91], a[44:47], v[44:47]
    v_mfma_f32_16x16x32_bf16 v[48:51], v[88:91], a[48:51], v[48:51]
    v_mfma_f32_16x16x32_bf16 v[52:55], v[88:91], a[52:55], v[52:55]
    v_mfma_f32_16x16x32_bf16 v[56:59], v[88:91], a[56:59], v[56:59]
    v_mfma_f32_16x16x32_bf16 v[60:63], v[92:95], a[40:43], v[60:63]
    v_mfma_f32_16x16x32_bf16 v[64:67], v[92:95], a[44:47], v[64:67]
    v_mfma_f32_16x16x32_bf16 v[68:71], v[92:95], a[48:51], v[68:71]
    v_mfma_f32_16x16x32_bf16 v[72:75], v[92:95], a[52:55], v[72:75]
    v_mfma_f32_16x16x32_bf16 v[76:79], v[92:95], a[56:59], v[76:79]
    s_waitcnt lgkmcnt(0)
    s_waitcnt vmcnt(5)
    v_mfma_f32_16x16x32_bf16 v[0:3], v[96:99], a[0:3], v[0:3]
    ds_read_b64_tr_b16 v[80:81], v128 offset:0
    v_mfma_f32_16x16x32_bf16 v[4:7], v[96:99], a[4:7], v[4:7]
    ds_read_b64_tr_b16 v[82:83], v128 offset:2048
    buffer_load_dwordx4 a[40:43], v112, s[8:11], s50 offen sc1
    v_mfma_f32_16x16x32_bf16 v[8:11], v[96:99], a[8:11], v[8:11]
    ds_read_b64_tr_b16 v[84:85], v129 offset:0
    v_mfma_f32_16x16x32_bf16 v[12:15], v[96:99], a[12:15], v[12:15]
    ds_read_b64_tr_b16 v[86:87], v129 offset:2048
    buffer_load_dwordx4 a[44:47], v113, s[8:11], s50 offen sc1
    v_mfma_f32_16x16x32_bf16 v[16:19], v[96:99], a[16:19], v[16:19]
    ds_read_b64_tr_b16 v[88:89], v130 offset:0
    v_mfma_f32_16x16x32_bf16 v[20:23], v[100:103], a[0:3], v[20:23]
    ds_read_b64_tr_b16 v[90:91], v130 offset:2048
    buffer_load_dwordx4 a[48:51], v114, s[8:11], s50 offen sc1
    v_mfma_f32_16x16x32_bf16 v[24:27], v[100:103], a[4:7], v[24:27]
    ds_read_b64_tr_b16 v[92:93], v131 offset:0
    v_mfma_f32_16x16x32_bf16 v[28:31], v[100:103], a[8:11], v[28:31]
    ds_read_b64_tr_b16 v[94:95], v131 offset:2048
    buffer_load_dwordx4 a[52:55], v115, s[8:11], s50 offen sc1
    v_mfma_f32_16x16x32_bf16 v[32:35], v[100:103], a[12:15], v[32:35]
    v_mfma_f32_16x16x32_bf16 v[36:39], v[100:103], a[16:19], v[36:39]
    buffer_load_dwordx4 a[56:59], v116, s[8:11], s50 offen sc1
    s_add_u32 s50, s50, 1024
    v_mfma_f32_16x16x32_bf16 v[40:43], v[104:107], a[0:3], v[40:43]
    v_mfma_f32_16x16x32_bf16 v[44:47], v[104:107], a[4:7], v[44:47]
    v_mfma_f32_16x16x32_bf16 v[48:51], v[104:107], a[8:11], v[48:51]
    v_mfma_f32_16x16x32_bf16 v[52:55], v[104:107], a[12:15], v[52:55]
    v_mfma_f32_16x16x32_bf16 v[56:59], v[104:107], a[16:19], v[56:59]
    v_mfma_f32_16x16x32_bf16 v[60:63], v[108:111], a[0:3], v[60:63]
    v_mfma_f32_16x16x32_bf16 v[64:67], v[108:111], a[4:7], v[64:67]
    v_mfma_f32_16x16x32_bf16 v[68:71], v[108:111], a[8:11], v[68:71]
    v_mfma_f32_16x16x32_bf16 v[72:75], v[108:111], a[12:15], v[72:75]
    v_mfma_f32_16x16x32_bf16 v[76:79], v[108:111], a[16:19], v[76:79]
    s_waitcnt lgkmcnt(0)
    s_waitcnt vmcnt(5)
    v_mfma_f32_16x16x32_bf16 v[0:3], v[80:83], a[20:23], v[0:3]
    ds_read_b64_tr_b16 v[96:97], v128 offset:16384
    v_mfma_f32_16x16x32_bf16 v[4:7], v[80:83], a[24:27], v[4:7]
    ds_read_b64_tr_b16 v[98:99], v128 offset:18432
    buffer_load_dwordx4 a[0:3], v112, s[8:11], s50 offen sc1
    v_mfma_f32_16x16x32_bf16 v[8:11], v[80:83], a[28:31], v[8:11]
    ds_read_b64_tr_b16 v[100:101], v129 offset:16384
    v_mfma_f32_16x16x32_bf16 v[12:15], v[80:83], a[32:35], v[12:15]
    ds_read_b64_tr_b16 v[102:103], v129 offset:18432
    buffer_load_dwordx4 a[4:7], v113, s[8:11], s50 offen sc1
    v_mfma_f32_16x16x32_bf16 v[16:19], v[80:83], a[36:39], v[16:19]
    ds_read_b64_tr_b16 v[104:105], v130 offset:16384
    v_mfma_f32_16x16x32_bf16 v[20:23], v[84:87], a[20:23], v[20:23]
    ds_read_b64_tr_b16 v[106:107], v130 offset:18432
    buffer_load_dwordx4 a[8:11], v114, s[8:11], s50 offen sc1
    v_mfma_f32_16x16x32_bf16 v[24:27], v[84:87], a[24:27], v[24:27]
    ds_read_b64_tr_b16 v[108:109], v131 offset:16384
    v_mfma_f32_16x16x32_bf16 v[28:31], v[84:87], a[28:31], v[28:31]
    ds_read_b64_tr_b16 v[110:111], v131 offset:18432
    buffer_load_dwordx4 a[12:15], v115, s[8:11], s50 offen sc1
    v_mfma_f32_16x16x32_bf16 v[32:35], v[84:87], a[32:35], v[32:35]
    v_mfma_f32_16x16x32_bf16 v[36:39], v[84:87], a[36:39], v[36:39]
    buffer_load_dwordx4 a[16:19], v116, s[8:11], s50 offen sc1
    s_add_u32 s50, s50, 1024
    v_mfma_f32_16x16x32_bf16 v[40:43], v[88:91], a[20:23], v[40:43]
    v_mfma_f32_16x16x32_bf16 v[44:47], v[88:91], a[24:27], v[44:47]
    v_mfma_f32_16x16x32_bf16 v[48:51], v[88:91], a[28:31], v[48:51]
    v_mfma_f32_16x16x32_bf16 v[52:55], v[88:91], a[32:35], v[52:55]
    v_mfma_f32_16x16x32_bf16 v[56:59], v[88:91], a[36:39], v[56:59]
    v_mfma_f32_16x16x32_bf16 v[60:63], v[92:95], a[20:23], v[60:63]
    v_mfma_f32_16x16x32_bf16 v[64:67], v[92:95], a[24:27], v[64:67]
    v_mfma_f32_16x16x32_bf16 v[68:71], v[92:95], a[28:31], v[68:71]
    v_mfma_f32_16x16x32_bf16 v[72:75], v[92:95], a[32:35], v[72:75]
    v_mfma_f32_16x16x32_bf16 v[76:79], v[92:95], a[36:39], v[76:79]
    s_waitcnt lgkmcnt(0)
    s_waitcnt vmcnt(5)
    v_mfma_f32_16x16x32_bf16 v[0:3], v[96:99], a[40:43], v[0:3]
    ds_read_b64_tr_b16 v[80:81], v124 offset:32768
    v_mfma_f32_16x16x32_bf16 v[4:7], v[96:99], a[44:47], v[4:7]
    ds_read_b64_tr_b16 v[82:83], v124 offset:34816
    buffer_load_dwordx4 a[20:23], v112, s[8:11], s50 offen sc1
    v_mfma_f32_16x16x32_bf16 v[8:11], v[96:99], a[48:51], v[8:11]
    ds_read_b64_tr_b16 v[84:85], v125 offset:32768
    v_mfma_f32_16x16x32_bf16 v[12:15], v[96:99], a[52:55], v[12:15]
    ds_read_b64_tr_b16 v[86:87], v125 offset:34816
    buffer_load_dwordx4 a[24:27], v113, s[8:11], s50 offen sc1
    v_mfma_f32_16x16x32_bf16 v[16:19], v[96:99], a[56:59], v[16:19]
    ds_read_b64_tr_b16 v[88:89], v126 offset:32768
    v_mfma_f32_16x16x32_bf16 v[20:23], v[100:103], a[40:43], v[20:23]
    ds_read_b64_tr_b16 v[90:91], v126 offset:34816
    buffer_load_dwordx4 a[28:31], v114, s[8:11], s50 offen sc1
    v_mfma_f32_16x16x32_bf16 v[24:27], v[100:103], a[44:47], v[24:27]
    ds_read_b64_tr_b16 v[92:93], v127 offset:32768
    v_mfma_f32_16x16x32_bf16 v[28:31], v[100:103], a[48:51], v[28:31]
    ds_read_b64_tr_b16 v[94:95], v127 offset:34816
    buffer_load_dwordx4 a[32:35], v115, s[8:11], s50 offen sc1
    v_mfma_f32_16x16x32_bf16 v[32:35], v[100:103], a[52:55], v[32:35]
    v_mfma_f32_16x16x32_bf16 v[36:39], v[100:103], a[56:59], v[36:39]
    buffer_load_dwordx4 a[36:39], v116, s[8:11], s50 offen sc1
    s_add_u32 s50, s50, 1024
    v_mfma_f32_16x16x32_bf16 v[40:43], v[104:107], a[40:43], v[40:43]
    v_mfma_f32_16x16x32_bf16 v[44:47], v[104:107], a[44:47], v[44:47]
    v_mfma_f32_16x16x32_bf16 v[48:51], v[104:107], a[48:51], v[48:51]
    v_mfma_f32_16x16x32_bf16 v[52:55], v[104:107], a[52:55], v[52:55]
    v_mfma_f32_16x16x32_bf16 v[56:59], v[104:107], a[56:59], v[56:59]
    v_mfma_f32_16x16x32_bf16 v[60:63], v[108:111], a[40:43], v[60:63]
    v_mfma_f32_16x16x32_bf16 v[64:67], v[108:111], a[44:47], v[64:67]
    v_mfma_f32_16x16x32_bf16 v[68:71], v[108:111], a[48:51], v[68:71]
    v_mfma_f32_16x16x32_bf16 v[72:75], v[108:111], a[52:55], v[72:75]
    v_mfma_f32_16x16x32_bf16 v[76:79], v[108:111], a[56:59], v[76:79]
    s_waitcnt lgkmcnt(0)
    s_waitcnt vmcnt(5)
    v_mfma_f32_16x16x32_bf16 v[0:3], v[80:83], a[0:3], v[0:3]
    ds_read_b64_tr_b16 v[96:97], v124 offset:49152
    v_mfma_f32_16x16x32_bf16 v[4:7], v[80:83], a[4:7], v[4:7]
    ds_read_b64_tr_b16 v[98:99], v124 offset:51200
    v_mfma_f32_16x16x32_bf16 v[8:11], v[80:83], a[8:11], v[8:11]
    ds_read_b64_tr_b16 v[100:101], v125 offset:49152
    v_mfma_f32_16x16x32_bf16 v[12:15], v[80:83], a[12:15], v[12:15]
    ds_read_b64_tr_b16 v[102:103], v125 offset:51200
    v_mfma_f32_16x16x32_bf16 v[16:19], v[80:83], a[16:19], v[16:19]
    ds_read_b64_tr_b16 v[104:105], v126 offset:49152
    v_mfma_f32_16x16x32_bf16 v[20:23], v[84:87], a[0:3], v[20:23]
    ds_read_b64_tr_b16 v[106:107], v126 offset:51200
    v_mfma_f32_16x16x32_bf16 v[24:27], v[84:87], a[4:7], v[24:27]
    ds_read_b64_tr_b16 v[108:109], v127 offset:49152
    v_mfma_f32_16x16x32_bf16 v[28:31], v[84:87], a[8:11], v[28:31]
    ds_read_b64_tr_b16 v[110:111], v127 offset:51200
    v_mfma_f32_16x16x32_bf16 v[32:35], v[84:87], a[12:15], v[32:35]
    v_mfma_f32_16x16x32_bf16 v[36:39], v[84:87], a[16:19], v[36:39]
    v_mfma_f32_16x16x32_bf16 v[40:43], v[88:91], a[0:3], v[40:43]
    v_mfma_f32_16x16x32_bf16 v[44:47], v[88:91], a[4:7], v[44:47]
    v_mfma_f32_16x16x32_bf16 v[48:51], v[88:91], a[8:11], v[48:51]
    v_mfma_f32_16x16x32_bf16 v[52:55], v[88:91], a[12:15], v[52:55]
    v_mfma_f32_16x16x32_bf16 v[56:59], v[88:91], a[16:19], v[56:59]
    v_mfma_f32_16x16x32_bf16 v[60:63], v[92:95], a[0:3], v[60:63]
    v_mfma_f32_16x16x32_bf16 v[64:67], v[92:95], a[4:7], v[64:67]
    v_mfma_f32_16x16x32_bf16 v[68:71], v[92:95], a[8:11], v[68:71]
    v_mfma_f32_16x16x32_bf16 v[72:75], v[92:95], a[12:15], v[72:75]
    v_mfma_f32_16x16x32_bf16 v[76:79], v[92:95], a[16:19], v[76:79]
    s_waitcnt lgkmcnt(0)
    s_waitcnt vmcnt(0)
    v_mfma_f32_16x16x32_bf16 v[0:3], v[96:99], a[20:23], v[0:3]
    v_mfma_f32_16x16x32_bf16 v[4:7], v[96:99], a[24:27], v[4:7]
    v_mfma_f32_16x16x32_bf16 v[8:11], v[96:99], a[28:31], v[8:11]
    v_mfma_f32_16x16x32_bf16 v[12:15], v[96:99], a[32:35], v[12:15]
    v_mfma_f32_16x16x32_bf16 v[16:19], v[96:99], a[36:39], v[16:19]
    v_mfma_f32_16x16x32_bf16 v[20:23], v[100:103], a[20:23], v[20:23]
    v_mfma_f32_16x16x32_bf16 v[24:27], v[100:103], a[24:27], v[24:27]
    v_mfma_f32_16x16x32_bf16 v[28:31], v[100:103], a[28:31], v[28:31]
    v_mfma_f32_16x16x32_bf16 v[32:35], v[100:103], a[32:35], v[32:35]
    v_mfma_f32_16x16x32_bf16 v[36:39], v[100:103], a[36:39], v[36:39]
    v_mfma_f32_16x16x32_bf16 v[40:43], v[104:107], a[20:23], v[40:43]
    v_mfma_f32_16x16x32_bf16 v[44:47], v[104:107], a[24:27], v[44:47]
    v_mfma_f32_16x16x32_bf16 v[48:51], v[104:107], a[28:31], v[48:51]
    v_mfma_f32_16x16x32_bf16 v[52:55], v[104:107], a[32:35], v[52:55]
    v_mfma_f32_16x16x32_bf16 v[56:59], v[104:107], a[36:39], v[56:59]
    v_mfma_f32_16x16x32_bf16 v[60:63], v[108:111], a[20:23], v[60:63]
    v_mfma_f32_16x16x32_bf16 v[64:67], v[108:111], a[24:27], v[64:67]
    v_mfma_f32_16x16x32_bf16 v[68:71], v[108:111], a[28:31], v[68:71]
    v_mfma_f32_16x16x32_bf16 v[72:75], v[108:111], a[32:35], v[72:75]
    v_mfma_f32_16x16x32_bf16 v[76:79], v[108:111], a[36:39], v[76:79]
    v_lshlrev_b32 v132, 4, v227
    v_add_u32 v133, s35, v132
    v_add_u32 v138, 65536, v133
    v_and_b32 v134, 15, v227
    v_lshrrev_b32 v135, 4, v227
    v_add_u32 v134, s44, v134
    s_movk_i32 s39, 1152
    v_lshlrev_b32 v135, 3, v135
    v_mad_u32_u24 v134, v134, s39, v135
    s_lshl_b32 s39, s24, 10
    v_add_u32 v136, s39, v132
    v_add_u32 v137, 65536, v136
    ds_write_b128 v133, v[0:3] offset:0
    ds_write_b128 v133, v[4:7] offset:1024
    ds_write_b128 v133, v[8:11] offset:2048
    ds_write_b128 v133, v[12:15] offset:3072
    ds_write_b128 v133, v[16:19] offset:16384
    ds_write_b128 v133, v[20:23] offset:17408
    ds_write_b128 v133, v[24:27] offset:18432
    ds_write_b128 v133, v[28:31] offset:19456
    ds_write_b128 v133, v[32:35] offset:32768
    ds_write_b128 v133, v[36:39] offset:33792
    ds_write_b128 v133, v[40:43] offset:34816
    ds_write_b128 v133, v[44:47] offset:35840
    ds_write_b128 v133, v[48:51] offset:49152
    ds_write_b128 v133, v[52:55] offset:50176
    ds_write_b128 v133, v[56:59] offset:51200
    ds_write_b128 v133, v[60:63] offset:52224
    ds_write_b128 v138, v[64:67] offset:0
    ds_write_b128 v138, v[68:71] offset:1024
    ds_write_b128 v138, v[72:75] offset:2048
    ds_write_b128 v138, v[76:79] offset:3072
    s_waitcnt lgkmcnt(0)
    s_barrier
    ds_read_b128 v[0:3], v136 offset:0
    ds_read_b128 v[4:7], v136 offset:4096
    ds_read_b128 v[8:11], v136 offset:8192
    ds_read_b128 v[12:15], v136 offset:12288
    ds_read_b128 v[16:19], v136 offset:16384
    ds_read_b128 v[20:23], v136 offset:20480
    ds_read_b128 v[24:27], v136 offset:24576
    ds_read_b128 v[28:31], v136 offset:28672
    ds_read_b128 v[32:35], v136 offset:32768
    ds_read_b128 v[36:39], v136 offset:36864
    ds_read_b128 v[40:43], v136 offset:40960
    ds_read_b128 v[44:47], v136 offset:45056
    ds_read_b128 v[48:51], v136 offset:49152
    ds_read_b128 v[52:55], v136 offset:53248
    ds_read_b128 v[56:59], v136 offset:57344
    ds_read_b128 v[60:63], v136 offset:61440
    ds_read_b128 v[64:67], v137 offset:0
    ds_read_b128 v[68:71], v137 offset:4096
    ds_read_b128 v[72:75], v137 offset:8192
    ds_read_b128 v[76:79], v137 offset:12288
    s_add_u32 s27, s24, 0
    s_mul_i32 s28, s27, 52
    s_lshr_b32 s28, s28, 8
    s_mul_i32 s29, s28, 5
    s_sub_u32 s29, s27, s29
    s_mul_i32 s29, s29, 18432
    s_lshl_b32 s30, s28, 4
    s_add_u32 s30, s30, s45
    s_lshl_b32 s30, s30, 1
    s_add_u32 s29, s29, s30
    s_waitcnt lgkmcnt(15)
    v_add_f32 v0, v0, v4
    v_add_f32 v8, v8, v12
    v_add_f32 v1, v1, v5
    v_add_f32 v9, v9, v13
    v_add_f32 v2, v2, v6
    v_add_f32 v10, v10, v14
    v_add_f32 v3, v3, v7
    v_add_f32 v11, v11, v15
    v_add_f32 v0, v0, v8
    v_add_f32 v1, v1, v9
    v_add_f32 v2, v2, v10
    v_add_f32 v3, v3, v11
    v_cvt_pk_bf16_f32 v4, v0, v1
    v_cvt_pk_bf16_f32 v5, v2, v3
    buffer_store_dwordx2 v[4:5], v134, s[40:43], s29 offen
    s_add_u32 s27, s24, 4
    s_mul_i32 s28, s27, 52
    s_lshr_b32 s28, s28, 8
    s_mul_i32 s29, s28, 5
    s_sub_u32 s29, s27, s29
    s_mul_i32 s29, s29, 18432
    s_lshl_b32 s30, s28, 4
    s_add_u32 s30, s30, s45
    s_lshl_b32 s30, s30, 1
    s_add_u32 s29, s29, s30
    s_waitcnt lgkmcnt(12)
    v_add_f32 v16, v16, v20
    v_add_f32 v24, v24, v28
    v_add_f32 v17, v17, v21
    v_add_f32 v25, v25, v29
    v_add_f32 v18, v18, v22
    v_add_f32 v26, v26, v30
    v_add_f32 v19, v19, v23
    v_add_f32 v27, v27, v31
    v_add_f32 v16, v16, v24
    v_add_f32 v17, v17, v25
    v_add_f32 v18, v18, v26
    v_add_f32 v19, v19, v27
    v_cvt_pk_bf16_f32 v20, v16, v17
    v_cvt_pk_bf16_f32 v21, v18, v19
    buffer_store_dwordx2 v[20:21], v134, s[40:43], s29 offen
    s_add_u32 s27, s24, 8
    s_mul_i32 s28, s27, 52
    s_lshr_b32 s28, s28, 8
    s_mul_i32 s29, s28, 5
    s_sub_u32 s29, s27, s29
    s_mul_i32 s29, s29, 18432
    s_lshl_b32 s30, s28, 4
    s_add_u32 s30, s30, s45
    s_lshl_b32 s30, s30, 1
    s_add_u32 s29, s29, s30
    s_waitcnt lgkmcnt(8)
    v_add_f32 v32, v32, v36
    v_add_f32 v40, v40, v44
    v_add_f32 v33, v33, v37
    v_add_f32 v41, v41, v45
    v_add_f32 v34, v34, v38
    v_add_f32 v42, v42, v46
    v_add_f32 v35, v35, v39
    v_add_f32 v43, v43, v47
    v_add_f32 v32, v32, v40
    v_add_f32 v33, v33, v41
    v_add_f32 v34, v34, v42
    v_add_f32 v35, v35, v43
    v_cvt_pk_bf16_f32 v36, v32, v33
    v_cvt_pk_bf16_f32 v37, v34, v35
    buffer_store_dwordx2 v[36:37], v134, s[40:43], s29 offen
    s_add_u32 s27, s24, 12
    s_mul_i32 s28, s27, 52
    s_lshr_b32 s28, s28, 8
    s_mul_i32 s29, s28, 5
    s_sub_u32 s29, s27, s29
    s_mul_i32 s29, s29, 18432
    s_lshl_b32 s30, s28, 4
    s_add_u32 s30, s30, s45
    s_lshl_b32 s30, s30, 1
    s_add_u32 s29, s29, s30
    s_waitcnt lgkmcnt(4)
    v_add_f32 v48, v48, v52
    v_add_f32 v56, v56, v60
    v_add_f32 v49, v49, v53
    v_add_f32 v57, v57, v61
    v_add_f32 v50, v50, v54
    v_add_f32 v58, v58, v62
    v_add_f32 v51, v51, v55
    v_add_f32 v59, v59, v63
    v_add_f32 v48, v48, v56
    v_add_f32 v49, v49, v57
    v_add_f32 v50, v50, v58
    v_add_f32 v51, v51, v59
    v_cvt_pk_bf16_f32 v52, v48, v49
    v_cvt_pk_bf16_f32 v53, v50, v51
    buffer_store_dwordx2 v[52:53], v134, s[40:43], s29 offen
    s_add_u32 s27, s24, 16
    s_mul_i32 s28, s27, 52
    s_lshr_b32 s28, s28, 8
    s_mul_i32 s29, s28, 5
    s_sub_u32 s29, s27, s29
    s_mul_i32 s29, s29, 18432
    s_lshl_b32 s30, s28, 4
    s_add_u32 s30, s30, s45
    s_lshl_b32 s30, s30, 1
    s_add_u32 s29, s29, s30
    s_waitcnt lgkmcnt(0)
    v_add_f32 v64, v64, v68
    v_add_f32 v72, v72, v76
    v_add_f32 v65, v65, v69
    v_add_f32 v73, v73, v77
    v_add_f32 v66, v66, v70
    v_add_f32 v74, v74, v78
    v_add_f32 v67, v67, v71
    v_add_f32 v75, v75, v79
    v_add_f32 v64, v64, v72
    v_add_f32 v65, v65, v73
    v_add_f32 v66, v66, v74
    v_add_f32 v67, v67, v75
    v_cvt_pk_bf16_f32 v68, v64, v65
    v_cvt_pk_bf16_f32 v69, v66, v67
    buffer_store_dwordx2 v[68:69], v134, s[40:43], s29 offen
L_done:
    s_endpgm
L_loop3:
    s_waitcnt vmcnt(24) lgkmcnt(0)
    s_barrier
    s_add_u32 m0, s35, 98304
    v_mfma_f32_16x16x32_bf16 v[128:131], a[64:67], a[0:3], v[152:155]
    v_exp_f32 v136, v136
    v_mfma_f32_16x16x32_bf16 v[128:131], a[68:71], a[4:7], v[128:131]
    ds_read_b128 a[96:99], v176 offset:49152
    v_mfma_f32_16x16x32_bf16 v[128:131], a[72:75], a[8:11], v[128:131]
    v_exp_f32 v137, v137
    v_mfma_f32_16x16x32_bf16 v[128:131], a[76:79], a[12:15], v[128:131]
    ds_read_b128 a[100:103], v177 offset:49152
    v_cvt_pk_bf16_f32 v148, v136, v137
    v_mfma_f32_16x16x32_bf16 v[132:135], a[80:83], a[0:3], v[152:155]
    v_exp_f32 v138, v138
    v_mfma_f32_16x16x32_bf16 v[132:135], a[84:87], a[4:7], v[132:135]
    ds_read_b128 a[104:107], v178 offset:49152
    v_mfma_f32_16x16x32_bf16 v[132:135], a[88:91], a[8:11], v[132:135]
    v_exp_f32 v139, v139
    v_mfma_f32_16x16x32_bf16 v[132:135], a[92:95], a[12:15], v[132:135]
    ds_read_b128 a[108:111], v179 offset:49152
    v_cvt_pk_bf16_f32 v149, v138, v139
    v_mfma_f32_16x16x32_bf16 v[4:7], a[160:163], v[144:147], v[4:7]
    v_exp_f32 v140, v140
    v_mfma_f32_16x16x32_bf16 v[20:23], a[164:167], v[144:147], v[20:23]
    ds_read_b128 a[112:115], v176 offset:57344
    v_mfma_f32_16x16x32_bf16 v[36:39], a[168:171], v[144:147], v[36:39]
    v_exp_f32 v141, v141
    v_mfma_f32_16x16x32_bf16 v[52:55], a[172:175], v[144:147], v[52:55]
    ds_read_b128 a[116:119], v177 offset:57344
    v_cvt_pk_bf16_f32 v150, v140, v141
    v_mfma_f32_16x16x32_bf16 v[68:71], a[176:179], v[144:147], v[68:71]
    v_exp_f32 v142, v142
    v_mfma_f32_16x16x32_bf16 v[84:87], a[180:183], v[144:147], v[84:87]
    ds_read_b128 a[120:123], v178 offset:57344
    v_mfma_f32_16x16x32_bf16 v[100:103], a[184:187], v[144:147], v[100:103]
    v_exp_f32 v143, v143
    v_mfma_f32_16x16x32_bf16 v[116:119], a[188:191], v[144:147], v[116:119]
    ds_read_b128 a[124:127], v179 offset:57344
    v_cvt_pk_bf16_f32 v151, v142, v143
    v_mfma_f32_16x16x32_bf16 v[204:207], v[216:219], v[144:147], v[204:207]
    buffer_load_dwordx4 v196, s[12:15], s27 offen nt lds
    v_mfma_f32_16x16x32_bf16 v[136:139], a[64:67], a[16:19], v[156:159]
    v_exp_f32 v128, v128
    v_mfma_f32_16x16x32_bf16 v[136:139], a[68:71], a[20:23], v[136:139]
    v_mfma_f32_16x16x32_bf16 v[136:139], a[72:75], a[24:27], v[136:139]
    v_exp_f32 v129, v129
    v_mfma_f32_16x16x32_bf16 v[136:139], a[76:79], a[28:31], v[136:139]
    v_cvt_pk_bf16_f32 v144, v128, v129
    v_mfma_f32_16x16x32_bf16 v[140:143], a[80:83], a[16:19], v[156:159]
    v_exp_f32 v130, v130
    v_mfma_f32_16x16x32_bf16 v[140:143], a[84:87], a[20:23], v[140:143]
    buffer_load_dwordx4 v197, s[12:15], s27 offen offset:1024 nt lds
    v_mfma_f32_16x16x32_bf16 v[140:143], a[88:91], a[24:27], v[140:143]
    v_exp_f32 v131, v131
    v_mfma_f32_16x16x32_bf16 v[140:143], a[92:95], a[28:31], v[140:143]
    v_cvt_pk_bf16_f32 v145, v130, v131
    v_mfma_f32_16x16x32_bf16 v[8:11], a[160:163], v[148:151], v[8:11]
    v_exp_f32 v132, v132
    v_mfma_f32_16x16x32_bf16 v[24:27], a[164:167], v[148:151], v[24:27]
    ds_read_b64_tr_b16 a[160:161], v188 offset:49152
    v_mfma_f32_16x16x32_bf16 v[40:43], a[168:171], v[148:151], v[40:43]
    ds_read_b64_tr_b16 a[162:163], v188 offset:57344
    v_exp_f32 v133, v133
    v_mfma_f32_16x16x32_bf16 v[56:59], a[172:175], v[148:151], v[56:59]
    ds_read_b64_tr_b16 a[164:165], v189 offset:49152
    v_cvt_pk_bf16_f32 v146, v132, v133
    v_mfma_f32_16x16x32_bf16 v[72:75], a[176:179], v[148:151], v[72:75]
    ds_read_b64_tr_b16 a[166:167], v189 offset:57344
    v_exp_f32 v134, v134
    v_mfma_f32_16x16x32_bf16 v[88:91], a[180:183], v[148:151], v[88:91]
    ds_read_b64_tr_b16 a[168:169], v190 offset:49152
    v_mfma_f32_16x16x32_bf16 v[104:107], a[184:187], v[148:151], v[104:107]
    ds_read_b64_tr_b16 a[170:171], v190 offset:57344
    v_exp_f32 v135, v135
    v_mfma_f32_16x16x32_bf16 v[120:123], a[188:191], v[148:151], v[120:123]
    v_cvt_pk_bf16_f32 v147, v134, v135
    v_mfma_f32_16x16x32_bf16 v[208:211], v[216:219], v[148:151], v[208:211]
    buffer_load_dwordx4 v198, s[16:19], s27 offen offset:2048 nt lds
    v_mfma_f32_16x16x32_bf16 v[128:131], a[64:67], a[32:35], v[160:163]
    v_exp_f32 v136, v136
    v_mfma_f32_16x16x32_bf16 v[128:131], a[68:71], a[36:39], v[128:131]
    ds_read_b64_tr_b16 a[172:173], v191 offset:49152
    v_mfma_f32_16x16x32_bf16 v[128:131], a[72:75], a[40:43], v[128:131]
    ds_read_b64_tr_b16 a[174:175], v191 offset:57344
    v_exp_f32 v137, v137
    v_mfma_f32_16x16x32_bf16 v[128:131], a[76:79], a[44:47], v[128:131]
    ds_read_b64_tr_b16 a[176:177], v192 offset:49152
    v_cvt_pk_bf16_f32 v148, v136, v137
    v_mfma_f32_16x16x32_bf16 v[132:135], a[80:83], a[32:35], v[160:163]
    ds_read_b64_tr_b16 a[178:179], v192 offset:57344
    v_exp_f32 v138, v138
    v_mfma_f32_16x16x32_bf16 v[132:135], a[84:87], a[36:39], v[132:135]
    ds_read_b64_tr_b16 a[180:181], v193 offset:49152
    v_mfma_f32_16x16x32_bf16 v[132:135], a[88:91], a[40:43], v[132:135]
    ds_read_b64_tr_b16 a[182:183], v193 offset:57344
    v_exp_f32 v139, v139
    v_mfma_f32_16x16x32_bf16 v[132:135], a[92:95], a[44:47], v[132:135]
    ds_read_b64_tr_b16 a[184:185], v194 offset:49152
    v_cvt_pk_bf16_f32 v149, v138, v139
    v_mfma_f32_16x16x32_bf16 v[0:3], a[128:131], v[144:147], v[0:3]
    v_exp_f32 v140, v140
    v_mfma_f32_16x16x32_bf16 v[16:19], a[132:135], v[144:147], v[16:19]
    ds_read_b64_tr_b16 a[186:187], v194 offset:57344
    v_mfma_f32_16x16x32_bf16 v[32:35], a[136:139], v[144:147], v[32:35]
    ds_read_b64_tr_b16 a[188:189], v195 offset:49152
    v_exp_f32 v141, v141
    v_mfma_f32_16x16x32_bf16 v[48:51], a[140:143], v[144:147], v[48:51]
    ds_read_b64_tr_b16 a[190:191], v195 offset:57344
    v_cvt_pk_bf16_f32 v150, v140, v141
    v_mfma_f32_16x16x32_bf16 v[64:67], a[144:147], v[144:147], v[64:67]
    v_exp_f32 v142, v142
    v_mfma_f32_16x16x32_bf16 v[80:83], a[148:151], v[144:147], v[80:83]
    buffer_load_dwordx4 v199, s[16:19], s27 offen offset:3072 nt lds
    s_add_u32 s27, s27, 8192
    v_mfma_f32_16x16x32_bf16 v[96:99], a[152:155], v[144:147], v[96:99]
    v_exp_f32 v143, v143
    v_mfma_f32_16x16x32_bf16 v[112:115], a[156:159], v[144:147], v[112:115]
    v_cvt_pk_bf16_f32 v151, v142, v143
    v_mfma_f32_16x16x32_bf16 v[200:203], v[216:219], v[144:147], v[200:203]
    s_waitcnt vmcnt(24) lgkmcnt(0)
    s_barrier
    s_add_u32 m0, s35, 114688
    v_mfma_f32_16x16x32_bf16 v[136:139], a[96:99], a[0:3], v[152:155]
    v_exp_f32 v128, v128
    v_mfma_f32_16x16x32_bf16 v[136:139], a[100:103], a[4:7], v[136:139]
    ds_read_b128 a[64:67], v172 offset:0
    v_mfma_f32_16x16x32_bf16 v[136:139], a[104:107], a[8:11], v[136:139]
    v_exp_f32 v129, v129
    v_mfma_f32_16x16x32_bf16 v[136:139], a[108:111], a[12:15], v[136:139]
    ds_read_b128 a[68:71], v173 offset:0
    v_cvt_pk_bf16_f32 v144, v128, v129
    v_mfma_f32_16x16x32_bf16 v[140:143], a[112:115], a[0:3], v[152:155]
    v_exp_f32 v130, v130
    v_mfma_f32_16x16x32_bf16 v[140:143], a[116:119], a[4:7], v[140:143]
    ds_read_b128 a[72:75], v174 offset:0
    v_mfma_f32_16x16x32_bf16 v[140:143], a[120:123], a[8:11], v[140:143]
    v_exp_f32 v131, v131
    v_mfma_f32_16x16x32_bf16 v[140:143], a[124:127], a[12:15], v[140:143]
    ds_read_b128 a[76:79], v175 offset:0
    v_cvt_pk_bf16_f32 v145, v130, v131
    v_mfma_f32_16x16x32_bf16 v[4:7], a[128:131], v[148:151], v[4:7]
    v_exp_f32 v132, v132
    v_mfma_f32_16x16x32_bf16 v[20:23], a[132:135], v[148:151], v[20:23]
    ds_read_b128 a[80:83], v172 offset:8192
    v_mfma_f32_16x16x32_bf16 v[36:39], a[136:139], v[148:151], v[36:39]
    v_exp_f32 v133, v133
    v_mfma_f32_16x16x32_bf16 v[52:55], a[140:143], v[148:151], v[52:55]
    ds_read_b128 a[84:87], v173 offset:8192
    v_cvt_pk_bf16_f32 v146, v132, v133
    v_mfma_f32_16x16x32_bf16 v[68:71], a[144:147], v[148:151], v[68:71]
    v_exp_f32 v134, v134
    v_mfma_f32_16x16x32_bf16 v[84:87], a[148:151], v[148:151], v[84:87]
    ds_read_b128 a[88:91], v174 offset:8192
    v_mfma_f32_16x16x32_bf16 v[100:103], a[152:155], v[148:151], v[100:103]
    v_exp_f32 v135, v135
    v_mfma_f32_16x16x32_bf16 v[116:119], a[156:159], v[148:151], v[116:119]
    ds_read_b128 a[92:95], v175 offset:8192
    v_cvt_pk_bf16_f32 v147, v134, v135
    v_mfma_f32_16x16x32_bf16 v[204:207], v[216:219], v[148:151], v[204:207]
    buffer_load_dwordx4 v196, s[12:15], s27 offen nt lds
    v_mfma_f32_16x16x32_bf16 v[128:131], a[96:99], a[16:19], v[156:159]
    v_exp_f32 v136, v136
    v_mfma_f32_16x16x32_bf16 v[128:131], a[100:103], a[20:23], v[128:131]
    v_mfma_f32_16x16x32_bf16 v[128:131], a[104:107], a[24:27], v[128:131]
    v_exp_f32 v137, v137
    v_mfma_f32_16x16x32_bf16 v[128:131], a[108:111], a[28:31], v[128:131]
    v_cvt_pk_bf16_f32 v148, v136, v137
    v_mfma_f32_16x16x32_bf16 v[132:135], a[112:115], a[16:19], v[156:159]
    v_exp_f32 v138, v138
    v_mfma_f32_16x16x32_bf16 v[132:135], a[116:119], a[20:23], v[132:135]
    buffer_load_dwordx4 v197, s[12:15], s27 offen offset:1024 nt lds
    v_mfma_f32_16x16x32_bf16 v[132:135], a[120:123], a[24:27], v[132:135]
    v_exp_f32 v139, v139
    v_mfma_f32_16x16x32_bf16 v[132:135], a[124:127], a[28:31], v[132:135]
    v_cvt_pk_bf16_f32 v149, v138, v139
    v_mfma_f32_16x16x32_bf16 v[8:11], a[128:131], v[144:147], v[8:11]
    v_exp_f32 v140, v140
    v_mfma_f32_16x16x32_bf16 v[24:27], a[132:135], v[144:147], v[24:27]
    ds_read_b64_tr_b16 a[128:129], v180 offset:0
    v_mfma_f32_16x16x32_bf16 v[40:43], a[136:139], v[144:147], v[40:43]
    ds_read_b64_tr_b16 a[130:131], v180 offset:8192
    v_exp_f32 v141, v141
    v_mfma_f32_16x16x32_bf16 v[56:59], a[140:143], v[144:147], v[56:59]
    ds_read_b64_tr_b16 a[132:133], v181 offset:0
    v_cvt_pk_bf16_f32 v150, v140, v141
    v_mfma_f32_16x16x32_bf16 v[72:75], a[144:147], v[144:147], v[72:75]
    ds_read_b64_tr_b16 a[134:135], v181 offset:8192
    v_exp_f32 v142, v142
    v_mfma_f32_16x16x32_bf16 v[88:91], a[148:151], v[144:147], v[88:91]
    ds_read_b64_tr_b16 a[136:137], v182 offset:0
    v_mfma_f32_16x16x32_bf16 v[104:107], a[152:155], v[144:147], v[104:107]
    ds_read_b64_tr_b16 a[138:139], v182 offset:8192
    v_exp_f32 v143, v143
    v_mfma_f32_16x16x32_bf16 v[120:123], a[156:159], v[144:147], v[120:123]
    v_cvt_pk_bf16_f32 v151, v142, v143
    v_mfma_f32_16x16x32_bf16 v[208:211], v[216:219], v[144:147], v[208:211]
    buffer_load_dwordx4 v198, s[16:19], s27 offen offset:2048 nt lds
    v_mfma_f32_16x16x32_bf16 v[136:139], a[96:99], a[32:35], v[160:163]
    v_exp_f32 v128, v128
    v_mfma_f32_16x16x32_bf16 v[136:139], a[100:103], a[36:39], v[136:139]
    ds_read_b64_tr_b16 a[140:141], v183 offset:0
    v_mfma_f32_16x16x32_bf16 v[136:139], a[104:107], a[40:43], v[136:139]
    ds_read_b64_tr_b16 a[142:143], v183 offset:8192
    v_exp_f32 v129, v129
    v_mfma_f32_16x16x32_bf16 v[136:139], a[108:111], a[44:47], v[136:139]
    ds_read_b64_tr_b16 a[144:145], v184 offset:0
    v_cvt_pk_bf16_f32 v144, v128, v129
    v_mfma_f32_16x16x32_bf16 v[140:143], a[112:115], a[32:35], v[160:163]
    ds_read_b64_tr_b16 a[146:147], v184 offset:8192
    v_exp_f32 v130, v130
    v_mfma_f32_16x16x32_bf16 v[140:143], a[116:119], a[36:39], v[140:143]
    ds_read_b64_tr_b16 a[148:149], v185 offset:0
    v_mfma_f32_16x16x32_bf16 v[140:143], a[120:123], a[40:43], v[140:143]
    ds_read_b64_tr_b16 a[150:151], v185 offset:8192
    v_exp_f32 v131, v131
    v_mfma_f32_16x16x32_bf16 v[140:143], a[124:127], a[44:47], v[140:143]
    ds_read_b64_tr_b16 a[152:153], v186 offset:0
    v_cvt_pk_bf16_f32 v145, v130, v131
    v_mfma_f32_16x16x32_bf16 v[0:3], a[160:163], v[148:151], v[0:3]
    v_exp_f32 v132, v132
    v_mfma_f32_16x16x32_bf16 v[16:19], a[164:167], v[148:151], v[16:19]
    ds_read_b64_tr_b16 a[154:155], v186 offset:8192
    v_mfma_f32_16x16x32_bf16 v[32:35], a[168:171], v[148:151], v[32:35]
    ds_read_b64_tr_b16 a[156:157], v187 offset:0
    v_exp_f32 v133, v133
    v_mfma_f32_16x16x32_bf16 v[48:51], a[172:175], v[148:151], v[48:51]
    ds_read_b64_tr_b16 a[158:159], v187 offset:8192
    v_cvt_pk_bf16_f32 v146, v132, v133
    v_mfma_f32_16x16x32_bf16 v[64:67], a[176:179], v[148:151], v[64:67]
    v_exp_f32 v134, v134
    v_mfma_f32_16x16x32_bf16 v[80:83], a[180:183], v[148:151], v[80:83]
    buffer_load_dwordx4 v199, s[16:19], s27 offen offset:3072 nt lds
    s_add_u32 s27, s27, 8192
    v_mfma_f32_16x16x32_bf16 v[96:99], a[184:187], v[148:151], v[96:99]
    v_exp_f32 v135, v135
    v_mfma_f32_16x16x32_bf16 v[112:115], a[188:191], v[148:151], v[112:115]
    v_cvt_pk_bf16_f32 v147, v134, v135
    v_mfma_f32_16x16x32_bf16 v[200:203], v[216:219], v[148:151], v[200:203]
    s_waitcnt vmcnt(24) lgkmcnt(0)
    s_barrier
    s_add_u32 m0, s35, 0
    v_mfma_f32_16x16x32_bf16 v[128:131], a[64:67], a[0:3], v[152:155]
    v_exp_f32 v136, v136
    v_mfma_f32_16x16x32_bf16 v[128:131], a[68:71], a[4:7], v[128:131]
    ds_read_b128 a[96:99], v172 offset:16384
    v_mfma_f32_16x16x32_bf16 v[128:131], a[72:75], a[8:11], v[128:131]
    v_exp_f32 v137, v137
    v_mfma_f32_16x16x32_bf16 v[128:131], a[76:79], a[12:15], v[128:131]
    ds_read_b128 a[100:103], v173 offset:16384
    v_cvt_pk_bf16_f32 v148, v136, v137
    v_mfma_f32_16x16x32_bf16 v[132:135], a[80:83], a[0:3], v[152:155]
    v_exp_f32 v138, v138
    v_mfma_f32_16x16x32_bf16 v[132:135], a[84:87], a[4:7], v[132:135]
    ds_read_b128 a[104:107], v174 offset:16384
    v_mfma_f32_16x16x32_bf16 v[132:135], a[88:91], a[8:11], v[132:135]
    v_exp_f32 v139, v139
    v_mfma_f32_16x16x32_bf16 v[132:135], a[92:95], a[12:15], v[132:135]
    ds_read_b128 a[108:111], v175 offset:16384
    v_cvt_pk_bf16_f32 v149, v138, v139
    v_mfma_f32_16x16x32_bf16 v[4:7], a[160:163], v[144:147], v[4:7]
    v_exp_f32 v140, v140
    v_mfma_f32_16x16x32_bf16 v[20:23], a[164:167], v[144:147], v[20:23]
    ds_read_b128 a[112:115], v172 offset:24576
    v_mfma_f32_16x16x32_bf16 v[36:39], a[168:171], v[144:147], v[36:39]
    v_exp_f32 v141, v141
    v_mfma_f32_16x16x32_bf16 v[52:55], a[172:175], v[144:147], v[52:55]
    ds_read_b128 a[116:119], v173 offset:24576
    v_cvt_pk_bf16_f32 v150, v140, v141
    v_mfma_f32_16x16x32_bf16 v[68:71], a[176:179], v[144:147], v[68:71]
    v_exp_f32 v142, v142
    v_mfma_f32_16x16x32_bf16 v[84:87], a[180:183], v[144:147], v[84:87]
    ds_read_b128 a[120:123], v174 offset:24576
    v_mfma_f32_16x16x32_bf16 v[100:103], a[184:187], v[144:147], v[100:103]
    v_exp_f32 v143, v143
    v_mfma_f32_16x16x32_bf16 v[116:119], a[188:191], v[144:147], v[116:119]
    ds_read_b128 a[124:127], v175 offset:24576
    v_cvt_pk_bf16_f32 v151, v142, v143
    v_mfma_f32_16x16x32_bf16 v[204:207], v[216:219], v[144:147], v[204:207]
    buffer_load_dwordx4 v196, s[12:15], s27 offen nt lds
    v_mfma_f32_16x16x32_bf16 v[136:139], a[64:67], a[16:19], v[156:159]
    v_exp_f32 v128, v128
    v_mfma_f32_16x16x32_bf16 v[136:139], a[68:71], a[20:23], v[136:139]
    v_mfma_f32_16x16x32_bf16 v[136:139], a[72:75], a[24:27], v[136:139]
    v_exp_f32 v129, v129
    v_mfma_f32_16x16x32_bf16 v[136:139], a[76:79], a[28:31], v[136:139]
    v_cvt_pk_bf16_f32 v144, v128, v129
    v_mfma_f32_16x16x32_bf16 v[140:143], a[80:83], a[16:19], v[156:159]
    v_exp_f32 v130, v130
    v_mfma_f32_16x16x32_bf16 v[140:143], a[84:87], a[20:23], v[140:143]
    buffer_load_dwordx4 v197, s[12:15], s27 offen offset:1024 nt lds
    v_mfma_f32_16x16x32_bf16 v[140:143], a[88:91], a[24:27], v[140:143]
    v_exp_f32 v131, v131
    v_mfma_f32_16x16x32_bf16 v[140:143], a[92:95], a[28:31], v[140:143]
    v_cvt_pk_bf16_f32 v145, v130, v131
    v_mfma_f32_16x16x32_bf16 v[8:11], a[160:163], v[148:151], v[8:11]
    v_exp_f32 v132, v132
    v_mfma_f32_16x16x32_bf16 v[24:27], a[164:167], v[148:151], v[24:27]
    ds_read_b64_tr_b16 a[160:161], v180 offset:16384
    v_mfma_f32_16x16x32_bf16 v[40:43], a[168:171], v[148:151], v[40:43]
    ds_read_b64_tr_b16 a[162:163], v180 offset:24576
    v_exp_f32 v133, v133
    v_mfma_f32_16x16x32_bf16 v[56:59], a[172:175], v[148:151], v[56:59]
    ds_read_b64_tr_b16 a[164:165], v181 offset:16384
    v_cvt_pk_bf16_f32 v146, v132, v133
    v_mfma_f32_16x16x32_bf16 v[72:75], a[176:179], v[148:151], v[72:75]
    ds_read_b64_tr_b16 a[166:167], v181 offset:24576
    v_exp_f32 v134, v134
    v_mfma_f32_16x16x32_bf16 v[88:91], a[180:183], v[148:151], v[88:91]
    ds_read_b64_tr_b16 a[168:169], v182 offset:16384
    v_mfma_f32_16x16x32_bf16 v[104:107], a[184:187], v[148:151], v[104:107]
    ds_read_b64_tr_b16 a[170:171], v182 offset:24576
    v_exp_f32 v135, v135
    v_mfma_f32_16x16x32_bf16 v[120:123], a[188:191], v[148:151], v[120:123]
    v_cvt_pk_bf16_f32 v147, v134, v135
    v_mfma_f32_16x16x32_bf16 v[208:211], v[216:219], v[148:151], v[208:211]
    buffer_load_dwordx4 v198, s[16:19], s27 offen offset:2048 nt lds
    v_mfma_f32_16x16x32_bf16 v[128:131], a[64:67], a[32:35], v[160:163]
    v_exp_f32 v136, v136
    v_mfma_f32_16x16x32_bf16 v[128:131], a[68:71], a[36:39], v[128:131]
    ds_read_b64_tr_b16 a[172:173], v183 offset:16384
    v_mfma_f32_16x16x32_bf16 v[128:131], a[72:75], a[40:43], v[128:131]
    ds_read_b64_tr_b16 a[174:175], v183 offset:24576
    v_exp_f32 v137, v137
    v_mfma_f32_16x16x32_bf16 v[128:131], a[76:79], a[44:47], v[128:131]
    ds_read_b64_tr_b16 a[176:177], v184 offset:16384
    v_cvt_pk_bf16_f32 v148, v136, v137
    v_mfma_f32_16x16x32_bf16 v[132:135], a[80:83], a[32:35], v[160:163]
    ds_read_b64_tr_b16 a[178:179], v184 offset:24576
    v_exp_f32 v138, v138
    v_mfma_f32_16x16x32_bf16 v[132:135], a[84:87], a[36:39], v[132:135]
    ds_read_b64_tr_b16 a[180:181], v185 offset:16384
    v_mfma_f32_16x16x32_bf16 v[132:135], a[88:91], a[40:43], v[132:135]
    ds_read_b64_tr_b16 a[182:183], v185 offset:24576
    v_exp_f32 v139, v139
    v_mfma_f32_16x16x32_bf16 v[132:135], a[92:95], a[44:47], v[132:135]
    ds_read_b64_tr_b16 a[184:185], v186 offset:16384
    v_cvt_pk_bf16_f32 v149, v138, v139
    v_mfma_f32_16x16x32_bf16 v[0:3], a[128:131], v[144:147], v[0:3]
    v_exp_f32 v140, v140
    v_mfma_f32_16x16x32_bf16 v[16:19], a[132:135], v[144:147], v[16:19]
    ds_read_b64_tr_b16 a[186:187], v186 offset:24576
    v_mfma_f32_16x16x32_bf16 v[32:35], a[136:139], v[144:147], v[32:35]
    ds_read_b64_tr_b16 a[188:189], v187 offset:16384
    v_exp_f32 v141, v141
    v_mfma_f32_16x16x32_bf16 v[48:51], a[140:143], v[144:147], v[48:51]
    ds_read_b64_tr_b16 a[190:191], v187 offset:24576
    v_cvt_pk_bf16_f32 v150, v140, v141
    v_mfma_f32_16x16x32_bf16 v[64:67], a[144:147], v[144:147], v[64:67]
    v_exp_f32 v142, v142
    v_mfma_f32_16x16x32_bf16 v[80:83], a[148:151], v[144:147], v[80:83]
    buffer_load_dwordx4 v199, s[16:19], s27 offen offset:3072 nt lds
    s_add_u32 s27, s27, 8192
    v_mfma_f32_16x16x32_bf16 v[96:99], a[152:155], v[144:147], v[96:99]
    v_exp_f32 v143, v143
    v_mfma_f32_16x16x32_bf16 v[112:115], a[156:159], v[144:147], v[112:115]
    v_cvt_pk_bf16_f32 v151, v142, v143
    v_mfma_f32_16x16x32_bf16 v[200:203], v[216:219], v[144:147], v[200:203]
    s_waitcnt vmcnt(24) lgkmcnt(0)
    s_barrier
    s_add_u32 m0, s35, 16384
    v_mfma_f32_16x16x32_bf16 v[136:139], a[96:99], a[0:3], v[152:155]
    v_exp_f32 v128, v128
    v_mfma_f32_16x16x32_bf16 v[136:139], a[100:103], a[4:7], v[136:139]
    ds_read_b128 a[64:67], v172 offset:32768
    v_mfma_f32_16x16x32_bf16 v[136:139], a[104:107], a[8:11], v[136:139]
    v_exp_f32 v129, v129
    v_mfma_f32_16x16x32_bf16 v[136:139], a[108:111], a[12:15], v[136:139]
    ds_read_b128 a[68:71], v173 offset:32768
    v_cvt_pk_bf16_f32 v144, v128, v129
    v_mfma_f32_16x16x32_bf16 v[140:143], a[112:115], a[0:3], v[152:155]
    v_exp_f32 v130, v130
    v_mfma_f32_16x16x32_bf16 v[140:143], a[116:119], a[4:7], v[140:143]
    ds_read_b128 a[72:75], v174 offset:32768
    v_mfma_f32_16x16x32_bf16 v[140:143], a[120:123], a[8:11], v[140:143]
    v_exp_f32 v131, v131
    v_mfma_f32_16x16x32_bf16 v[140:143], a[124:127], a[12:15], v[140:143]
    ds_read_b128 a[76:79], v175 offset:32768
    v_cvt_pk_bf16_f32 v145, v130, v131
    v_mfma_f32_16x16x32_bf16 v[4:7], a[128:131], v[148:151], v[4:7]
    v_exp_f32 v132, v132
    v_mfma_f32_16x16x32_bf16 v[20:23], a[132:135], v[148:151], v[20:23]
    ds_read_b128 a[80:83], v172 offset:40960
    v_mfma_f32_16x16x32_bf16 v[36:39], a[136:139], v[148:151], v[36:39]
    v_exp_f32 v133, v133
    v_mfma_f32_16x16x32_bf16 v[52:55], a[140:143], v[148:151], v[52:55]
    ds_read_b128 a[84:87], v173 offset:40960
    v_cvt_pk_bf16_f32 v146, v132, v133
    v_mfma_f32_16x16x32_bf16 v[68:71], a[144:147], v[148:151], v[68:71]
    v_exp_f32 v134, v134
    v_mfma_f32_16x16x32_bf16 v[84:87], a[148:151], v[148:151], v[84:87]
    ds_read_b128 a[88:91], v174 offset:40960
    v_mfma_f32_16x16x32_bf16 v[100:103], a[152:155], v[148:151], v[100:103]
    v_exp_f32 v135, v135
    v_mfma_f32_16x16x32_bf16 v[116:119], a[156:159], v[148:151], v[116:119]
    ds_read_b128 a[92:95], v175 offset:40960
    v_cvt_pk_bf16_f32 v147, v134, v135
    v_mfma_f32_16x16x32_bf16 v[204:207], v[216:219], v[148:151], v[204:207]
    buffer_load_dwordx4 v196, s[12:15], s27 offen nt lds
    v_mfma_f32_16x16x32_bf16 v[128:131], a[96:99], a[16:19], v[156:159]
    v_exp_f32 v136, v136
    v_mfma_f32_16x16x32_bf16 v[128:131], a[100:103], a[20:23], v[128:131]
    v_mfma_f32_16x16x32_bf16 v[128:131], a[104:107], a[24:27], v[128:131]
    v_exp_f32 v137, v137
    v_mfma_f32_16x16x32_bf16 v[128:131], a[108:111], a[28:31], v[128:131]
    v_cvt_pk_bf16_f32 v148, v136, v137
    v_mfma_f32_16x16x32_bf16 v[132:135], a[112:115], a[16:19], v[156:159]
    v_exp_f32 v138, v138
    v_mfma_f32_16x16x32_bf16 v[132:135], a[116:119], a[20:23], v[132:135]
    buffer_load_dwordx4 v197, s[12:15], s27 offen offset:1024 nt lds
    v_mfma_f32_16x16x32_bf16 v[132:135], a[120:123], a[24:27], v[132:135]
    v_exp_f32 v139, v139
    v_mfma_f32_16x16x32_bf16 v[132:135], a[124:127], a[28:31], v[132:135]
    v_cvt_pk_bf16_f32 v149, v138, v139
    v_mfma_f32_16x16x32_bf16 v[8:11], a[128:131], v[144:147], v[8:11]
    v_exp_f32 v140, v140
    v_mfma_f32_16x16x32_bf16 v[24:27], a[132:135], v[144:147], v[24:27]
    ds_read_b64_tr_b16 a[128:129], v180 offset:32768
    v_mfma_f32_16x16x32_bf16 v[40:43], a[136:139], v[144:147], v[40:43]
    ds_read_b64_tr_b16 a[130:131], v180 offset:40960
    v_exp_f32 v141, v141
    v_mfma_f32_16x16x32_bf16 v[56:59], a[140:143], v[144:147], v[56:59]
    ds_read_b64_tr_b16 a[132:133], v181 offset:32768
    v_cvt_pk_bf16_f32 v150, v140, v141
    v_mfma_f32_16x16x32_bf16 v[72:75], a[144:147], v[144:147], v[72:75]
    ds_read_b64_tr_b16 a[134:135], v181 offset:40960
    v_exp_f32 v142, v142
    v_mfma_f32_16x16x32_bf16 v[88:91], a[148:151], v[144:147], v[88:91]
    ds_read_b64_tr_b16 a[136:137], v182 offset:32768
    v_mfma_f32_16x16x32_bf16 v[104:107], a[152:155], v[144:147], v[104:107]
    ds_read_b64_tr_b16 a[138:139], v182 offset:40960
    v_exp_f32 v143, v143
    v_mfma_f32_16x16x32_bf16 v[120:123], a[156:159], v[144:147], v[120:123]
    v_cvt_pk_bf16_f32 v151, v142, v143
    v_mfma_f32_16x16x32_bf16 v[208:211], v[216:219], v[144:147], v[208:211]
    buffer_load_dwordx4 v198, s[16:19], s27 offen offset:2048 nt lds
    v_mfma_f32_16x16x32_bf16 v[136:139], a[96:99], a[32:35], v[160:163]
    v_exp_f32 v128, v128
    v_mfma_f32_16x16x32_bf16 v[136:139], a[100:103], a[36:39], v[136:139]
    ds_read_b64_tr_b16 a[140:141], v183 offset:32768
    v_mfma_f32_16x16x32_bf16 v[136:139], a[104:107], a[40:43], v[136:139]
    ds_read_b64_tr_b16 a[142:143], v183 offset:40960
    v_exp_f32 v129, v129
    v_mfma_f32_16x16x32_bf16 v[136:139], a[108:111], a[44:47], v[136:139]
    ds_read_b64_tr_b16 a[144:145], v184 offset:32768
    v_cvt_pk_bf16_f32 v144, v128, v129
    v_mfma_f32_16x16x32_bf16 v[140:143], a[112:115], a[32:35], v[160:163]
    ds_read_b64_tr_b16 a[146:147], v184 offset:40960
    v_exp_f32 v130, v130
    v_mfma_f32_16x16x32_bf16 v[140:143], a[116:119], a[36:39], v[140:143]
    ds_read_b64_tr_b16 a[148:149], v185 offset:32768
    v_mfma_f32_16x16x32_bf16 v[140:143], a[120:123], a[40:43], v[140:143]
    ds_read_b64_tr_b16 a[150:151], v185 offset:40960
    v_exp_f32 v131, v131
    v_mfma_f32_16x16x32_bf16 v[140:143], a[124:127], a[44:47], v[140:143]
    ds_read_b64_tr_b16 a[152:153], v186 offset:32768
    v_cvt_pk_bf16_f32 v145, v130, v131
    v_mfma_f32_16x16x32_bf16 v[0:3], a[160:163], v[148:151], v[0:3]
    v_exp_f32 v132, v132
    v_mfma_f32_16x16x32_bf16 v[16:19], a[164:167], v[148:151], v[16:19]
    ds_read_b64_tr_b16 a[154:155], v186 offset:40960
    v_mfma_f32_16x16x32_bf16 v[32:35], a[168:171], v[148:151], v[32:35]
    ds_read_b64_tr_b16 a[156:157], v187 offset:32768
    v_exp_f32 v133, v133
    v_mfma_f32_16x16x32_bf16 v[48:51], a[172:175], v[148:151], v[48:51]
    ds_read_b64_tr_b16 a[158:159], v187 offset:40960
    v_cvt_pk_bf16_f32 v146, v132, v133
    v_mfma_f32_16x16x32_bf16 v[64:67], a[176:179], v[148:151], v[64:67]
    v_exp_f32 v134, v134
    v_mfma_f32_16x16x32_bf16 v[80:83], a[180:183], v[148:151], v[80:83]
    buffer_load_dwordx4 v199, s[16:19], s27 offen offset:3072 nt lds
    s_add_u32 s27, s27, 8192
    v_mfma_f32_16x16x32_bf16 v[96:99], a[184:187], v[148:151], v[96:99]
    v_exp_f32 v135, v135
    v_mfma_f32_16x16x32_bf16 v[112:115], a[188:191], v[148:151], v[112:115]
    v_cvt_pk_bf16_f32 v147, v134, v135
    v_mfma_f32_16x16x32_bf16 v[200:203], v[216:219], v[148:151], v[200:203]
    s_waitcnt vmcnt(24) lgkmcnt(0)
    s_barrier
    s_add_u32 m0, s35, 32768
    v_mfma_f32_16x16x32_bf16 v[128:131], a[64:67], a[0:3], v[152:155]
    v_exp_f32 v136, v136
    v_mfma_f32_16x16x32_bf16 v[128:131], a[68:71], a[4:7], v[128:131]
    ds_read_b128 a[96:99], v172 offset:49152
    v_mfma_f32_16x16x32_bf16 v[128:131], a[72:75], a[8:11], v[128:131]
    v_exp_f32 v137, v137
    v_mfma_f32_16x16x32_bf16 v[128:131], a[76:79], a[12:15], v[128:131]
    ds_read_b128 a[100:103], v173 offset:49152
    v_cvt_pk_bf16_f32 v148, v136, v137
    v_mfma_f32_16x16x32_bf16 v[132:135], a[80:83], a[0:3], v[152:155]
    v_exp_f32 v138, v138
    v_mfma_f32_16x16x32_bf16 v[132:135], a[84:87], a[4:7], v[132:135]
    ds_read_b128 a[104:107], v174 offset:49152
    v_mfma_f32_16x16x32_bf16 v[132:135], a[88:91], a[8:11], v[132:135]
    v_exp_f32 v139, v139
    v_mfma_f32_16x16x32_bf16 v[132:135], a[92:95], a[12:15], v[132:135]
    ds_read_b128 a[108:111], v175 offset:49152
    v_cvt_pk_bf16_f32 v149, v138, v139
    v_mfma_f32_16x16x32_bf16 v[4:7], a[160:163], v[144:147], v[4:7]
    v_exp_f32 v140, v140
    v_mfma_f32_16x16x32_bf16 v[20:23], a[164:167], v[144:147], v[20:23]
    ds_read_b128 a[112:115], v172 offset:57344
    v_mfma_f32_16x16x32_bf16 v[36:39], a[168:171], v[144:147], v[36:39]
    v_exp_f32 v141, v141
    v_mfma_f32_16x16x32_bf16 v[52:55], a[172:175], v[144:147], v[52:55]
    ds_read_b128 a[116:119], v173 offset:57344
    v_cvt_pk_bf16_f32 v150, v140, v141
    v_mfma_f32_16x16x32_bf16 v[68:71], a[176:179], v[144:147], v[68:71]
    v_exp_f32 v142, v142
    v_mfma_f32_16x16x32_bf16 v[84:87], a[180:183], v[144:147], v[84:87]
    ds_read_b128 a[120:123], v174 offset:57344
    v_mfma_f32_16x16x32_bf16 v[100:103], a[184:187], v[144:147], v[100:103]
    v_exp_f32 v143, v143
    v_mfma_f32_16x16x32_bf16 v[116:119], a[188:191], v[144:147], v[116:119]
    ds_read_b128 a[124:127], v175 offset:57344
    v_cvt_pk_bf16_f32 v151, v142, v143
    v_mfma_f32_16x16x32_bf16 v[204:207], v[216:219], v[144:147], v[204:207]
    buffer_load_dwordx4 v196, s[12:15], s27 offen nt lds
    v_mfma_f32_16x16x32_bf16 v[136:139], a[64:67], a[16:19], v[156:159]
    v_exp_f32 v128, v128
    v_mfma_f32_16x16x32_bf16 v[136:139], a[68:71], a[20:23], v[136:139]
    v_mfma_f32_16x16x32_bf16 v[136:139], a[72:75], a[24:27], v[136:139]
    v_exp_f32 v129, v129
    v_mfma_f32_16x16x32_bf16 v[136:139], a[76:79], a[28:31], v[136:139]
    v_cvt_pk_bf16_f32 v144, v128, v129
    v_mfma_f32_16x16x32_bf16 v[140:143], a[80:83], a[16:19], v[156:159]
    v_exp_f32 v130, v130
    v_mfma_f32_16x16x32_bf16 v[140:143], a[84:87], a[20:23], v[140:143]
    buffer_load_dwordx4 v197, s[12:15], s27 offen offset:1024 nt lds
    v_mfma_f32_16x16x32_bf16 v[140:143], a[88:91], a[24:27], v[140:143]
    v_exp_f32 v131, v131
    v_mfma_f32_16x16x32_bf16 v[140:143], a[92:95], a[28:31], v[140:143]
    v_cvt_pk_bf16_f32 v145, v130, v131
    v_mfma_f32_16x16x32_bf16 v[8:11], a[160:163], v[148:151], v[8:11]
    v_exp_f32 v132, v132
    v_mfma_f32_16x16x32_bf16 v[24:27], a[164:167], v[148:151], v[24:27]
    ds_read_b64_tr_b16 a[160:161], v180 offset:49152
    v_mfma_f32_16x16x32_bf16 v[40:43], a[168:171], v[148:151], v[40:43]
    ds_read_b64_tr_b16 a[162:163], v180 offset:57344
    v_exp_f32 v133, v133
    v_mfma_f32_16x16x32_bf16 v[56:59], a[172:175], v[148:151], v[56:59]
    ds_read_b64_tr_b16 a[164:165], v181 offset:49152
    v_cvt_pk_bf16_f32 v146, v132, v133
    v_mfma_f32_16x16x32_bf16 v[72:75], a[176:179], v[148:151], v[72:75]
    ds_read_b64_tr_b16 a[166:167], v181 offset:57344
    v_exp_f32 v134, v134
    v_mfma_f32_16x16x32_bf16 v[88:91], a[180:183], v[148:151], v[88:91]
    ds_read_b64_tr_b16 a[168:169], v182 offset:49152
    v_mfma_f32_16x16x32_bf16 v[104:107], a[184:187], v[148:151], v[104:107]
    ds_read_b64_tr_b16 a[170:171], v182 offset:57344
    v_exp_f32 v135, v135
    v_mfma_f32_16x16x32_bf16 v[120:123], a[188:191], v[148:151], v[120:123]
    v_cvt_pk_bf16_f32 v147, v134, v135
    v_mfma_f32_16x16x32_bf16 v[208:211], v[216:219], v[148:151], v[208:211]
    buffer_load_dwordx4 v198, s[16:19], s27 offen offset:2048 nt lds
    v_mfma_f32_16x16x32_bf16 v[128:131], a[64:67], a[32:35], v[160:163]
    v_exp_f32 v136, v136
    v_mfma_f32_16x16x32_bf16 v[128:131], a[68:71], a[36:39], v[128:131]
    ds_read_b64_tr_b16 a[172:173], v183 offset:49152
    v_mfma_f32_16x16x32_bf16 v[128:131], a[72:75], a[40:43], v[128:131]
    ds_read_b64_tr_b16 a[174:175], v183 offset:57344
    v_exp_f32 v137, v137
    v_mfma_f32_16x16x32_bf16 v[128:131], a[76:79], a[44:47], v[128:131]
    ds_read_b64_tr_b16 a[176:177], v184 offset:49152
    v_cvt_pk_bf16_f32 v148, v136, v137
    v_mfma_f32_16x16x32_bf16 v[132:135], a[80:83], a[32:35], v[160:163]
    ds_read_b64_tr_b16 a[178:179], v184 offset:57344
    v_exp_f32 v138, v138
    v_mfma_f32_16x16x32_bf16 v[132:135], a[84:87], a[36:39], v[132:135]
    ds_read_b64_tr_b16 a[180:181], v185 offset:49152
    v_mfma_f32_16x16x32_bf16 v[132:135], a[88:91], a[40:43], v[132:135]
    ds_read_b64_tr_b16 a[182:183], v185 offset:57344
    v_exp_f32 v139, v139
    v_mfma_f32_16x16x32_bf16 v[132:135], a[92:95], a[44:47], v[132:135]
    ds_read_b64_tr_b16 a[184:185], v186 offset:49152
    v_cvt_pk_bf16_f32 v149, v138, v139
    v_mfma_f32_16x16x32_bf16 v[0:3], a[128:131], v[144:147], v[0:3]
    v_exp_f32 v140, v140
    v_mfma_f32_16x16x32_bf16 v[16:19], a[132:135], v[144:147], v[16:19]
    ds_read_b64_tr_b16 a[186:187], v186 offset:57344
    v_mfma_f32_16x16x32_bf16 v[32:35], a[136:139], v[144:147], v[32:35]
    ds_read_b64_tr_b16 a[188:189], v187 offset:49152
    v_exp_f32 v141, v141
    v_mfma_f32_16x16x32_bf16 v[48:51], a[140:143], v[144:147], v[48:51]
    ds_read_b64_tr_b16 a[190:191], v187 offset:57344
    v_cvt_pk_bf16_f32 v150, v140, v141
    v_mfma_f32_16x16x32_bf16 v[64:67], a[144:147], v[144:147], v[64:67]
    v_exp_f32 v142, v142
    v_mfma_f32_16x16x32_bf16 v[80:83], a[148:151], v[144:147], v[80:83]
    buffer_load_dwordx4 v199, s[16:19], s27 offen offset:3072 nt lds
    s_add_u32 s27, s27, 8192
    v_mfma_f32_16x16x32_bf16 v[96:99], a[152:155], v[144:147], v[96:99]
    v_exp_f32 v143, v143
    v_mfma_f32_16x16x32_bf16 v[112:115], a[156:159], v[144:147], v[112:115]
    v_cvt_pk_bf16_f32 v151, v142, v143
    v_mfma_f32_16x16x32_bf16 v[200:203], v[216:219], v[144:147], v[200:203]
    s_waitcnt vmcnt(24) lgkmcnt(0)
    s_barrier
    s_add_u32 m0, s35, 49152
    v_mfma_f32_16x16x32_bf16 v[136:139], a[96:99], a[0:3], v[152:155]
    v_exp_f32 v128, v128
    v_mfma_f32_16x16x32_bf16 v[136:139], a[100:103], a[4:7], v[136:139]
    ds_read_b128 a[64:67], v176 offset:0
    v_mfma_f32_16x16x32_bf16 v[136:139], a[104:107], a[8:11], v[136:139]
    v_exp_f32 v129, v129
    v_mfma_f32_16x16x32_bf16 v[136:139], a[108:111], a[12:15], v[136:139]
    ds_read_b128 a[68:71], v177 offset:0
    v_cvt_pk_bf16_f32 v144, v128, v129
    v_mfma_f32_16x16x32_bf16 v[140:143], a[112:115], a[0:3], v[152:155]
    v_exp_f32 v130, v130
    v_mfma_f32_16x16x32_bf16 v[140:143], a[116:119], a[4:7], v[140:143]
    ds_read_b128 a[72:75], v178 offset:0
    v_mfma_f32_16x16x32_bf16 v[140:143], a[120:123], a[8:11], v[140:143]
    v_exp_f32 v131, v131
    v_mfma_f32_16x16x32_bf16 v[140:143], a[124:127], a[12:15], v[140:143]
    ds_read_b128 a[76:79], v179 offset:0
    v_cvt_pk_bf16_f32 v145, v130, v131
    v_mfma_f32_16x16x32_bf16 v[4:7], a[128:131], v[148:151], v[4:7]
    v_exp_f32 v132, v132
    v_mfma_f32_16x16x32_bf16 v[20:23], a[132:135], v[148:151], v[20:23]
    ds_read_b128 a[80:83], v176 offset:8192
    v_mfma_f32_16x16x32_bf16 v[36:39], a[136:139], v[148:151], v[36:39]
    v_exp_f32 v133, v133
    v_mfma_f32_16x16x32_bf16 v[52:55], a[140:143], v[148:151], v[52:55]
    ds_read_b128 a[84:87], v177 offset:8192
    v_cvt_pk_bf16_f32 v146, v132, v133
    v_mfma_f32_16x16x32_bf16 v[68:71], a[144:147], v[148:151], v[68:71]
    v_exp_f32 v134, v134
    v_mfma_f32_16x16x32_bf16 v[84:87], a[148:151], v[148:151], v[84:87]
    ds_read_b128 a[88:91], v178 offset:8192
    v_mfma_f32_16x16x32_bf16 v[100:103], a[152:155], v[148:151], v[100:103]
    v_exp_f32 v135, v135
    v_mfma_f32_16x16x32_bf16 v[116:119], a[156:159], v[148:151], v[116:119]
    ds_read_b128 a[92:95], v179 offset:8192
    v_cvt_pk_bf16_f32 v147, v134, v135
    v_mfma_f32_16x16x32_bf16 v[204:207], v[216:219], v[148:151], v[204:207]
    buffer_load_dwordx4 v196, s[12:15], s27 offen nt lds
    v_mfma_f32_16x16x32_bf16 v[128:131], a[96:99], a[16:19], v[156:159]
    v_exp_f32 v136, v136
    v_mfma_f32_16x16x32_bf16 v[128:131], a[100:103], a[20:23], v[128:131]
    v_mfma_f32_16x16x32_bf16 v[128:131], a[104:107], a[24:27], v[128:131]
    v_exp_f32 v137, v137
    v_mfma_f32_16x16x32_bf16 v[128:131], a[108:111], a[28:31], v[128:131]
    v_cvt_pk_bf16_f32 v148, v136, v137
    v_mfma_f32_16x16x32_bf16 v[132:135], a[112:115], a[16:19], v[156:159]
    v_exp_f32 v138, v138
    v_mfma_f32_16x16x32_bf16 v[132:135], a[116:119], a[20:23], v[132:135]
    buffer_load_dwordx4 v197, s[12:15], s27 offen offset:1024 nt lds
    v_mfma_f32_16x16x32_bf16 v[132:135], a[120:123], a[24:27], v[132:135]
    v_exp_f32 v139, v139
    v_mfma_f32_16x16x32_bf16 v[132:135], a[124:127], a[28:31], v[132:135]
    v_cvt_pk_bf16_f32 v149, v138, v139
    v_mfma_f32_16x16x32_bf16 v[8:11], a[128:131], v[144:147], v[8:11]
    v_exp_f32 v140, v140
    v_mfma_f32_16x16x32_bf16 v[24:27], a[132:135], v[144:147], v[24:27]
    ds_read_b64_tr_b16 a[128:129], v188 offset:0
    v_mfma_f32_16x16x32_bf16 v[40:43], a[136:139], v[144:147], v[40:43]
    ds_read_b64_tr_b16 a[130:131], v188 offset:8192
    v_exp_f32 v141, v141
    v_mfma_f32_16x16x32_bf16 v[56:59], a[140:143], v[144:147], v[56:59]
    ds_read_b64_tr_b16 a[132:133], v189 offset:0
    v_cvt_pk_bf16_f32 v150, v140, v141
    v_mfma_f32_16x16x32_bf16 v[72:75], a[144:147], v[144:147], v[72:75]
    ds_read_b64_tr_b16 a[134:135], v189 offset:8192
    v_exp_f32 v142, v142
    v_mfma_f32_16x16x32_bf16 v[88:91], a[148:151], v[144:147], v[88:91]
    ds_read_b64_tr_b16 a[136:137], v190 offset:0
    v_mfma_f32_16x16x32_bf16 v[104:107], a[152:155], v[144:147], v[104:107]
    ds_read_b64_tr_b16 a[138:139], v190 offset:8192
    v_exp_f32 v143, v143
    v_mfma_f32_16x16x32_bf16 v[120:123], a[156:159], v[144:147], v[120:123]
    v_cvt_pk_bf16_f32 v151, v142, v143
    v_mfma_f32_16x16x32_bf16 v[208:211], v[216:219], v[144:147], v[208:211]
    buffer_load_dwordx4 v198, s[16:19], s27 offen offset:2048 nt lds
    v_mfma_f32_16x16x32_bf16 v[136:139], a[96:99], a[32:35], v[160:163]
    v_exp_f32 v128, v128
    v_mfma_f32_16x16x32_bf16 v[136:139], a[100:103], a[36:39], v[136:139]
    ds_read_b64_tr_b16 a[140:141], v191 offset:0
    v_mfma_f32_16x16x32_bf16 v[136:139], a[104:107], a[40:43], v[136:139]
    ds_read_b64_tr_b16 a[142:143], v191 offset:8192
    v_exp_f32 v129, v129
    v_mfma_f32_16x16x32_bf16 v[136:139], a[108:111], a[44:47], v[136:139]
    ds_read_b64_tr_b16 a[144:145], v192 offset:0
    v_cvt_pk_bf16_f32 v144, v128, v129
    v_mfma_f32_16x16x32_bf16 v[140:143], a[112:115], a[32:35], v[160:163]
    ds_read_b64_tr_b16 a[146:147], v192 offset:8192
    v_exp_f32 v130, v130
    v_mfma_f32_16x16x32_bf16 v[140:143], a[116:119], a[36:39], v[140:143]
    ds_read_b64_tr_b16 a[148:149], v193 offset:0
    v_mfma_f32_16x16x32_bf16 v[140:143], a[120:123], a[40:43], v[140:143]
    ds_read_b64_tr_b16 a[150:151], v193 offset:8192
    v_exp_f32 v131, v131
    v_mfma_f32_16x16x32_bf16 v[140:143], a[124:127], a[44:47], v[140:143]
    ds_read_b64_tr_b16 a[152:153], v194 offset:0
    v_cvt_pk_bf16_f32 v145, v130, v131
    v_mfma_f32_16x16x32_bf16 v[0:3], a[160:163], v[148:151], v[0:3]
    v_exp_f32 v132, v132
    v_mfma_f32_16x16x32_bf16 v[16:19], a[164:167], v[148:151], v[16:19]
    ds_read_b64_tr_b16 a[154:155], v194 offset:8192
    v_mfma_f32_16x16x32_bf16 v[32:35], a[168:171], v[148:151], v[32:35]
    ds_read_b64_tr_b16 a[156:157], v195 offset:0
    v_exp_f32 v133, v133
    v_mfma_f32_16x16x32_bf16 v[48:51], a[172:175], v[148:151], v[48:51]
    ds_read_b64_tr_b16 a[158:159], v195 offset:8192
    v_cvt_pk_bf16_f32 v146, v132, v133
    v_mfma_f32_16x16x32_bf16 v[64:67], a[176:179], v[148:151], v[64:67]
    v_exp_f32 v134, v134
    v_mfma_f32_16x16x32_bf16 v[80:83], a[180:183], v[148:151], v[80:83]
    buffer_load_dwordx4 v199, s[16:19], s27 offen offset:3072 nt lds
    s_add_u32 s27, s27, 8192
    v_mfma_f32_16x16x32_bf16 v[96:99], a[184:187], v[148:151], v[96:99]
    v_exp_f32 v135, v135
    v_mfma_f32_16x16x32_bf16 v[112:115], a[188:191], v[148:151], v[112:115]
    v_cvt_pk_bf16_f32 v147, v134, v135
    v_mfma_f32_16x16x32_bf16 v[200:203], v[216:219], v[148:151], v[200:203]
    s_waitcnt vmcnt(24) lgkmcnt(0)
    s_barrier
    s_add_u32 m0, s35, 65536
    v_mfma_f32_16x16x32_bf16 v[128:131], a[64:67], a[0:3], v[152:155]
    v_exp_f32 v136, v136
    v_mfma_f32_16x16x32_bf16 v[128:131], a[68:71], a[4:7], v[128:131]
    ds_read_b128 a[96:99], v176 offset:16384
    v_mfma_f32_16x16x32_bf16 v[128:131], a[72:75], a[8:11], v[128:131]
    v_exp_f32 v137, v137
    v_mfma_f32_16x16x32_bf16 v[128:131], a[76:79], a[12:15], v[128:131]
    ds_read_b128 a[100:103], v177 offset:16384
    v_cvt_pk_bf16_f32 v148, v136, v137
    v_mfma_f32_16x16x32_bf16 v[132:135], a[80:83], a[0:3], v[152:155]
    v_exp_f32 v138, v138
    v_mfma_f32_16x16x32_bf16 v[132:135], a[84:87], a[4:7], v[132:135]
    ds_read_b128 a[104:107], v178 offset:16384
    v_mfma_f32_16x16x32_bf16 v[132:135], a[88:91], a[8:11], v[132:135]
    v_exp_f32 v139, v139
    v_mfma_f32_16x16x32_bf16 v[132:135], a[92:95], a[12:15], v[132:135]
    ds_read_b128 a[108:111], v179 offset:16384
    v_cvt_pk_bf16_f32 v149, v138, v139
    v_mfma_f32_16x16x32_bf16 v[4:7], a[160:163], v[144:147], v[4:7]
    v_exp_f32 v140, v140
    v_mfma_f32_16x16x32_bf16 v[20:23], a[164:167], v[144:147], v[20:23]
    ds_read_b128 a[112:115], v176 offset:24576
    v_mfma_f32_16x16x32_bf16 v[36:39], a[168:171], v[144:147], v[36:39]
    v_exp_f32 v141, v141
    v_mfma_f32_16x16x32_bf16 v[52:55], a[172:175], v[144:147], v[52:55]
    ds_read_b128 a[116:119], v177 offset:24576
    v_cvt_pk_bf16_f32 v150, v140, v141
    v_mfma_f32_16x16x32_bf16 v[68:71], a[176:179], v[144:147], v[68:71]
    v_exp_f32 v142, v142
    v_mfma_f32_16x16x32_bf16 v[84:87], a[180:183], v[144:147], v[84:87]
    ds_read_b128 a[120:123], v178 offset:24576
    v_mfma_f32_16x16x32_bf16 v[100:103], a[184:187], v[144:147], v[100:103]
    v_exp_f32 v143, v143
    v_mfma_f32_16x16x32_bf16 v[116:119], a[188:191], v[144:147], v[116:119]
    ds_read_b128 a[124:127], v179 offset:24576
    v_cvt_pk_bf16_f32 v151, v142, v143
    v_mfma_f32_16x16x32_bf16 v[204:207], v[216:219], v[144:147], v[204:207]
    buffer_load_dwordx4 v196, s[12:15], s27 offen nt lds
    v_mfma_f32_16x16x32_bf16 v[136:139], a[64:67], a[16:19], v[156:159]
    v_exp_f32 v128, v128
    v_mfma_f32_16x16x32_bf16 v[136:139], a[68:71], a[20:23], v[136:139]
    v_mfma_f32_16x16x32_bf16 v[136:139], a[72:75], a[24:27], v[136:139]
    v_exp_f32 v129, v129
    v_mfma_f32_16x16x32_bf16 v[136:139], a[76:79], a[28:31], v[136:139]
    v_cvt_pk_bf16_f32 v144, v128, v129
    v_mfma_f32_16x16x32_bf16 v[140:143], a[80:83], a[16:19], v[156:159]
    v_exp_f32 v130, v130
    v_mfma_f32_16x16x32_bf16 v[140:143], a[84:87], a[20:23], v[140:143]
    buffer_load_dwordx4 v197, s[12:15], s27 offen offset:1024 nt lds
    v_mfma_f32_16x16x32_bf16 v[140:143], a[88:91], a[24:27], v[140:143]
    v_exp_f32 v131, v131
    v_mfma_f32_16x16x32_bf16 v[140:143], a[92:95], a[28:31], v[140:143]
    v_cvt_pk_bf16_f32 v145, v130, v131
    v_mfma_f32_16x16x32_bf16 v[8:11], a[160:163], v[148:151], v[8:11]
    v_exp_f32 v132, v132
    v_mfma_f32_16x16x32_bf16 v[24:27], a[164:167], v[148:151], v[24:27]
    ds_read_b64_tr_b16 a[160:161], v188 offset:16384
    v_mfma_f32_16x16x32_bf16 v[40:43], a[168:171], v[148:151], v[40:43]
    ds_read_b64_tr_b16 a[162:163], v188 offset:24576
    v_exp_f32 v133, v133
    v_mfma_f32_16x16x32_bf16 v[56:59], a[172:175], v[148:151], v[56:59]
    ds_read_b64_tr_b16 a[164:165], v189 offset:16384
    v_cvt_pk_bf16_f32 v146, v132, v133
    v_mfma_f32_16x16x32_bf16 v[72:75], a[176:179], v[148:151], v[72:75]
    ds_read_b64_tr_b16 a[166:167], v189 offset:24576
    v_exp_f32 v134, v134
    v_mfma_f32_16x16x32_bf16 v[88:91], a[180:183], v[148:151], v[88:91]
    ds_read_b64_tr_b16 a[168:169], v190 offset:16384
    v_mfma_f32_16x16x32_bf16 v[104:107], a[184:187], v[148:151], v[104:107]
    ds_read_b64_tr_b16 a[170:171], v190 offset:24576
    v_exp_f32 v135, v135
    v_mfma_f32_16x16x32_bf16 v[120:123], a[188:191], v[148:151], v[120:123]
    v_cvt_pk_bf16_f32 v147, v134, v135
    v_mfma_f32_16x16x32_bf16 v[208:211], v[216:219], v[148:151], v[208:211]
    buffer_load_dwordx4 v198, s[16:19], s27 offen offset:2048 nt lds
    v_mfma_f32_16x16x32_bf16 v[128:131], a[64:67], a[32:35], v[160:163]
    v_exp_f32 v136, v136
    v_mfma_f32_16x16x32_bf16 v[128:131], a[68:71], a[36:39], v[128:131]
    ds_read_b64_tr_b16 a[172:173], v191 offset:16384
    v_mfma_f32_16x16x32_bf16 v[128:131], a[72:75], a[40:43], v[128:131]
    ds_read_b64_tr_b16 a[174:175], v191 offset:24576
    v_exp_f32 v137, v137
    v_mfma_f32_16x16x32_bf16 v[128:131], a[76:79], a[44:47], v[128:131]
    ds_read_b64_tr_b16 a[176:177], v192 offset:16384
    v_cvt_pk_bf16_f32 v148, v136, v137
    v_mfma_f32_16x16x32_bf16 v[132:135], a[80:83], a[32:35], v[160:163]
    ds_read_b64_tr_b16 a[178:179], v192 offset:24576
    v_exp_f32 v138, v138
    v_mfma_f32_16x16x32_bf16 v[132:135], a[84:87], a[36:39], v[132:135]
    ds_read_b64_tr_b16 a[180:181], v193 offset:16384
    v_mfma_f32_16x16x32_bf16 v[132:135], a[88:91], a[40:43], v[132:135]
    ds_read_b64_tr_b16 a[182:183], v193 offset:24576
    v_exp_f32 v139, v139
    v_mfma_f32_16x16x32_bf16 v[132:135], a[92:95], a[44:47], v[132:135]
    ds_read_b64_tr_b16 a[184:185], v194 offset:16384
    v_cvt_pk_bf16_f32 v149, v138, v139
    v_mfma_f32_16x16x32_bf16 v[0:3], a[128:131], v[144:147], v[0:3]
    v_exp_f32 v140, v140
    v_mfma_f32_16x16x32_bf16 v[16:19], a[132:135], v[144:147], v[16:19]
    ds_read_b64_tr_b16 a[186:187], v194 offset:24576
    v_mfma_f32_16x16x32_bf16 v[32:35], a[136:139], v[144:147], v[32:35]
    ds_read_b64_tr_b16 a[188:189], v195 offset:16384
    v_exp_f32 v141, v141
    v_mfma_f32_16x16x32_bf16 v[48:51], a[140:143], v[144:147], v[48:51]
    ds_read_b64_tr_b16 a[190:191], v195 offset:24576
    v_cvt_pk_bf16_f32 v150, v140, v141
    v_mfma_f32_16x16x32_bf16 v[64:67], a[144:147], v[144:147], v[64:67]
    v_exp_f32 v142, v142
    v_mfma_f32_16x16x32_bf16 v[80:83], a[148:151], v[144:147], v[80:83]
    buffer_load_dwordx4 v199, s[16:19], s27 offen offset:3072 nt lds
    s_add_u32 s27, s27, 8192
    v_mfma_f32_16x16x32_bf16 v[96:99], a[152:155], v[144:147], v[96:99]
    v_exp_f32 v143, v143
    v_mfma_f32_16x16x32_bf16 v[112:115], a[156:159], v[144:147], v[112:115]
    v_cvt_pk_bf16_f32 v151, v142, v143
    v_mfma_f32_16x16x32_bf16 v[200:203], v[216:219], v[144:147], v[200:203]
    s_waitcnt vmcnt(24) lgkmcnt(0)
    s_barrier
    s_add_u32 m0, s35, 81920
    v_mfma_f32_16x16x32_bf16 v[136:139], a[96:99], a[0:3], v[152:155]
    v_exp_f32 v128, v128
    v_mfma_f32_16x16x32_bf16 v[136:139], a[100:103], a[4:7], v[136:139]
    ds_read_b128 a[64:67], v176 offset:32768
    v_mfma_f32_16x16x32_bf16 v[136:139], a[104:107], a[8:11], v[136:139]
    v_exp_f32 v129, v129
    v_mfma_f32_16x16x32_bf16 v[136:139], a[108:111], a[12:15], v[136:139]
    ds_read_b128 a[68:71], v177 offset:32768
    v_cvt_pk_bf16_f32 v144, v128, v129
    v_mfma_f32_16x16x32_bf16 v[140:143], a[112:115], a[0:3], v[152:155]
    v_exp_f32 v130, v130
    v_mfma_f32_16x16x32_bf16 v[140:143], a[116:119], a[4:7], v[140:143]
    ds_read_b128 a[72:75], v178 offset:32768
    v_mfma_f32_16x16x32_bf16 v[140:143], a[120:123], a[8:11], v[140:143]
    v_exp_f32 v131, v131
    v_mfma_f32_16x16x32_bf16 v[140:143], a[124:127], a[12:15], v[140:143]
    ds_read_b128 a[76:79], v179 offset:32768
    v_cvt_pk_bf16_f32 v145, v130, v131
    v_mfma_f32_16x16x32_bf16 v[4:7], a[128:131], v[148:151], v[4:7]
    v_exp_f32 v132, v132
    v_mfma_f32_16x16x32_bf16 v[20:23], a[132:135], v[148:151], v[20:23]
    ds_read_b128 a[80:83], v176 offset:40960
    v_mfma_f32_16x16x32_bf16 v[36:39], a[136:139], v[148:151], v[36:39]
    v_exp_f32 v133, v133
    v_mfma_f32_16x16x32_bf16 v[52:55], a[140:143], v[148:151], v[52:55]
    ds_read_b128 a[84:87], v177 offset:40960
    v_cvt_pk_bf16_f32 v146, v132, v133
    v_mfma_f32_16x16x32_bf16 v[68:71], a[144:147], v[148:151], v[68:71]
    v_exp_f32 v134, v134
    v_mfma_f32_16x16x32_bf16 v[84:87], a[148:151], v[148:151], v[84:87]
    ds_read_b128 a[88:91], v178 offset:40960
    v_mfma_f32_16x16x32_bf16 v[100:103], a[152:155], v[148:151], v[100:103]
    v_exp_f32 v135, v135
    v_mfma_f32_16x16x32_bf16 v[116:119], a[156:159], v[148:151], v[116:119]
    ds_read_b128 a[92:95], v179 offset:40960
    v_cvt_pk_bf16_f32 v147, v134, v135
    v_mfma_f32_16x16x32_bf16 v[204:207], v[216:219], v[148:151], v[204:207]
    buffer_load_dwordx4 v196, s[12:15], s27 offen nt lds
    v_mfma_f32_16x16x32_bf16 v[128:131], a[96:99], a[16:19], v[156:159]
    v_exp_f32 v136, v136
    v_mfma_f32_16x16x32_bf16 v[128:131], a[100:103], a[20:23], v[128:131]
    v_mfma_f32_16x16x32_bf16 v[128:131], a[104:107], a[24:27], v[128:131]
    v_exp_f32 v137, v137
    v_mfma_f32_16x16x32_bf16 v[128:131], a[108:111], a[28:31], v[128:131]
    v_cvt_pk_bf16_f32 v148, v136, v137
    v_mfma_f32_16x16x32_bf16 v[132:135], a[112:115], a[16:19], v[156:159]
    v_exp_f32 v138, v138
    v_mfma_f32_16x16x32_bf16 v[132:135], a[116:119], a[20:23], v[132:135]
    buffer_load_dwordx4 v197, s[12:15], s27 offen offset:1024 nt lds
    v_mfma_f32_16x16x32_bf16 v[132:135], a[120:123], a[24:27], v[132:135]
    v_exp_f32 v139, v139
    v_mfma_f32_16x16x32_bf16 v[132:135], a[124:127], a[28:31], v[132:135]
    v_cvt_pk_bf16_f32 v149, v138, v139
    v_mfma_f32_16x16x32_bf16 v[8:11], a[128:131], v[144:147], v[8:11]
    v_exp_f32 v140, v140
    v_mfma_f32_16x16x32_bf16 v[24:27], a[132:135], v[144:147], v[24:27]
    ds_read_b64_tr_b16 a[128:129], v188 offset:32768
    v_mfma_f32_16x16x32_bf16 v[40:43], a[136:139], v[144:147], v[40:43]
    ds_read_b64_tr_b16 a[130:131], v188 offset:40960
    v_exp_f32 v141, v141
    v_mfma_f32_16x16x32_bf16 v[56:59], a[140:143], v[144:147], v[56:59]
    ds_read_b64_tr_b16 a[132:133], v189 offset:32768
    v_cvt_pk_bf16_f32 v150, v140, v141
    v_mfma_f32_16x16x32_bf16 v[72:75], a[144:147], v[144:147], v[72:75]
    ds_read_b64_tr_b16 a[134:135], v189 offset:40960
    v_exp_f32 v142, v142
    v_mfma_f32_16x16x32_bf16 v[88:91], a[148:151], v[144:147], v[88:91]
    ds_read_b64_tr_b16 a[136:137], v190 offset:32768
    v_mfma_f32_16x16x32_bf16 v[104:107], a[152:155], v[144:147], v[104:107]
    ds_read_b64_tr_b16 a[138:139], v190 offset:40960
    v_exp_f32 v143, v143
    v_mfma_f32_16x16x32_bf16 v[120:123], a[156:159], v[144:147], v[120:123]
    v_cvt_pk_bf16_f32 v151, v142, v143
    v_mfma_f32_16x16x32_bf16 v[208:211], v[216:219], v[144:147], v[208:211]
    buffer_load_dwordx4 v198, s[16:19], s27 offen offset:2048 nt lds
    v_mfma_f32_16x16x32_bf16 v[136:139], a[96:99], a[32:35], v[160:163]
    v_exp_f32 v128, v128
    v_mfma_f32_16x16x32_bf16 v[136:139], a[100:103], a[36:39], v[136:139]
    ds_read_b64_tr_b16 a[140:141], v191 offset:32768
    v_mfma_f32_16x16x32_bf16 v[136:139], a[104:107], a[40:43], v[136:139]
    ds_read_b64_tr_b16 a[142:143], v191 offset:40960
    v_exp_f32 v129, v129
    v_mfma_f32_16x16x32_bf16 v[136:139], a[108:111], a[44:47], v[136:139]
    ds_read_b64_tr_b16 a[144:145], v192 offset:32768
    v_cvt_pk_bf16_f32 v144, v128, v129
    v_mfma_f32_16x16x32_bf16 v[140:143], a[112:115], a[32:35], v[160:163]
    ds_read_b64_tr_b16 a[146:147], v192 offset:40960
    v_exp_f32 v130, v130
    v_mfma_f32_16x16x32_bf16 v[140:143], a[116:119], a[36:39], v[140:143]
    ds_read_b64_tr_b16 a[148:149], v193 offset:32768
    v_mfma_f32_16x16x32_bf16 v[140:143], a[120:123], a[40:43], v[140:143]
    ds_read_b64_tr_b16 a[150:151], v193 offset:40960
    v_exp_f32 v131, v131
    v_mfma_f32_16x16x32_bf16 v[140:143], a[124:127], a[44:47], v[140:143]
    ds_read_b64_tr_b16 a[152:153], v194 offset:32768
    v_cvt_pk_bf16_f32 v145, v130, v131
    v_mfma_f32_16x16x32_bf16 v[0:3], a[160:163], v[148:151], v[0:3]
    v_exp_f32 v132, v132
    v_mfma_f32_16x16x32_bf16 v[16:19], a[164:167], v[148:151], v[16:19]
    ds_read_b64_tr_b16 a[154:155], v194 offset:40960
    v_mfma_f32_16x16x32_bf16 v[32:35], a[168:171], v[148:151], v[32:35]
    ds_read_b64_tr_b16 a[156:157], v195 offset:32768
    v_exp_f32 v133, v133
    v_mfma_f32_16x16x32_bf16 v[48:51], a[172:175], v[148:151], v[48:51]
    ds_read_b64_tr_b16 a[158:159], v195 offset:40960
    v_cvt_pk_bf16_f32 v146, v132, v133
    v_mfma_f32_16x16x32_bf16 v[64:67], a[176:179], v[148:151], v[64:67]
    v_exp_f32 v134, v134
    v_mfma_f32_16x16x32_bf16 v[80:83], a[180:183], v[148:151], v[80:83]
    buffer_load_dwordx4 v199, s[16:19], s27 offen offset:3072 nt lds
    s_add_u32 s27, s27, 8192
    s_and_b32 s27, s27, 0x7ffff
    v_mfma_f32_16x16x32_bf16 v[96:99], a[184:187], v[148:151], v[96:99]
    v_exp_f32 v135, v135
    v_mfma_f32_16x16x32_bf16 v[112:115], a[188:191], v[148:151], v[112:115]
    v_cvt_pk_bf16_f32 v147, v134, v135
    v_mfma_f32_16x16x32_bf16 v[200:203], v[216:219], v[148:151], v[200:203]
    s_sub_u32 s31, s31, 1
    s_cmp_lg_u32 s31, 0
    s_cbranch_scc1 L_loop3
    s_lshl_b32 s38, s47, 5
    v_mov_b32 v221, s38
    global_load_dword v220, v221, s[64:65] sc1
    s_mul_i32 s49, s24, 1179648
    s_add_u32 s46, s49, 368640
    s_waitcnt vmcnt(24) lgkmcnt(0)
    s_barrier
    s_add_u32 m0, s35, 98304
    v_mfma_f32_16x16x32_bf16 v[128:131], a[64:67], a[0:3], v[152:155]
    v_exp_f32 v136, v136
    v_mfma_f32_16x16x32_bf16 v[128:131], a[68:71], a[4:7], v[128:131]
    ds_read_b128 a[96:99], v176 offset:49152
    v_mfma_f32_16x16x32_bf16 v[128:131], a[72:75], a[8:11], v[128:131]
    v_exp_f32 v137, v137
    v_mfma_f32_16x16x32_bf16 v[128:131], a[76:79], a[12:15], v[128:131]
    ds_read_b128 a[100:103], v177 offset:49152
    v_cvt_pk_bf16_f32 v148, v136, v137
    v_mfma_f32_16x16x32_bf16 v[132:135], a[80:83], a[0:3], v[152:155]
    v_exp_f32 v138, v138
    v_mfma_f32_16x16x32_bf16 v[132:135], a[84:87], a[4:7], v[132:135]
    ds_read_b128 a[104:107], v178 offset:49152
    v_mfma_f32_16x16x32_bf16 v[132:135], a[88:91], a[8:11], v[132:135]
    buffer_load_dwordx4 a[192:195], v250, s[4:7], s46 offen offset:0
    v_exp_f32 v139, v139
    v_mfma_f32_16x16x32_bf16 v[132:135], a[92:95], a[12:15], v[132:135]
    ds_read_b128 a[108:111], v179 offset:49152
    v_cvt_pk_bf16_f32 v149, v138, v139
    v_mfma_f32_16x16x32_bf16 v[4:7], a[160:163], v[144:147], v[4:7]
    v_exp_f32 v140, v140
    v_mfma_f32_16x16x32_bf16 v[20:23], a[164:167], v[144:147], v[20:23]
    ds_read_b128 a[112:115], v176 offset:57344
    v_mfma_f32_16x16x32_bf16 v[36:39], a[168:171], v[144:147], v[36:39]
    v_exp_f32 v141, v141
    v_mfma_f32_16x16x32_bf16 v[52:55], a[172:175], v[144:147], v[52:55]
    ds_read_b128 a[116:119], v177 offset:57344
    v_cvt_pk_bf16_f32 v150, v140, v141
    v_mfma_f32_16x16x32_bf16 v[68:71], a[176:179], v[144:147], v[68:71]
    v_exp_f32 v142, v142
    v_mfma_f32_16x16x32_bf16 v[84:87], a[180:183], v[144:147], v[84:87]
    ds_read_b128 a[120:123], v178 offset:57344
    v_mfma_f32_16x16x32_bf16 v[100:103], a[184:187], v[144:147], v[100:103]
    v_exp_f32 v143, v143
    v_mfma_f32_16x16x32_bf16 v[116:119], a[188:191], v[144:147], v[116:119]
    ds_read_b128 a[124:127], v179 offset:57344
    v_cvt_pk_bf16_f32 v151, v142, v143
    v_mfma_f32_16x16x32_bf16 v[204:207], v[216:219], v[144:147], v[204:207]
    buffer_load_dwordx4 v250, s[4:7], s49 offen offset:0 lds
    v_mfma_f32_16x16x32_bf16 v[136:139], a[64:67], a[16:19], v[156:159]
    v_exp_f32 v128, v128
    v_mfma_f32_16x16x32_bf16 v[136:139], a[68:71], a[20:23], v[136:139]
    v_mfma_f32_16x16x32_bf16 v[136:139], a[72:75], a[24:27], v[136:139]
    v_exp_f32 v129, v129
    v_mfma_f32_16x16x32_bf16 v[136:139], a[76:79], a[28:31], v[136:139]
    buffer_load_dwordx4 a[196:199], v251, s[4:7], s46 offen offset:1024
    v_cvt_pk_bf16_f32 v144, v128, v129
    v_mfma_f32_16x16x32_bf16 v[140:143], a[80:83], a[16:19], v[156:159]
    v_exp_f32 v130, v130
    v_mfma_f32_16x16x32_bf16 v[140:143], a[84:87], a[20:23], v[140:143]
    buffer_load_dwordx4 v251, s[4:7], s49 offen offset:1024 lds
    v_mfma_f32_16x16x32_bf16 v[140:143], a[88:91], a[24:27], v[140:143]
    v_exp_f32 v131, v131
    v_mfma_f32_16x16x32_bf16 v[140:143], a[92:95], a[28:31], v[140:143]
    v_cvt_pk_bf16_f32 v145, v130, v131
    v_mfma_f32_16x16x32_bf16 v[8:11], a[160:163], v[148:151], v[8:11]
    v_exp_f32 v132, v132
    v_mfma_f32_16x16x32_bf16 v[24:27], a[164:167], v[148:151], v[24:27]
    ds_read_b64_tr_b16 a[160:161], v188 offset:49152
    v_mfma_f32_16x16x32_bf16 v[40:43], a[168:171], v[148:151], v[40:43]
    ds_read_b64_tr_b16 a[162:163], v188 offset:57344
    v_exp_f32 v133, v133
    v_mfma_f32_16x16x32_bf16 v[56:59], a[172:175], v[148:151], v[56:59]
    ds_read_b64_tr_b16 a[164:165], v189 offset:49152
    v_cvt_pk_bf16_f32 v146, v132, v133
    v_mfma_f32_16x16x32_bf16 v[72:75], a[176:179], v[148:151], v[72:75]
    ds_read_b64_tr_b16 a[166:167], v189 offset:57344
    v_exp_f32 v134, v134
    v_mfma_f32_16x16x32_bf16 v[88:91], a[180:183], v[148:151], v[88:91]
    ds_read_b64_tr_b16 a[168:169], v190 offset:49152
    v_mfma_f32_16x16x32_bf16 v[104:107], a[184:187], v[148:151], v[104:107]
    ds_read_b64_tr_b16 a[170:171], v190 offset:57344
    v_exp_f32 v135, v135
    v_mfma_f32_16x16x32_bf16 v[120:123], a[188:191], v[148:151], v[120:123]
    v_cvt_pk_bf16_f32 v147, v134, v135
    v_mfma_f32_16x16x32_bf16 v[208:211], v[216:219], v[148:151], v[208:211]
    buffer_load_dwordx4 v252, s[4:7], s49 offen offset:2048 lds
    v_mfma_f32_16x16x32_bf16 v[128:131], a[64:67], a[32:35], v[160:163]
    v_exp_f32 v136, v136
    v_mfma_f32_16x16x32_bf16 v[128:131], a[68:71], a[36:39], v[128:131]
    ds_read_b64_tr_b16 a[172:173], v191 offset:49152
    v_mfma_f32_16x16x32_bf16 v[128:131], a[72:75], a[40:43], v[128:131]
    ds_read_b64_tr_b16 a[174:175], v191 offset:57344
    v_exp_f32 v137, v137
    v_mfma_f32_16x16x32_bf16 v[128:131], a[76:79], a[44:47], v[128:131]
    ds_read_b64_tr_b16 a[176:177], v192 offset:49152
    v_cvt_pk_bf16_f32 v148, v136, v137
    v_mfma_f32_16x16x32_bf16 v[132:135], a[80:83], a[32:35], v[160:163]
    ds_read_b64_tr_b16 a[178:179], v192 offset:57344
    v_exp_f32 v138, v138
    v_mfma_f32_16x16x32_bf16 v[132:135], a[84:87], a[36:39], v[132:135]
    ds_read_b64_tr_b16 a[180:181], v193 offset:49152
    v_mfma_f32_16x16x32_bf16 v[132:135], a[88:91], a[40:43], v[132:135]
    ds_read_b64_tr_b16 a[182:183], v193 offset:57344
    v_exp_f32 v139, v139
    v_mfma_f32_16x16x32_bf16 v[132:135], a[92:95], a[44:47], v[132:135]
    ds_read_b64_tr_b16 a[184:185], v194 offset:49152
    v_cvt_pk_bf16_f32 v149, v138, v139
    v_mfma_f32_16x16x32_bf16 v[0:3], a[128:131], v[144:147], v[0:3]
    buffer_load_dwordx4 a[200:203], v252, s[4:7], s46 offen offset:2048
    v_exp_f32 v140, v140
    v_mfma_f32_16x16x32_bf16 v[16:19], a[132:135], v[144:147], v[16:19]
    ds_read_b64_tr_b16 a[186:187], v194 offset:57344
    v_mfma_f32_16x16x32_bf16 v[32:35], a[136:139], v[144:147], v[32:35]
    ds_read_b64_tr_b16 a[188:189], v195 offset:49152
    v_exp_f32 v141, v141
    v_mfma_f32_16x16x32_bf16 v[48:51], a[140:143], v[144:147], v[48:51]
    ds_read_b64_tr_b16 a[190:191], v195 offset:57344
    v_cvt_pk_bf16_f32 v150, v140, v141
    v_mfma_f32_16x16x32_bf16 v[64:67], a[144:147], v[144:147], v[64:67]
    v_exp_f32 v142, v142
    v_mfma_f32_16x16x32_bf16 v[80:83], a[148:151], v[144:147], v[80:83]
    buffer_load_dwordx4 v253, s[4:7], s49 offen offset:3072 lds
    s_add_u32 s49, s49, 36864
    v_mfma_f32_16x16x32_bf16 v[96:99], a[152:155], v[144:147], v[96:99]
    buffer_load_dwordx4 a[204:207], v253, s[4:7], s46 offen offset:3072
    v_exp_f32 v143, v143
    s_add_u32 s46, s46, 36864
    v_mfma_f32_16x16x32_bf16 v[112:115], a[156:159], v[144:147], v[112:115]
    v_cvt_pk_bf16_f32 v151, v142, v143
    v_mfma_f32_16x16x32_bf16 v[200:203], v[216:219], v[144:147], v[200:203]
    s_waitcnt vmcnt(28) lgkmcnt(0)
    s_barrier
    s_add_u32 m0, s35, 114688
    v_mfma_f32_16x16x32_bf16 v[136:139], a[96:99], a[0:3], v[152:155]
    v_exp_f32 v128, v128
    v_mfma_f32_16x16x32_bf16 v[136:139], a[100:103], a[4:7], v[136:139]
    ds_read_b128 a[64:67], v172 offset:0
    v_mfma_f32_16x16x32_bf16 v[136:139], a[104:107], a[8:11], v[136:139]
    v_exp_f32 v129, v129
    v_mfma_f32_16x16x32_bf16 v[136:139], a[108:111], a[12:15], v[136:139]
    ds_read_b128 a[68:71], v173 offset:0
    v_cvt_pk_bf16_f32 v144, v128, v129
    v_mfma_f32_16x16x32_bf16 v[140:143], a[112:115], a[0:3], v[152:155]
    v_exp_f32 v130, v130
    v_mfma_f32_16x16x32_bf16 v[140:143], a[116:119], a[4:7], v[140:143]
    ds_read_b128 a[72:75], v174 offset:0
    v_mfma_f32_16x16x32_bf16 v[140:143], a[120:123], a[8:11], v[140:143]
    buffer_load_dwordx4 a[208:211], v250, s[4:7], s46 offen offset:0
    v_exp_f32 v131, v131
    v_mfma_f32_16x16x32_bf16 v[140:143], a[124:127], a[12:15], v[140:143]
    ds_read_b128 a[76:79], v175 offset:0
    v_cvt_pk_bf16_f32 v145, v130, v131
    v_mfma_f32_16x16x32_bf16 v[4:7], a[128:131], v[148:151], v[4:7]
    v_exp_f32 v132, v132
    v_mfma_f32_16x16x32_bf16 v[20:23], a[132:135], v[148:151], v[20:23]
    ds_read_b128 a[80:83], v172 offset:8192
    v_mfma_f32_16x16x32_bf16 v[36:39], a[136:139], v[148:151], v[36:39]
    v_exp_f32 v133, v133
    v_mfma_f32_16x16x32_bf16 v[52:55], a[140:143], v[148:151], v[52:55]
    ds_read_b128 a[84:87], v173 offset:8192
    v_cvt_pk_bf16_f32 v146, v132, v133
    v_mfma_f32_16x16x32_bf16 v[68:71], a[144:147], v[148:151], v[68:71]
    v_exp_f32 v134, v134
    v_mfma_f32_16x16x32_bf16 v[84:87], a[148:151], v[148:151], v[84:87]
    ds_read_b128 a[88:91], v174 offset:8192
    v_mfma_f32_16x16x32_bf16 v[100:103], a[152:155], v[148:151], v[100:103]
    v_exp_f32 v135, v135
    v_mfma_f32_16x16x32_bf16 v[116:119], a[156:159], v[148:151], v[116:119]
    ds_read_b128 a[92:95], v175 offset:8192
    v_cvt_pk_bf16_f32 v147, v134, v135
    v_mfma_f32_16x16x32_bf16 v[204:207], v[216:219], v[148:151], v[204:207]
    buffer_load_dwordx4 v250, s[4:7], s49 offen offset:0 lds
    v_mfma_f32_16x16x32_bf16 v[128:131], a[96:99], a[16:19], v[156:159]
    v_exp_f32 v136, v136
    v_mfma_f32_16x16x32_bf16 v[128:131], a[100:103], a[20:23], v[128:131]
    v_mfma_f32_16x16x32_bf16 v[128:131], a[104:107], a[24:27], v[128:131]
    v_exp_f32 v137, v137
    v_mfma_f32_16x16x32_bf16 v[128:131], a[108:111], a[28:31], v[128:131]
    buffer_load_dwordx4 a[212:215], v251, s[4:7], s46 offen offset:1024
    v_cvt_pk_bf16_f32 v148, v136, v137
    v_mfma_f32_16x16x32_bf16 v[132:135], a[112:115], a[16:19], v[156:159]
    v_exp_f32 v138, v138
    v_mfma_f32_16x16x32_bf16 v[132:135], a[116:119], a[20:23], v[132:135]
    buffer_load_dwordx4 v251, s[4:7], s49 offen offset:1024 lds
    v_mfma_f32_16x16x32_bf16 v[132:135], a[120:123], a[24:27], v[132:135]
    v_exp_f32 v139, v139
    v_mfma_f32_16x16x32_bf16 v[132:135], a[124:127], a[28:31], v[132:135]
    v_cvt_pk_bf16_f32 v149, v138, v139
    v_mfma_f32_16x16x32_bf16 v[8:11], a[128:131], v[144:147], v[8:11]
    v_exp_f32 v140, v140
    v_mfma_f32_16x16x32_bf16 v[24:27], a[132:135], v[144:147], v[24:27]
    ds_read_b64_tr_b16 a[128:129], v180 offset:0
    v_mfma_f32_16x16x32_bf16 v[40:43], a[136:139], v[144:147], v[40:43]
    ds_read_b64_tr_b16 a[130:131], v180 offset:8192
    v_exp_f32 v141, v141
    v_mfma_f32_16x16x32_bf16 v[56:59], a[140:143], v[144:147], v[56:59]
    ds_read_b64_tr_b16 a[132:133], v181 offset:0
    v_cvt_pk_bf16_f32 v150, v140, v141
    v_mfma_f32_16x16x32_bf16 v[72:75], a[144:147], v[144:147], v[72:75]
    ds_read_b64_tr_b16 a[134:135], v181 offset:8192
    v_exp_f32 v142, v142
    v_mfma_f32_16x16x32_bf16 v[88:91], a[148:151], v[144:147], v[88:91]
    ds_read_b64_tr_b16 a[136:137], v182 offset:0
    v_mfma_f32_16x16x32_bf16 v[104:107], a[152:155], v[144:147], v[104:107]
    ds_read_b64_tr_b16 a[138:139], v182 offset:8192
    v_exp_f32 v143, v143
    v_mfma_f32_16x16x32_bf16 v[120:123], a[156:159], v[144:147], v[120:123]
    v_cvt_pk_bf16_f32 v151, v142, v143
    v_mfma_f32_16x16x32_bf16 v[208:211], v[216:219], v[144:147], v[208:211]
    buffer_load_dwordx4 v252, s[4:7], s49 offen offset:2048 lds
    v_mfma_f32_16x16x32_bf16 v[136:139], a[96:99], a[32:35], v[160:163]
    v_exp_f32 v128, v128
    v_mfma_f32_16x16x32_bf16 v[136:139], a[100:103], a[36:39], v[136:139]
    ds_read_b64_tr_b16 a[140:141], v183 offset:0
    v_mfma_f32_16x16x32_bf16 v[136:139], a[104:107], a[40:43], v[136:139]
    ds_read_b64_tr_b16 a[142:143], v183 offset:8192
    v_exp_f32 v129, v129
    v_mfma_f32_16x16x32_bf16 v[136:139], a[108:111], a[44:47], v[136:139]
    ds_read_b64_tr_b16 a[144:145], v184 offset:0
    v_cvt_pk_bf16_f32 v144, v128, v129
    v_mfma_f32_16x16x32_bf16 v[140:143], a[112:115], a[32:35], v[160:163]
    ds_read_b64_tr_b16 a[146:147], v184 offset:8192
    v_exp_f32 v130, v130
    v_mfma_f32_16x16x32_bf16 v[140:143], a[116:119], a[36:39], v[140:143]
    ds_read_b64_tr_b16 a[148:149], v185 offset:0
    v_mfma_f32_16x16x32_bf16 v[140:143], a[120:123], a[40:43], v[140:143]
    ds_read_b64_tr_b16 a[150:151], v185 offset:8192
    v_exp_f32 v131, v131
    v_mfma_f32_16x16x32_bf16 v[140:143], a[124:127], a[44:47], v[140:143]
    ds_read_b64_tr_b16 a[152:153], v186 offset:0
    v_cvt_pk_bf16_f32 v145, v130, v131
    v_mfma_f32_16x16x32_bf16 v[0:3], a[160:163], v[148:151], v[0:3]
    buffer_load_dwordx4 a[216:219], v252, s[4:7], s46 offen offset:2048
    v_exp_f32 v132, v132
    v_mfma_f32_16x16x32_bf16 v[16:19], a[164:167], v[148:151], v[16:19]
    ds_read_b64_tr_b16 a[154:155], v186 offset:8192
    v_mfma_f32_16x16x32_bf16 v[32:35], a[168:171], v[148:151], v[32:35]
    ds_read_b64_tr_b16 a[156:157], v187 offset:0
    v_exp_f32 v133, v133
    v_mfma_f32_16x16x32_bf16 v[48:51], a[172:175], v[148:151], v[48:51]
    ds_read_b64_tr_b16 a[158:159], v187 offset:8192
    v_cvt_pk_bf16_f32 v146, v132, v133
    v_mfma_f32_16x16x32_bf16 v[64:67], a[176:179], v[148:151], v[64:67]
    v_exp_f32 v134, v134
    v_mfma_f32_16x16x32_bf16 v[80:83], a[180:183], v[148:151], v[80:83]
    buffer_load_dwordx4 v253, s[4:7], s49 offen offset:3072 lds
    s_add_u32 s49, s49, 36864
    v_mfma_f32_16x16x32_bf16 v[96:99], a[184:187], v[148:151], v[96:99]
    buffer_load_dwordx4 a[220:223], v253, s[4:7], s46 offen offset:3072
    v_exp_f32 v135, v135
    s_add_u32 s46, s46, 36864
    v_mfma_f32_16x16x32_bf16 v[112:115], a[188:191], v[148:151], v[112:115]
    v_cvt_pk_bf16_f32 v147, v134, v135
    v_mfma_f32_16x16x32_bf16 v[200:203], v[216:219], v[148:151], v[200:203]
    s_waitcnt vmcnt(32) lgkmcnt(0)
    s_barrier
    s_add_u32 m0, s35, 0
    v_mfma_f32_16x16x32_bf16 v[128:131], a[64:67], a[0:3], v[152:155]
    v_exp_f32 v136, v136
    v_mfma_f32_16x16x32_bf16 v[128:131], a[68:71], a[4:7], v[128:131]
    ds_read_b128 a[96:99], v172 offset:16384
    v_mfma_f32_16x16x32_bf16 v[128:131], a[72:75], a[8:11], v[128:131]
    v_exp_f32 v137, v137
    v_mfma_f32_16x16x32_bf16 v[128:131], a[76:79], a[12:15], v[128:131]
    ds_read_b128 a[100:103], v173 offset:16384
    v_cvt_pk_bf16_f32 v148, v136, v137
    v_mfma_f32_16x16x32_bf16 v[132:135], a[80:83], a[0:3], v[152:155]
    v_exp_f32 v138, v138
    v_mfma_f32_16x16x32_bf16 v[132:135], a[84:87], a[4:7], v[132:135]
    ds_read_b128 a[104:107], v174 offset:16384
    v_mfma_f32_16x16x32_bf16 v[132:135], a[88:91], a[8:11], v[132:135]
    buffer_load_dwordx4 a[224:227], v250, s[4:7], s46 offen offset:0
    v_exp_f32 v139, v139
    v_mfma_f32_16x16x32_bf16 v[132:135], a[92:95], a[12:15], v[132:135]
    ds_read_b128 a[108:111], v175 offset:16384
    v_cvt_pk_bf16_f32 v149, v138, v139
    v_mfma_f32_16x16x32_bf16 v[4:7], a[160:163], v[144:147], v[4:7]
    v_exp_f32 v140, v140
    v_mfma_f32_16x16x32_bf16 v[20:23], a[164:167], v[144:147], v[20:23]
    ds_read_b128 a[112:115], v172 offset:24576
    v_mfma_f32_16x16x32_bf16 v[36:39], a[168:171], v[144:147], v[36:39]
    v_exp_f32 v141, v141
    v_mfma_f32_16x16x32_bf16 v[52:55], a[172:175], v[144:147], v[52:55]
    ds_read_b128 a[116:119], v173 offset:24576
    v_cvt_pk_bf16_f32 v150, v140, v141
    v_mfma_f32_16x16x32_bf16 v[68:71], a[176:179], v[144:147], v[68:71]
    v_exp_f32 v142, v142
    v_mfma_f32_16x16x32_bf16 v[84:87], a[180:183], v[144:147], v[84:87]
    ds_read_b128 a[120:123], v174 offset:24576
    v_mfma_f32_16x16x32_bf16 v[100:103], a[184:187], v[144:147], v[100:103]
    v_exp_f32 v143, v143
    v_mfma_f32_16x16x32_bf16 v[116:119], a[188:191], v[144:147], v[116:119]
    ds_read_b128 a[124:127], v175 offset:24576
    v_cvt_pk_bf16_f32 v151, v142, v143
    v_mfma_f32_16x16x32_bf16 v[204:207], v[216:219], v[144:147], v[204:207]
    buffer_load_dwordx4 v250, s[4:7], s49 offen offset:0 lds
    v_mfma_f32_16x16x32_bf16 v[136:139], a[64:67], a[16:19], v[156:159]
    v_exp_f32 v128, v128
    v_mfma_f32_16x16x32_bf16 v[136:139], a[68:71], a[20:23], v[136:139]
    v_mfma_f32_16x16x32_bf16 v[136:139], a[72:75], a[24:27], v[136:139]
    v_exp_f32 v129, v129
    v_mfma_f32_16x16x32_bf16 v[136:139], a[76:79], a[28:31], v[136:139]
    buffer_load_dwordx4 a[228:231], v251, s[4:7], s46 offen offset:1024
    v_cvt_pk_bf16_f32 v144, v128, v129
    v_mfma_f32_16x16x32_bf16 v[140:143], a[80:83], a[16:19], v[156:159]
    v_exp_f32 v130, v130
    v_mfma_f32_16x16x32_bf16 v[140:143], a[84:87], a[20:23], v[140:143]
    buffer_load_dwordx4 v251, s[4:7], s49 offen offset:1024 lds
    v_mfma_f32_16x16x32_bf16 v[140:143], a[88:91], a[24:27], v[140:143]
    v_exp_f32 v131, v131
    v_mfma_f32_16x16x32_bf16 v[140:143], a[92:95], a[28:31], v[140:143]
    v_cvt_pk_bf16_f32 v145, v130, v131
    v_mfma_f32_16x16x32_bf16 v[8:11], a[160:163], v[148:151], v[8:11]
    v_exp_f32 v132, v132
    v_mfma_f32_16x16x32_bf16 v[24:27], a[164:167], v[148:151], v[24:27]
    ds_read_b64_tr_b16 a[160:161], v180 offset:16384
    v_mfma_f32_16x16x32_bf16 v[40:43], a[168:171], v[148:151], v[40:43]
    ds_read_b64_tr_b16 a[162:163], v180 offset:24576
    v_exp_f32 v133, v133
    v_mfma_f32_16x16x32_bf16 v[56:59], a[172:175], v[148:151], v[56:59]
    ds_read_b64_tr_b16 a[164:165], v181 offset:16384
    v_cvt_pk_bf16_f32 v146, v132, v133
    v_mfma_f32_16x16x32_bf16 v[72:75], a[176:179], v[148:151], v[72:75]
    ds_read_b64_tr_b16 a[166:167], v181 offset:24576
    v_exp_f32 v134, v134
    v_mfma_f32_16x16x32_bf16 v[88:91], a[180:183], v[148:151], v[88:91]
    ds_read_b64_tr_b16 a[168:169], v182 offset:16384
    v_mfma_f32_16x16x32_bf16 v[104:107], a[184:187], v[148:151], v[104:107]
    ds_read_b64_tr_b16 a[170:171], v182 offset:24576
    v_exp_f32 v135, v135
    v_mfma_f32_16x16x32_bf16 v[120:123], a[188:191], v[148:151], v[120:123]
    v_cvt_pk_bf16_f32 v147, v134, v135
    v_mfma_f32_16x16x32_bf16 v[208:211], v[216:219], v[148:151], v[208:211]
    buffer_load_dwordx4 v252, s[4:7], s49 offen offset:2048 lds
    v_mfma_f32_16x16x32_bf16 v[128:131], a[64:67], a[32:35], v[160:163]
    v_exp_f32 v136, v136
    v_mfma_f32_16x16x32_bf16 v[128:131], a[68:71], a[36:39], v[128:131]
    ds_read_b64_tr_b16 a[172:173], v183 offset:16384
    v_mfma_f32_16x16x32_bf16 v[128:131], a[72:75], a[40:43], v[128:131]
    ds_read_b64_tr_b16 a[174:175], v183 offset:24576
    v_exp_f32 v137, v137
    v_mfma_f32_16x16x32_bf16 v[128:131], a[76:79], a[44:47], v[128:131]
    ds_read_b64_tr_b16 a[176:177], v184 offset:16384
    v_cvt_pk_bf16_f32 v148, v136, v137
    v_mfma_f32_16x16x32_bf16 v[132:135], a[80:83], a[32:35], v[160:163]
    ds_read_b64_tr_b16 a[178:179], v184 offset:24576
    v_exp_f32 v138, v138
    v_mfma_f32_16x16x32_bf16 v[132:135], a[84:87], a[36:39], v[132:135]
    ds_read_b64_tr_b16 a[180:181], v185 offset:16384
    v_mfma_f32_16x16x32_bf16 v[132:135], a[88:91], a[40:43], v[132:135]
    ds_read_b64_tr_b16 a[182:183], v185 offset:24576
    v_exp_f32 v139, v139
    v_mfma_f32_16x16x32_bf16 v[132:135], a[92:95], a[44:47], v[132:135]
    ds_read_b64_tr_b16 a[184:185], v186 offset:16384
    v_cvt_pk_bf16_f32 v149, v138, v139
    v_mfma_f32_16x16x32_bf16 v[0:3], a[128:131], v[144:147], v[0:3]
    buffer_load_dwordx4 a[232:235], v252, s[4:7], s46 offen offset:2048
    v_exp_f32 v140, v140
    v_mfma_f32_16x16x32_bf16 v[16:19], a[132:135], v[144:147], v[16:19]
    ds_read_b64_tr_b16 a[186:187], v186 offset:24576
    v_mfma_f32_16x16x32_bf16 v[32:35], a[136:139], v[144:147], v[32:35]
    ds_read_b64_tr_b16 a[188:189], v187 offset:16384
    v_exp_f32 v141, v141
    v_mfma_f32_16x16x32_bf16 v[48:51], a[140:143], v[144:147], v[48:51]
    ds_read_b64_tr_b16 a[190:191], v187 offset:24576
    v_cvt_pk_bf16_f32 v150, v140, v141
    v_mfma_f32_16x16x32_bf16 v[64:67], a[144:147], v[144:147], v[64:67]
    v_exp_f32 v142, v142
    v_mfma_f32_16x16x32_bf16 v[80:83], a[148:151], v[144:147], v[80:83]
    buffer_load_dwordx4 v253, s[4:7], s49 offen offset:3072 lds
    s_add_u32 s49, s49, 36864
    v_mfma_f32_16x16x32_bf16 v[96:99], a[152:155], v[144:147], v[96:99]
    buffer_load_dwordx4 a[236:239], v253, s[4:7], s46 offen offset:3072
    v_exp_f32 v143, v143
    s_add_u32 s46, s46, 36864
    v_mfma_f32_16x16x32_bf16 v[112:115], a[156:159], v[144:147], v[112:115]
    v_cvt_pk_bf16_f32 v151, v142, v143
    v_mfma_f32_16x16x32_bf16 v[200:203], v[216:219], v[144:147], v[200:203]
    s_waitcnt vmcnt(36) lgkmcnt(0)
    s_barrier
    s_add_u32 m0, s35, 16384
    v_mfma_f32_16x16x32_bf16 v[136:139], a[96:99], a[0:3], v[152:155]
    v_exp_f32 v128, v128
    v_mfma_f32_16x16x32_bf16 v[136:139], a[100:103], a[4:7], v[136:139]
    ds_read_b128 a[64:67], v172 offset:32768
    v_mfma_f32_16x16x32_bf16 v[136:139], a[104:107], a[8:11], v[136:139]
    v_exp_f32 v129, v129
    v_mfma_f32_16x16x32_bf16 v[136:139], a[108:111], a[12:15], v[136:139]
    ds_read_b128 a[68:71], v173 offset:32768
    v_cvt_pk_bf16_f32 v144, v128, v129
    v_mfma_f32_16x16x32_bf16 v[140:143], a[112:115], a[0:3], v[152:155]
    v_exp_f32 v130, v130
    v_mfma_f32_16x16x32_bf16 v[140:143], a[116:119], a[4:7], v[140:143]
    ds_read_b128 a[72:75], v174 offset:32768
    v_mfma_f32_16x16x32_bf16 v[140:143], a[120:123], a[8:11], v[140:143]
    buffer_load_dwordx4 a[240:243], v250, s[4:7], s46 offen offset:0
    v_exp_f32 v131, v131
    v_mfma_f32_16x16x32_bf16 v[140:143], a[124:127], a[12:15], v[140:143]
    ds_read_b128 a[76:79], v175 offset:32768
    v_cvt_pk_bf16_f32 v145, v130, v131
    v_mfma_f32_16x16x32_bf16 v[4:7], a[128:131], v[148:151], v[4:7]
    v_exp_f32 v132, v132
    v_mfma_f32_16x16x32_bf16 v[20:23], a[132:135], v[148:151], v[20:23]
    ds_read_b128 a[80:83], v172 offset:40960
    v_mfma_f32_16x16x32_bf16 v[36:39], a[136:139], v[148:151], v[36:39]
    v_exp_f32 v133, v133
    v_mfma_f32_16x16x32_bf16 v[52:55], a[140:143], v[148:151], v[52:55]
    ds_read_b128 a[84:87], v173 offset:40960
    v_cvt_pk_bf16_f32 v146, v132, v133
    v_mfma_f32_16x16x32_bf16 v[68:71], a[144:147], v[148:151], v[68:71]
    v_exp_f32 v134, v134
    v_mfma_f32_16x16x32_bf16 v[84:87], a[148:151], v[148:151], v[84:87]
    ds_read_b128 a[88:91], v174 offset:40960
    v_mfma_f32_16x16x32_bf16 v[100:103], a[152:155], v[148:151], v[100:103]
    v_exp_f32 v135, v135
    v_mfma_f32_16x16x32_bf16 v[116:119], a[156:159], v[148:151], v[116:119]
    ds_read_b128 a[92:95], v175 offset:40960
    v_cvt_pk_bf16_f32 v147, v134, v135
    v_mfma_f32_16x16x32_bf16 v[204:207], v[216:219], v[148:151], v[204:207]
    buffer_load_dwordx4 v250, s[4:7], s49 offen offset:0 lds
    v_mfma_f32_16x16x32_bf16 v[128:131], a[96:99], a[16:19], v[156:159]
    v_exp_f32 v136, v136
    v_mfma_f32_16x16x32_bf16 v[128:131], a[100:103], a[20:23], v[128:131]
    v_mfma_f32_16x16x32_bf16 v[128:131], a[104:107], a[24:27], v[128:131]
    v_exp_f32 v137, v137
    v_mfma_f32_16x16x32_bf16 v[128:131], a[108:111], a[28:31], v[128:131]
    buffer_load_dwordx4 a[244:247], v251, s[4:7], s46 offen offset:1024
    v_cvt_pk_bf16_f32 v148, v136, v137
    v_mfma_f32_16x16x32_bf16 v[132:135], a[112:115], a[16:19], v[156:159]
    v_exp_f32 v138, v138
    v_mfma_f32_16x16x32_bf16 v[132:135], a[116:119], a[20:23], v[132:135]
    buffer_load_dwordx4 v251, s[4:7], s49 offen offset:1024 lds
    v_mfma_f32_16x16x32_bf16 v[132:135], a[120:123], a[24:27], v[132:135]
    v_exp_f32 v139, v139
    v_mfma_f32_16x16x32_bf16 v[132:135], a[124:127], a[28:31], v[132:135]
    v_cvt_pk_bf16_f32 v149, v138, v139
    v_mfma_f32_16x16x32_bf16 v[8:11], a[128:131], v[144:147], v[8:11]
    v_exp_f32 v140, v140
    v_mfma_f32_16x16x32_bf16 v[24:27], a[132:135], v[144:147], v[24:27]
    ds_read_b64_tr_b16 a[128:129], v180 offset:32768
    v_mfma_f32_16x16x32_bf16 v[40:43], a[136:139], v[144:147], v[40:43]
    ds_read_b64_tr_b16 a[130:131], v180 offset:40960
    v_exp_f32 v141, v141
    v_mfma_f32_16x16x32_bf16 v[56:59], a[140:143], v[144:147], v[56:59]
    ds_read_b64_tr_b16 a[132:133], v181 offset:32768
    v_cvt_pk_bf16_f32 v150, v140, v141
    v_mfma_f32_16x16x32_bf16 v[72:75], a[144:147], v[144:147], v[72:75]
    ds_read_b64_tr_b16 a[134:135], v181 offset:40960
    v_exp_f32 v142, v142
    v_mfma_f32_16x16x32_bf16 v[88:91], a[148:151], v[144:147], v[88:91]
    ds_read_b64_tr_b16 a[136:137], v182 offset:32768
    v_mfma_f32_16x16x32_bf16 v[104:107], a[152:155], v[144:147], v[104:107]
    ds_read_b64_tr_b16 a[138:139], v182 offset:40960
    v_exp_f32 v143, v143
    v_mfma_f32_16x16x32_bf16 v[120:123], a[156:159], v[144:147], v[120:123]
    v_cvt_pk_bf16_f32 v151, v142, v143
    v_mfma_f32_16x16x32_bf16 v[208:211], v[216:219], v[144:147], v[208:211]
    buffer_load_dwordx4 v252, s[4:7], s49 offen offset:2048 lds
    v_mfma_f32_16x16x32_bf16 v[136:139], a[96:99], a[32:35], v[160:163]
    v_exp_f32 v128, v128
    v_mfma_f32_16x16x32_bf16 v[136:139], a[100:103], a[36:39], v[136:139]
    ds_read_b64_tr_b16 a[140:141], v183 offset:32768
    v_mfma_f32_16x16x32_bf16 v[136:139], a[104:107], a[40:43], v[136:139]
    ds_read_b64_tr_b16 a[142:143], v183 offset:40960
    v_exp_f32 v129, v129
    v_mfma_f32_16x16x32_bf16 v[136:139], a[108:111], a[44:47], v[136:139]
    ds_read_b64_tr_b16 a[144:145], v184 offset:32768
    v_cvt_pk_bf16_f32 v144, v128, v129
    v_mfma_f32_16x16x32_bf16 v[140:143], a[112:115], a[32:35], v[160:163]
    ds_read_b64_tr_b16 a[146:147], v184 offset:40960
    v_exp_f32 v130, v130
    v_mfma_f32_16x16x32_bf16 v[140:143], a[116:119], a[36:39], v[140:143]
    ds_read_b64_tr_b16 a[148:149], v185 offset:32768
    v_mfma_f32_16x16x32_bf16 v[140:143], a[120:123], a[40:43], v[140:143]
    ds_read_b64_tr_b16 a[150:151], v185 offset:40960
    v_exp_f32 v131, v131
    v_mfma_f32_16x16x32_bf16 v[140:143], a[124:127], a[44:47], v[140:143]
    ds_read_b64_tr_b16 a[152:153], v186 offset:32768
    v_cvt_pk_bf16_f32 v145, v130, v131
    v_mfma_f32_16x16x32_bf16 v[0:3], a[160:163], v[148:151], v[0:3]
    buffer_load_dwordx4 a[248:251], v252, s[4:7], s46 offen offset:2048
    v_exp_f32 v132, v132
    v_mfma_f32_16x16x32_bf16 v[16:19], a[164:167], v[148:151], v[16:19]
    ds_read_b64_tr_b16 a[154:155], v186 offset:40960
    v_mfma_f32_16x16x32_bf16 v[32:35], a[168:171], v[148:151], v[32:35]
    ds_read_b64_tr_b16 a[156:157], v187 offset:32768
    v_exp_f32 v133, v133
    v_mfma_f32_16x16x32_bf16 v[48:51], a[172:175], v[148:151], v[48:51]
    ds_read_b64_tr_b16 a[158:159], v187 offset:40960
    v_cvt_pk_bf16_f32 v146, v132, v133
    v_mfma_f32_16x16x32_bf16 v[64:67], a[176:179], v[148:151], v[64:67]
    v_exp_f32 v134, v134
    v_mfma_f32_16x16x32_bf16 v[80:83], a[180:183], v[148:151], v[80:83]
    buffer_load_dwordx4 v253, s[4:7], s49 offen offset:3072 lds
    s_add_u32 s49, s49, 36864
    v_mfma_f32_16x16x32_bf16 v[96:99], a[184:187], v[148:151], v[96:99]
    buffer_load_dwordx4 a[252:255], v253, s[4:7], s46 offen offset:3072
    v_exp_f32 v135, v135
    s_add_u32 s46, s46, 36864
    v_mfma_f32_16x16x32_bf16 v[112:115], a[188:191], v[148:151], v[112:115]
    v_cvt_pk_bf16_f32 v147, v134, v135
    v_mfma_f32_16x16x32_bf16 v[200:203], v[216:219], v[148:151], v[200:203]
    s_waitcnt vmcnt(40) lgkmcnt(0)
    s_barrier
    s_add_u32 m0, s35, 32768
    v_mfma_f32_16x16x32_bf16 v[128:131], a[64:67], a[0:3], v[152:155]
    v_exp_f32 v136, v136
    v_mfma_f32_16x16x32_bf16 v[128:131], a[68:71], a[4:7], v[128:131]
    ds_read_b128 a[96:99], v172 offset:49152
    v_mfma_f32_16x16x32_bf16 v[128:131], a[72:75], a[8:11], v[128:131]
    v_exp_f32 v137, v137
    v_mfma_f32_16x16x32_bf16 v[128:131], a[76:79], a[12:15], v[128:131]
    ds_read_b128 a[100:103], v173 offset:49152
    v_cvt_pk_bf16_f32 v148, v136, v137
    v_mfma_f32_16x16x32_bf16 v[132:135], a[80:83], a[0:3], v[152:155]
    v_exp_f32 v138, v138
    v_mfma_f32_16x16x32_bf16 v[132:135], a[84:87], a[4:7], v[132:135]
    ds_read_b128 a[104:107], v174 offset:49152
    v_mfma_f32_16x16x32_bf16 v[132:135], a[88:91], a[8:11], v[132:135]
    v_exp_f32 v139, v139
    v_mfma_f32_16x16x32_bf16 v[132:135], a[92:95], a[12:15], v[132:135]
    ds_read_b128 a[108:111], v175 offset:49152
    v_cvt_pk_bf16_f32 v149, v138, v139
    v_mfma_f32_16x16x32_bf16 v[4:7], a[160:163], v[144:147], v[4:7]
    v_exp_f32 v140, v140
    v_mfma_f32_16x16x32_bf16 v[20:23], a[164:167], v[144:147], v[20:23]
    ds_read_b128 a[112:115], v172 offset:57344
    v_mfma_f32_16x16x32_bf16 v[36:39], a[168:171], v[144:147], v[36:39]
    v_exp_f32 v141, v141
    v_mfma_f32_16x16x32_bf16 v[52:55], a[172:175], v[144:147], v[52:55]
    ds_read_b128 a[116:119], v173 offset:57344
    v_cvt_pk_bf16_f32 v150, v140, v141
    v_mfma_f32_16x16x32_bf16 v[68:71], a[176:179], v[144:147], v[68:71]
    v_exp_f32 v142, v142
    v_mfma_f32_16x16x32_bf16 v[84:87], a[180:183], v[144:147], v[84:87]
    ds_read_b128 a[120:123], v174 offset:57344
    v_mfma_f32_16x16x32_bf16 v[100:103], a[184:187], v[144:147], v[100:103]
    v_exp_f32 v143, v143
    v_mfma_f32_16x16x32_bf16 v[116:119], a[188:191], v[144:147], v[116:119]
    ds_read_b128 a[124:127], v175 offset:57344
    v_cvt_pk_bf16_f32 v151, v142, v143
    v_mfma_f32_16x16x32_bf16 v[204:207], v[216:219], v[144:147], v[204:207]
    buffer_load_dwordx4 v250, s[4:7], s49 offen offset:0 lds
    v_mfma_f32_16x16x32_bf16 v[136:139], a[64:67], a[16:19], v[156:159]
    v_exp_f32 v128, v128
    v_mfma_f32_16x16x32_bf16 v[136:139], a[68:71], a[20:23], v[136:139]
    v_mfma_f32_16x16x32_bf16 v[136:139], a[72:75], a[24:27], v[136:139]
    v_exp_f32 v129, v129
    v_mfma_f32_16x16x32_bf16 v[136:139], a[76:79], a[28:31], v[136:139]
    v_cvt_pk_bf16_f32 v144, v128, v129
    v_mfma_f32_16x16x32_bf16 v[140:143], a[80:83], a[16:19], v[156:159]
    v_exp_f32 v130, v130
    v_mfma_f32_16x16x32_bf16 v[140:143], a[84:87], a[20:23], v[140:143]
    buffer_load_dwordx4 v251, s[4:7], s49 offen offset:1024 lds
    v_mfma_f32_16x16x32_bf16 v[140:143], a[88:91], a[24:27], v[140:143]
    v_exp_f32 v131, v131
    v_mfma_f32_16x16x32_bf16 v[140:143], a[92:95], a[28:31], v[140:143]
    v_cvt_pk_bf16_f32 v145, v130, v131
    v_mfma_f32_16x16x32_bf16 v[8:11], a[160:163], v[148:151], v[8:11]
    v_exp_f32 v132, v132
    v_mfma_f32_16x16x32_bf16 v[24:27], a[164:167], v[148:151], v[24:27]
    ds_read_b64_tr_b16 a[160:161], v180 offset:49152
    v_mfma_f32_16x16x32_bf16 v[40:43], a[168:171], v[148:151], v[40:43]
    ds_read_b64_tr_b16 a[162:163], v180 offset:57344
    v_exp_f32 v133, v133
    v_mfma_f32_16x16x32_bf16 v[56:59], a[172:175], v[148:151], v[56:59]
    ds_read_b64_tr_b16 a[164:165], v181 offset:49152
    v_cvt_pk_bf16_f32 v146, v132, v133
    v_mfma_f32_16x16x32_bf16 v[72:75], a[176:179], v[148:151], v[72:75]
    ds_read_b64_tr_b16 a[166:167], v181 offset:57344
    v_exp_f32 v134, v134
    v_mfma_f32_16x16x32_bf16 v[88:91], a[180:183], v[148:151], v[88:91]
    ds_read_b64_tr_b16 a[168:169], v182 offset:49152
    v_mfma_f32_16x16x32_bf16 v[104:107], a[184:187], v[148:151], v[104:107]
    ds_read_b64_tr_b16 a[170:171], v182 offset:57344
    v_exp_f32 v135, v135
    v_mfma_f32_16x16x32_bf16 v[120:123], a[188:191], v[148:151], v[120:123]
    v_cvt_pk_bf16_f32 v147, v134, v135
    v_mfma_f32_16x16x32_bf16 v[208:211], v[216:219], v[148:151], v[208:211]
    buffer_load_dwordx4 v252, s[4:7], s49 offen offset:2048 lds
    v_mfma_f32_16x16x32_bf16 v[128:131], a[64:67], a[32:35], v[160:163]
    v_exp_f32 v136, v136
    v_mfma_f32_16x16x32_bf16 v[128:131], a[68:71], a[36:39], v[128:131]
    ds_read_b64_tr_b16 a[172:173], v183 offset:49152
    v_mfma_f32_16x16x32_bf16 v[128:131], a[72:75], a[40:43], v[128:131]
    ds_read_b64_tr_b16 a[174:175], v183 offset:57344
    v_exp_f32 v137, v137
    v_mfma_f32_16x16x32_bf16 v[128:131], a[76:79], a[44:47], v[128:131]
    ds_read_b64_tr_b16 a[176:177], v184 offset:49152
    v_cvt_pk_bf16_f32 v148, v136, v137
    v_mfma_f32_16x16x32_bf16 v[132:135], a[80:83], a[32:35], v[160:163]
    ds_read_b64_tr_b16 a[178:179], v184 offset:57344
    v_exp_f32 v138, v138
    v_mfma_f32_16x16x32_bf16 v[132:135], a[84:87], a[36:39], v[132:135]
    ds_read_b64_tr_b16 a[180:181], v185 offset:49152
    v_mfma_f32_16x16x32_bf16 v[132:135], a[88:91], a[40:43], v[132:135]
    ds_read_b64_tr_b16 a[182:183], v185 offset:57344
    v_exp_f32 v139, v139
    v_mfma_f32_16x16x32_bf16 v[132:135], a[92:95], a[44:47], v[132:135]
    ds_read_b64_tr_b16 a[184:185], v186 offset:49152
    v_cvt_pk_bf16_f32 v149, v138, v139
    v_mfma_f32_16x16x32_bf16 v[0:3], a[128:131], v[144:147], v[0:3]
    v_exp_f32 v140, v140
    v_mfma_f32_16x16x32_bf16 v[16:19], a[132:135], v[144:147], v[16:19]
    ds_read_b64_tr_b16 a[186:187], v186 offset:57344
    v_mfma_f32_16x16x32_bf16 v[32:35], a[136:139], v[144:147], v[32:35]
    ds_read_b64_tr_b16 a[188:189], v187 offset:49152
    v_exp_f32 v141, v141
    v_mfma_f32_16x16x32_bf16 v[48:51], a[140:143], v[144:147], v[48:51]
    ds_read_b64_tr_b16 a[190:191], v187 offset:57344
    v_cvt_pk_bf16_f32 v150, v140, v141
    v_mfma_f32_16x16x32_bf16 v[64:67], a[144:147], v[144:147], v[64:67]
    v_exp_f32 v142, v142
    v_mfma_f32_16x16x32_bf16 v[80:83], a[148:151], v[144:147], v[80:83]
    buffer_load_dwordx4 v253, s[4:7], s49 offen offset:3072 lds
    s_add_u32 s49, s49, 36864
    v_mfma_f32_16x16x32_bf16 v[96:99], a[152:155], v[144:147], v[96:99]
    v_exp_f32 v143, v143
    v_mfma_f32_16x16x32_bf16 v[112:115], a[156:159], v[144:147], v[112:115]
    v_cvt_pk_bf16_f32 v151, v142, v143
    v_mfma_f32_16x16x32_bf16 v[200:203], v[216:219], v[144:147], v[200:203]
    s_waitcnt vmcnt(40) lgkmcnt(0)
    s_barrier
    s_add_u32 m0, s35, 49152
    v_mfma_f32_16x16x32_bf16 v[136:139], a[96:99], a[0:3], v[152:155]
    v_exp_f32 v128, v128
    v_mfma_f32_16x16x32_bf16 v[136:139], a[100:103], a[4:7], v[136:139]
    ds_read_b128 a[64:67], v176 offset:0
    v_mfma_f32_16x16x32_bf16 v[136:139], a[104:107], a[8:11], v[136:139]
    v_exp_f32 v129, v129
    v_mfma_f32_16x16x32_bf16 v[136:139], a[108:111], a[12:15], v[136:139]
    ds_read_b128 a[68:71], v177 offset:0
    v_cvt_pk_bf16_f32 v144, v128, v129
    v_mfma_f32_16x16x32_bf16 v[140:143], a[112:115], a[0:3], v[152:155]
    v_exp_f32 v130, v130
    v_mfma_f32_16x16x32_bf16 v[140:143], a[116:119], a[4:7], v[140:143]
    ds_read_b128 a[72:75], v178 offset:0
    v_mfma_f32_16x16x32_bf16 v[140:143], a[120:123], a[8:11], v[140:143]
    v_exp_f32 v131, v131
    v_mfma_f32_16x16x32_bf16 v[140:143], a[124:127], a[12:15], v[140:143]
    ds_read_b128 a[76:79], v179 offset:0
    v_cvt_pk_bf16_f32 v145, v130, v131
    v_mfma_f32_16x16x32_bf16 v[4:7], a[128:131], v[148:151], v[4:7]
    v_exp_f32 v132, v132
    v_mfma_f32_16x16x32_bf16 v[20:23], a[132:135], v[148:151], v[20:23]
    ds_read_b128 a[80:83], v176 offset:8192
    v_mfma_f32_16x16x32_bf16 v[36:39], a[136:139], v[148:151], v[36:39]
    v_exp_f32 v133, v133
    v_mfma_f32_16x16x32_bf16 v[52:55], a[140:143], v[148:151], v[52:55]
    ds_read_b128 a[84:87], v177 offset:8192
    v_cvt_pk_bf16_f32 v146, v132, v133
    v_mfma_f32_16x16x32_bf16 v[68:71], a[144:147], v[148:151], v[68:71]
    v_exp_f32 v134, v134
    v_mfma_f32_16x16x32_bf16 v[84:87], a[148:151], v[148:151], v[84:87]
    ds_read_b128 a[88:91], v178 offset:8192
    v_mfma_f32_16x16x32_bf16 v[100:103], a[152:155], v[148:151], v[100:103]
    v_exp_f32 v135, v135
    v_mfma_f32_16x16x32_bf16 v[116:119], a[156:159], v[148:151], v[116:119]
    ds_read_b128 a[92:95], v179 offset:8192
    v_cvt_pk_bf16_f32 v147, v134, v135
    v_mfma_f32_16x16x32_bf16 v[204:207], v[216:219], v[148:151], v[204:207]
    buffer_load_dwordx4 v250, s[4:7], s49 offen offset:0 lds
    v_mfma_f32_16x16x32_bf16 v[128:131], a[96:99], a[16:19], v[156:159]
    v_exp_f32 v136, v136
    v_mfma_f32_16x16x32_bf16 v[128:131], a[100:103], a[20:23], v[128:131]
    v_mfma_f32_16x16x32_bf16 v[128:131], a[104:107], a[24:27], v[128:131]
    v_exp_f32 v137, v137
    v_mfma_f32_16x16x32_bf16 v[128:131], a[108:111], a[28:31], v[128:131]
    v_cvt_pk_bf16_f32 v148, v136, v137
    v_mfma_f32_16x16x32_bf16 v[132:135], a[112:115], a[16:19], v[156:159]
    v_exp_f32 v138, v138
    v_mfma_f32_16x16x32_bf16 v[132:135], a[116:119], a[20:23], v[132:135]
    buffer_load_dwordx4 v251, s[4:7], s49 offen offset:1024 lds
    v_mfma_f32_16x16x32_bf16 v[132:135], a[120:123], a[24:27], v[132:135]
    v_exp_f32 v139, v139
    v_mfma_f32_16x16x32_bf16 v[132:135], a[124:127], a[28:31], v[132:135]
    v_cvt_pk_bf16_f32 v149, v138, v139
    v_mfma_f32_16x16x32_bf16 v[8:11], a[128:131], v[144:147], v[8:11]
    v_exp_f32 v140, v140
    v_mfma_f32_16x16x32_bf16 v[24:27], a[132:135], v[144:147], v[24:27]
    ds_read_b64_tr_b16 a[128:129], v188 offset:0
    v_mfma_f32_16x16x32_bf16 v[40:43], a[136:139], v[144:147], v[40:43]
    ds_read_b64_tr_b16 a[130:131], v188 offset:8192
    v_exp_f32 v141, v141
    v_mfma_f32_16x16x32_bf16 v[56:59], a[140:143], v[144:147], v[56:59]
    ds_read_b64_tr_b16 a[132:133], v189 offset:0
    v_cvt_pk_bf16_f32 v150, v140, v141
    v_mfma_f32_16x16x32_bf16 v[72:75], a[144:147], v[144:147], v[72:75]
    ds_read_b64_tr_b16 a[134:135], v189 offset:8192
    v_exp_f32 v142, v142
    v_mfma_f32_16x16x32_bf16 v[88:91], a[148:151], v[144:147], v[88:91]
    ds_read_b64_tr_b16 a[136:137], v190 offset:0
    v_mfma_f32_16x16x32_bf16 v[104:107], a[152:155], v[144:147], v[104:107]
    ds_read_b64_tr_b16 a[138:139], v190 offset:8192
    v_exp_f32 v143, v143
    v_mfma_f32_16x16x32_bf16 v[120:123], a[156:159], v[144:147], v[120:123]
    v_cvt_pk_bf16_f32 v151, v142, v143
    v_mfma_f32_16x16x32_bf16 v[208:211], v[216:219], v[144:147], v[208:211]
    buffer_load_dwordx4 v252, s[4:7], s49 offen offset:2048 lds
    v_mfma_f32_16x16x32_bf16 v[136:139], a[96:99], a[32:35], v[160:163]
    v_exp_f32 v128, v128
    v_mfma_f32_16x16x32_bf16 v[136:139], a[100:103], a[36:39], v[136:139]
    ds_read_b64_tr_b16 a[140:141], v191 offset:0
    v_mfma_f32_16x16x32_bf16 v[136:139], a[104:107], a[40:43], v[136:139]
    ds_read_b64_tr_b16 a[142:143], v191 offset:8192
    v_exp_f32 v129, v129
    v_mfma_f32_16x16x32_bf16 v[136:139], a[108:111], a[44:47], v[136:139]
    ds_read_b64_tr_b16 a[144:145], v192 offset:0
    v_cvt_pk_bf16_f32 v144, v128, v129
    v_mfma_f32_16x16x32_bf16 v[140:143], a[112:115], a[32:35], v[160:163]
    ds_read_b64_tr_b16 a[146:147], v192 offset:8192
    v_exp_f32 v130, v130
    v_mfma_f32_16x16x32_bf16 v[140:143], a[116:119], a[36:39], v[140:143]
    ds_read_b64_tr_b16 a[148:149], v193 offset:0
    v_mfma_f32_16x16x32_bf16 v[140:143], a[120:123], a[40:43], v[140:143]
    ds_read_b64_tr_b16 a[150:151], v193 offset:8192
    v_exp_f32 v131, v131
    v_mfma_f32_16x16x32_bf16 v[140:143], a[124:127], a[44:47], v[140:143]
    ds_read_b64_tr_b16 a[152:153], v194 offset:0
    v_cvt_pk_bf16_f32 v145, v130, v131
    v_mfma_f32_16x16x32_bf16 v[0:3], a[160:163], v[148:151], v[0:3]
    v_exp_f32 v132, v132
    v_mfma_f32_16x16x32_bf16 v[16:19], a[164:167], v[148:151], v[16:19]
    ds_read_b64_tr_b16 a[154:155], v194 offset:8192
    v_mfma_f32_16x16x32_bf16 v[32:35], a[168:171], v[148:151], v[32:35]
    ds_read_b64_tr_b16 a[156:157], v195 offset:0
    v_exp_f32 v133, v133
    v_mfma_f32_16x16x32_bf16 v[48:51], a[172:175], v[148:151], v[48:51]
    ds_read_b64_tr_b16 a[158:159], v195 offset:8192
    v_cvt_pk_bf16_f32 v146, v132, v133
    v_mfma_f32_16x16x32_bf16 v[64:67], a[176:179], v[148:151], v[64:67]
    v_exp_f32 v134, v134
    v_mfma_f32_16x16x32_bf16 v[80:83], a[180:183], v[148:151], v[80:83]
    buffer_load_dwordx4 v253, s[4:7], s49 offen offset:3072 lds
    s_add_u32 s49, s49, 36864
    v_mfma_f32_16x16x32_bf16 v[96:99], a[184:187], v[148:151], v[96:99]
    v_exp_f32 v135, v135
    v_mfma_f32_16x16x32_bf16 v[112:115], a[188:191], v[148:151], v[112:115]
    v_cvt_pk_bf16_f32 v147, v134, v135
    v_mfma_f32_16x16x32_bf16 v[200:203], v[216:219], v[148:151], v[200:203]
    s_waitcnt vmcnt(40) lgkmcnt(0)
    s_barrier
    s_add_u32 m0, s35, 65536
    v_mfma_f32_16x16x32_bf16 v[128:131], a[64:67], a[0:3], v[152:155]
    v_exp_f32 v136, v136
    v_mfma_f32_16x16x32_bf16 v[128:131], a[68:71], a[4:7], v[128:131]
    ds_read_b128 a[96:99], v176 offset:16384
    v_mfma_f32_16x16x32_bf16 v[128:131], a[72:75], a[8:11], v[128:131]
    v_exp_f32 v137, v137
    v_mfma_f32_16x16x32_bf16 v[128:131], a[76:79], a[12:15], v[128:131]
    ds_read_b128 a[100:103], v177 offset:16384
    v_cvt_pk_bf16_f32 v148, v136, v137
    v_mfma_f32_16x16x32_bf16 v[132:135], a[80:83], a[0:3], v[152:155]
    v_exp_f32 v138, v138
    v_mfma_f32_16x16x32_bf16 v[132:135], a[84:87], a[4:7], v[132:135]
    ds_read_b128 a[104:107], v178 offset:16384
    v_mfma_f32_16x16x32_bf16 v[132:135], a[88:91], a[8:11], v[132:135]
    v_exp_f32 v139, v139
    v_mfma_f32_16x16x32_bf16 v[132:135], a[92:95], a[12:15], v[132:135]
    ds_read_b128 a[108:111], v179 offset:16384
    v_cvt_pk_bf16_f32 v149, v138, v139
    v_mfma_f32_16x16x32_bf16 v[4:7], a[160:163], v[144:147], v[4:7]
    v_exp_f32 v140, v140
    v_mfma_f32_16x16x32_bf16 v[20:23], a[164:167], v[144:147], v[20:23]
    ds_read_b128 a[112:115], v176 offset:24576
    v_mfma_f32_16x16x32_bf16 v[36:39], a[168:171], v[144:147], v[36:39]
    v_exp_f32 v141, v141
    v_mfma_f32_16x16x32_bf16 v[52:55], a[172:175], v[144:147], v[52:55]
    ds_read_b128 a[116:119], v177 offset:24576
    v_cvt_pk_bf16_f32 v150, v140, v141
    v_mfma_f32_16x16x32_bf16 v[68:71], a[176:179], v[144:147], v[68:71]
    v_exp_f32 v142, v142
    v_mfma_f32_16x16x32_bf16 v[84:87], a[180:183], v[144:147], v[84:87]
    ds_read_b128 a[120:123], v178 offset:24576
    v_mfma_f32_16x16x32_bf16 v[100:103], a[184:187], v[144:147], v[100:103]
    v_exp_f32 v143, v143
    v_mfma_f32_16x16x32_bf16 v[116:119], a[188:191], v[144:147], v[116:119]
    ds_read_b128 a[124:127], v179 offset:24576
    v_cvt_pk_bf16_f32 v151, v142, v143
    v_mfma_f32_16x16x32_bf16 v[204:207], v[216:219], v[144:147], v[204:207]
    buffer_load_dwordx4 v250, s[4:7], s49 offen offset:0 lds
    v_mfma_f32_16x16x32_bf16 v[136:139], a[64:67], a[16:19], v[156:159]
    v_exp_f32 v128, v128
    v_mfma_f32_16x16x32_bf16 v[136:139], a[68:71], a[20:23], v[136:139]
    v_mfma_f32_16x16x32_bf16 v[136:139], a[72:75], a[24:27], v[136:139]
    v_exp_f32 v129, v129
    v_mfma_f32_16x16x32_bf16 v[136:139], a[76:79], a[28:31], v[136:139]
    v_cvt_pk_bf16_f32 v144, v128, v129
    v_mfma_f32_16x16x32_bf16 v[140:143], a[80:83], a[16:19], v[156:159]
    v_exp_f32 v130, v130
    v_mfma_f32_16x16x32_bf16 v[140:143], a[84:87], a[20:23], v[140:143]
    buffer_load_dwordx4 v251, s[4:7], s49 offen offset:1024 lds
    v_mfma_f32_16x16x32_bf16 v[140:143], a[88:91], a[24:27], v[140:143]
    v_exp_f32 v131, v131
    v_mfma_f32_16x16x32_bf16 v[140:143], a[92:95], a[28:31], v[140:143]
    v_cvt_pk_bf16_f32 v145, v130, v131
    v_mfma_f32_16x16x32_bf16 v[8:11], a[160:163], v[148:151], v[8:11]
    v_exp_f32 v132, v132
    v_mfma_f32_16x16x32_bf16 v[24:27], a[164:167], v[148:151], v[24:27]
    ds_read_b64_tr_b16 a[160:161], v188 offset:16384
    v_mfma_f32_16x16x32_bf16 v[40:43], a[168:171], v[148:151], v[40:43]
    ds_read_b64_tr_b16 a[162:163], v188 offset:24576
    v_exp_f32 v133, v133
    v_mfma_f32_16x16x32_bf16 v[56:59], a[172:175], v[148:151], v[56:59]
    ds_read_b64_tr_b16 a[164:165], v189 offset:16384
    v_cvt_pk_bf16_f32 v146, v132, v133
    v_mfma_f32_16x16x32_bf16 v[72:75], a[176:179], v[148:151], v[72:75]
    ds_read_b64_tr_b16 a[166:167], v189 offset:24576
    v_exp_f32 v134, v134
    v_mfma_f32_16x16x32_bf16 v[88:91], a[180:183], v[148:151], v[88:91]
    ds_read_b64_tr_b16 a[168:169], v190 offset:16384
    v_mfma_f32_16x16x32_bf16 v[104:107], a[184:187], v[148:151], v[104:107]
    ds_read_b64_tr_b16 a[170:171], v190 offset:24576
    v_exp_f32 v135, v135
    v_mfma_f32_16x16x32_bf16 v[120:123], a[188:191], v[148:151], v[120:123]
    v_cvt_pk_bf16_f32 v147, v134, v135
    v_mfma_f32_16x16x32_bf16 v[208:211], v[216:219], v[148:151], v[208:211]
    buffer_load_dwordx4 v252, s[4:7], s49 offen offset:2048 lds
    v_mfma_f32_16x16x32_bf16 v[128:131], a[64:67], a[32:35], v[160:163]
    v_exp_f32 v136, v136
    v_mfma_f32_16x16x32_bf16 v[128:131], a[68:71], a[36:39], v[128:131]
    ds_read_b64_tr_b16 a[172:173], v191 offset:16384
    v_mfma_f32_16x16x32_bf16 v[128:131], a[72:75], a[40:43], v[128:131]
    ds_read_b64_tr_b16 a[174:175], v191 offset:24576
    v_exp_f32 v137, v137
    v_mfma_f32_16x16x32_bf16 v[128:131], a[76:79], a[44:47], v[128:131]
    ds_read_b64_tr_b16 a[176:177], v192 offset:16384
    v_cvt_pk_bf16_f32 v148, v136, v137
    v_mfma_f32_16x16x32_bf16 v[132:135], a[80:83], a[32:35], v[160:163]
    ds_read_b64_tr_b16 a[178:179], v192 offset:24576
    v_exp_f32 v138, v138
    v_mfma_f32_16x16x32_bf16 v[132:135], a[84:87], a[36:39], v[132:135]
    ds_read_b64_tr_b16 a[180:181], v193 offset:16384
    v_mfma_f32_16x16x32_bf16 v[132:135], a[88:91], a[40:43], v[132:135]
    ds_read_b64_tr_b16 a[182:183], v193 offset:24576
    v_exp_f32 v139, v139
    v_mfma_f32_16x16x32_bf16 v[132:135], a[92:95], a[44:47], v[132:135]
    ds_read_b64_tr_b16 a[184:185], v194 offset:16384
    v_cvt_pk_bf16_f32 v149, v138, v139
    v_mfma_f32_16x16x32_bf16 v[0:3], a[128:131], v[144:147], v[0:3]
    v_exp_f32 v140, v140
    v_mfma_f32_16x16x32_bf16 v[16:19], a[132:135], v[144:147], v[16:19]
    ds_read_b64_tr_b16 a[186:187], v194 offset:24576
    v_mfma_f32_16x16x32_bf16 v[32:35], a[136:139], v[144:147], v[32:35]
    ds_read_b64_tr_b16 a[188:189], v195 offset:16384
    v_exp_f32 v141, v141
    v_mfma_f32_16x16x32_bf16 v[48:51], a[140:143], v[144:147], v[48:51]
    ds_read_b64_tr_b16 a[190:191], v195 offset:24576
    v_cvt_pk_bf16_f32 v150, v140, v141
    v_mfma_f32_16x16x32_bf16 v[64:67], a[144:147], v[144:147], v[64:67]
    v_exp_f32 v142, v142
    v_mfma_f32_16x16x32_bf16 v[80:83], a[148:151], v[144:147], v[80:83]
    buffer_load_dwordx4 v253, s[4:7], s49 offen offset:3072 lds
    s_add_u32 s49, s49, 36864
    v_mfma_f32_16x16x32_bf16 v[96:99], a[152:155], v[144:147], v[96:99]
    v_exp_f32 v143, v143
    v_mfma_f32_16x16x32_bf16 v[112:115], a[156:159], v[144:147], v[112:115]
    v_cvt_pk_bf16_f32 v151, v142, v143
    v_mfma_f32_16x16x32_bf16 v[200:203], v[216:219], v[144:147], v[200:203]
    s_waitcnt vmcnt(20) lgkmcnt(0)
    s_barrier
    s_add_u32 m0, s35, 81920
    v_mfma_f32_16x16x32_bf16 v[136:139], a[96:99], a[0:3], v[152:155]
    v_exp_f32 v128, v128
    v_mfma_f32_16x16x32_bf16 v[136:139], a[100:103], a[4:7], v[136:139]
    v_mfma_f32_16x16x32_bf16 v[136:139], a[104:107], a[8:11], v[136:139]
    v_exp_f32 v129, v129
    v_mfma_f32_16x16x32_bf16 v[136:139], a[108:111], a[12:15], v[136:139]
    buffer_load_dwordx4 a[64:67], v250, s[4:7], s46 offen offset:0
    v_cvt_pk_bf16_f32 v144, v128, v129
    v_mfma_f32_16x16x32_bf16 v[140:143], a[112:115], a[0:3], v[152:155]
    v_exp_f32 v130, v130
    v_mfma_f32_16x16x32_bf16 v[140:143], a[116:119], a[4:7], v[140:143]
    v_mfma_f32_16x16x32_bf16 v[140:143], a[120:123], a[8:11], v[140:143]
    v_exp_f32 v131, v131
    v_mfma_f32_16x16x32_bf16 v[140:143], a[124:127], a[12:15], v[140:143]
    buffer_load_dwordx4 a[68:71], v251, s[4:7], s46 offen offset:1024
    v_cvt_pk_bf16_f32 v145, v130, v131
    v_mfma_f32_16x16x32_bf16 v[4:7], a[128:131], v[148:151], v[4:7]
    v_exp_f32 v132, v132
    v_mfma_f32_16x16x32_bf16 v[20:23], a[132:135], v[148:151], v[20:23]
    v_mfma_f32_16x16x32_bf16 v[36:39], a[136:139], v[148:151], v[36:39]
    v_exp_f32 v133, v133
    v_mfma_f32_16x16x32_bf16 v[52:55], a[140:143], v[148:151], v[52:55]
    buffer_load_dwordx4 a[72:75], v252, s[4:7], s46 offen offset:2048
    v_cvt_pk_bf16_f32 v146, v132, v133
    v_mfma_f32_16x16x32_bf16 v[68:71], a[144:147], v[148:151], v[68:71]
    v_exp_f32 v134, v134
    v_mfma_f32_16x16x32_bf16 v[84:87], a[148:151], v[148:151], v[84:87]
    v_mfma_f32_16x16x32_bf16 v[100:103], a[152:155], v[148:151], v[100:103]
    v_exp_f32 v135, v135
    v_mfma_f32_16x16x32_bf16 v[116:119], a[156:159], v[148:151], v[116:119]
    v_cvt_pk_bf16_f32 v147, v134, v135
    v_mfma_f32_16x16x32_bf16 v[204:207], v[216:219], v[148:151], v[204:207]
    buffer_load_dwordx4 v250, s[4:7], s49 offen offset:0 lds
    v_mfma_f32_16x16x32_bf16 v[128:131], a[96:99], a[16:19], v[156:159]
    v_exp_f32 v136, v136
    v_mfma_f32_16x16x32_bf16 v[128:131], a[100:103], a[20:23], v[128:131]
    v_mfma_f32_16x16x32_bf16 v[128:131], a[104:107], a[24:27], v[128:131]
    v_exp_f32 v137, v137
    v_mfma_f32_16x16x32_bf16 v[128:131], a[108:111], a[28:31], v[128:131]
    v_cvt_pk_bf16_f32 v148, v136, v137
    v_mfma_f32_16x16x32_bf16 v[132:135], a[112:115], a[16:19], v[156:159]
    v_exp_f32 v138, v138
    v_mfma_f32_16x16x32_bf16 v[132:135], a[116:119], a[20:23], v[132:135]
    buffer_load_dwordx4 v251, s[4:7], s49 offen offset:1024 lds
    v_mfma_f32_16x16x32_bf16 v[132:135], a[120:123], a[24:27], v[132:135]
    v_exp_f32 v139, v139
    v_mfma_f32_16x16x32_bf16 v[132:135], a[124:127], a[28:31], v[132:135]
    buffer_load_dwordx4 a[76:79], v253, s[4:7], s46 offen offset:3072
    v_cvt_pk_bf16_f32 v149, v138, v139
    s_add_u32 s46, s46, 36864
    v_mfma_f32_16x16x32_bf16 v[8:11], a[128:131], v[144:147], v[8:11]
    v_exp_f32 v140, v140
    v_mfma_f32_16x16x32_bf16 v[24:27], a[132:135], v[144:147], v[24:27]
    v_mfma_f32_16x16x32_bf16 v[40:43], a[136:139], v[144:147], v[40:43]
    v_exp_f32 v141, v141
    v_mfma_f32_16x16x32_bf16 v[56:59], a[140:143], v[144:147], v[56:59]
    buffer_load_dwordx4 a[80:83], v250, s[4:7], s46 offen offset:0
    v_cvt_pk_bf16_f32 v150, v140, v141
    v_mfma_f32_16x16x32_bf16 v[72:75], a[144:147], v[144:147], v[72:75]
    v_exp_f32 v142, v142
    v_mfma_f32_16x16x32_bf16 v[88:91], a[148:151], v[144:147], v[88:91]
    v_mfma_f32_16x16x32_bf16 v[104:107], a[152:155], v[144:147], v[104:107]
    v_exp_f32 v143, v143
    v_mfma_f32_16x16x32_bf16 v[120:123], a[156:159], v[144:147], v[120:123]
    v_cvt_pk_bf16_f32 v151, v142, v143
    v_mfma_f32_16x16x32_bf16 v[208:211], v[216:219], v[144:147], v[208:211]
    buffer_load_dwordx4 v252, s[4:7], s49 offen offset:2048 lds
    v_mfma_f32_16x16x32_bf16 v[136:139], a[96:99], a[32:35], v[160:163]
    v_exp_f32 v128, v128
    v_mfma_f32_16x16x32_bf16 v[136:139], a[100:103], a[36:39], v[136:139]
    v_mfma_f32_16x16x32_bf16 v[136:139], a[104:107], a[40:43], v[136:139]
    v_exp_f32 v129, v129
    v_mfma_f32_16x16x32_bf16 v[136:139], a[108:111], a[44:47], v[136:139]
    buffer_load_dwordx4 a[84:87], v251, s[4:7], s46 offen offset:1024
    v_cvt_pk_bf16_f32 v144, v128, v129
    v_mfma_f32_16x16x32_bf16 v[140:143], a[112:115], a[32:35], v[160:163]
    v_exp_f32 v130, v130
    v_mfma_f32_16x16x32_bf16 v[140:143], a[116:119], a[36:39], v[140:143]
    v_mfma_f32_16x16x32_bf16 v[140:143], a[120:123], a[40:43], v[140:143]
    v_exp_f32 v131, v131
    v_mfma_f32_16x16x32_bf16 v[140:143], a[124:127], a[44:47], v[140:143]
    buffer_load_dwordx4 a[88:91], v252, s[4:7], s46 offen offset:2048
    v_cvt_pk_bf16_f32 v145, v130, v131
    v_mfma_f32_16x16x32_bf16 v[0:3], a[160:163], v[148:151], v[0:3]
    v_exp_f32 v132, v132
    v_mfma_f32_16x16x32_bf16 v[16:19], a[164:167], v[148:151], v[16:19]
    v_mfma_f32_16x16x32_bf16 v[32:35], a[168:171], v[148:151], v[32:35]
    v_exp_f32 v133, v133
    v_mfma_f32_16x16x32_bf16 v[48:51], a[172:175], v[148:151], v[48:51]
    buffer_load_dwordx4 a[92:95], v253, s[4:7], s46 offen offset:3072
    v_cvt_pk_bf16_f32 v146, v132, v133
    s_add_u32 s46, s46, 36864
    v_mfma_f32_16x16x32_bf16 v[64:67], a[176:179], v[148:151], v[64:67]
    v_exp_f32 v134, v134
    v_mfma_f32_16x16x32_bf16 v[80:83], a[180:183], v[148:151], v[80:83]
    buffer_load_dwordx4 v253, s[4:7], s49 offen offset:3072 lds
    s_add_u32 s49, s49, 36864
    v_mfma_f32_16x16x32_bf16 v[96:99], a[184:187], v[148:151], v[96:99]
    v_exp_f32 v135, v135
    v_mfma_f32_16x16x32_bf16 v[112:115], a[188:191], v[148:151], v[112:115]
    v_cvt_pk_bf16_f32 v147, v134, v135
    v_mfma_f32_16x16x32_bf16 v[200:203], v[216:219], v[148:151], v[200:203]
    s_add_u32 m0, s35, 131072
    s_nop 0
    buffer_load_dwordx4 v250, s[4:7], s49 offen offset:0 lds
    buffer_load_dwordx4 v251, s[4:7], s49 offen offset:1024 lds
    buffer_load_dwordx4 v252, s[4:7], s49 offen offset:2048 lds
    buffer_load_dwordx4 v253, s[4:7], s49 offen offset:3072 lds
    s_add_u32 s49, s49, 36864
    s_nop 0
    v_exp_f32 v136, v136
    s_nop 0
    buffer_load_dwordx4 a[128:131], v250, s[4:7], s46 offen offset:0
    s_nop 0
    v_exp_f32 v137, v137
    s_nop 0
    v_cvt_pk_bf16_f32 v148, v136, v137
    s_nop 0
    v_exp_f32 v138, v138
    s_nop 0
    buffer_load_dwordx4 a[132:135], v251, s[4:7], s46 offen offset:1024
    s_nop 0
    v_exp_f32 v139, v139
    s_nop 0
    v_cvt_pk_bf16_f32 v149, v138, v139
    v_mfma_f32_16x16x32_bf16 v[4:7], a[160:163], v[144:147], v[4:7]
    v_exp_f32 v140, v140
    v_mfma_f32_16x16x32_bf16 v[20:23], a[164:167], v[144:147], v[20:23]
    buffer_load_dwordx4 a[136:139], v252, s[4:7], s46 offen offset:2048
    v_mfma_f32_16x16x32_bf16 v[36:39], a[168:171], v[144:147], v[36:39]
    v_exp_f32 v141, v141
    v_mfma_f32_16x16x32_bf16 v[52:55], a[172:175], v[144:147], v[52:55]
    v_cvt_pk_bf16_f32 v150, v140, v141
    v_mfma_f32_16x16x32_bf16 v[68:71], a[176:179], v[144:147], v[68:71]
    v_exp_f32 v142, v142
    v_mfma_f32_16x16x32_bf16 v[84:87], a[180:183], v[144:147], v[84:87]
    buffer_load_dwordx4 a[140:143], v253, s[4:7], s46 offen offset:3072
    s_add_u32 s46, s46, 36864
    v_mfma_f32_16x16x32_bf16 v[100:103], a[184:187], v[144:147], v[100:103]
    v_exp_f32 v143, v143
    v_mfma_f32_16x16x32_bf16 v[116:119], a[188:191], v[144:147], v[116:119]
    v_cvt_pk_bf16_f32 v151, v142, v143
    v_mfma_f32_16x16x32_bf16 v[204:207], v[216:219], v[144:147], v[204:207]
    s_nop 1
    v_mfma_f32_16x16x32_bf16 v[8:11], a[160:163], v[148:151], v[8:11]
    buffer_load_dwordx4 a[144:147], v250, s[4:7], s46 offen offset:0
    v_mfma_f32_16x16x32_bf16 v[24:27], a[164:167], v[148:151], v[24:27]
    v_mfma_f32_16x16x32_bf16 v[40:43], a[168:171], v[148:151], v[40:43]
    buffer_load_dwordx4 a[148:151], v251, s[4:7], s46 offen offset:1024
    v_mfma_f32_16x16x32_bf16 v[56:59], a[172:175], v[148:151], v[56:59]
    v_mfma_f32_16x16x32_bf16 v[72:75], a[176:179], v[148:151], v[72:75]
    buffer_load_dwordx4 a[152:155], v252, s[4:7], s46 offen offset:2048
    v_mfma_f32_16x16x32_bf16 v[88:91], a[180:183], v[148:151], v[88:91]
    v_mfma_f32_16x16x32_bf16 v[104:107], a[184:187], v[148:151], v[104:107]
    buffer_load_dwordx4 a[156:159], v253, s[4:7], s46 offen offset:3072
    s_add_u32 s46, s46, 36864
    v_mfma_f32_16x16x32_bf16 v[120:123], a[188:191], v[148:151], v[120:123]
    v_mfma_f32_16x16x32_bf16 v[208:211], v[216:219], v[148:151], v[208:211]
    s_branch L_join
L_fallback:
    s_mov_b32 s37, 1
    v_mov_b32 v168, 0xff800000
    v_mov_b32 v169, 0xff800000
    v_mov_b32 v170, 0xff800000
    v_mov_b32 v171, 0xff800000
    s_mov_b32 s29, s34
    s_mov_b32 s31, 64
L_fb_loop:
    s_barrier
    s_add_u32 m0, s35, 98304
    s_nop 0
    buffer_load_dwordx4 v196, s[12:15], s29 offen offset:0 nt lds
    buffer_load_dwordx4 v197, s[12:15], s29 offen offset:1024 nt lds
    s_add_u32 s29, s29, 8192
    s_waitcnt vmcnt(0)
    s_barrier
    ds_read_b128 a[64:67], v176 offset:32768
    ds_read_b128 a[68:71], v177 offset:32768
    ds_read_b128 a[72:75], v178 offset:32768
    ds_read_b128 a[76:79], v179 offset:32768
    ds_read_b128 a[80:83], v176 offset:40960
    ds_read_b128 a[84:87], v177 offset:40960
    ds_read_b128 a[88:91], v178 offset:40960
    ds_read_b128 a[92:95], v179 offset:40960
    s_waitcnt lgkmcnt(0)
    v_mfma_f32_16x16x32_bf16 v[0:3], a[64:67], a[0:3], 0
    v_mfma_f32_16x16x32_bf16 v[0:3], a[68:71], a[4:7], v[0:3]
    v_mfma_f32_16x16x32_bf16 v[0:3], a[72:75], a[8:11], v[0:3]
    v_mfma_f32_16x16x32_bf16 v[0:3], a[76:79], a[12:15], v[0:3]
    v_mfma_f32_16x16x32_bf16 v[4:7], a[80:83], a[0:3], 0
    v_mfma_f32_16x16x32_bf16 v[4:7], a[84:87], a[4:7], v[4:7]
    v_mfma_f32_16x16x32_bf16 v[4:7], a[88:91], a[8:11], v[4:7]
    v_mfma_f32_16x16x32_bf16 v[4:7], a[92:95], a[12:15], v[4:7]
    v_mfma_f32_16x16x32_bf16 v[8:11], a[64:67], a[16:19], 0
    v_mfma_f32_16x16x32_bf16 v[8:11], a[68:71], a[20:23], v[8:11]
    v_mfma_f32_16x16x32_bf16 v[8:11], a[72:75], a[24:27], v[8:11]
    v_mfma_f32_16x16x32_bf16 v[8:11], a[76:79], a[28:31], v[8:11]
    v_mfma_f32_16x16x32_bf16 v[12:15], a[80:83], a[16:19], 0
    v_mfma_f32_16x16x32_bf16 v[12:15], a[84:87], a[20:23], v[12:15]
    v_mfma_f32_16x16x32_bf16 v[12:15], a[88:91], a[24:27], v[12:15]
    v_mfma_f32_16x16x32_bf16 v[12:15], a[92:95], a[28:31], v[12:15]
    v_mfma_f32_16x16x32_bf16 v[16:19], a[64:67], a[32:35], 0
    v_mfma_f32_16x16x32_bf16 v[16:19], a[68:71], a[36:39], v[16:19]
    v_mfma_f32_16x16x32_bf16 v[16:19], a[72:75], a[40:43], v[16:19]
    v_mfma_f32_16x16x32_bf16 v[16:19], a[76:79], a[44:47], v[16:19]
    v_mfma_f32_16x16x32_bf16 v[20:23], a[80:83], a[32:35], 0
    v_mfma_f32_16x16x32_bf16 v[20:23], a[84:87], a[36:39], v[20:23]
    v_mfma_f32_16x16x32_bf16 v[20:23], a[88:91], a[40:43], v[20:23]
    v_mfma_f32_16x16x32_bf16 v[20:23], a[92:95], a[44:47], v[20:23]
    v_mfma_f32_16x16x32_bf16 v[24:27], a[64:67], a[48:51], 0
    v_mfma_f32_16x16x32_bf16 v[24:27], a[68:71], a[52:55], v[24:27]
    v_mfma_f32_16x16x32_bf16 v[24:27], a[72:75], a[56:59], v[24:27]
    v_mfma_f32_16x16x32_bf16 v[24:27], a[76:79], a[60:63], v[24:27]
    v_mfma_f32_16x16x32_bf16 v[28:31], a[80:83], a[48:51], 0
    v_mfma_f32_16x16x32_bf16 v[28:31], a[84:87], a[52:55], v[28:31]
    v_mfma_f32_16x16x32_bf16 v[28:31], a[88:91], a[56:59], v[28:31]
    v_mfma_f32_16x16x32_bf16 v[28:31], a[92:95], a[60:63], v[28:31]
    s_nop 7
    v_max3_f32 v168, v168, v0, v1
    v_max3_f32 v168, v168, v2, v3
    v_max3_f32 v168, v168, v4, v5
    v_max3_f32 v168, v168, v6, v7
    v_max3_f32 v169, v169, v8, v9
    v_max3_f32 v169, v169, v10, v11
    v_max3_f32 v169, v169, v12, v13
    v_max3_f32 v169, v169, v14, v15
    v_max3_f32 v170, v170, v16, v17
    v_max3_f32 v170, v170, v18, v19
    v_max3_f32 v170, v170, v20, v21
    v_max3_f32 v170, v170, v22, v23
    v_max3_f32 v171, v171, v24, v25
    v_max3_f32 v171, v171, v26, v27
    v_max3_f32 v171, v171, v28, v29
    v_max3_f32 v171, v171, v30, v31
    s_sub_u32 s31, s31, 1
    s_cmp_lg_u32 s31, 0
    s_cbranch_scc1 L_fb_loop
    v_mov_b32 v228, v168
    v_mov_b32 v229, v169
    v_mov_b32 v230, v170
    v_mov_b32 v231, v171
    s_nop 1
    v_permlane32_swap_b32 v168, v228
    v_permlane32_swap_b32 v169, v229
    v_permlane32_swap_b32 v170, v230
    v_permlane32_swap_b32 v171, v231
    v_max_f32 v168, v168, v228
    v_max_f32 v169, v169, v229
    v_max_f32 v170, v170, v230
    v_max_f32 v171, v171, v231
    v_mov_b32 v228, v168
    v_mov_b32 v229, v169
    v_mov_b32 v230, v170
    v_mov_b32 v231, v171
    s_nop 1
    v_permlane16_swap_b32 v168, v228
    v_permlane16_swap_b32 v169, v229
    v_permlane16_swap_b32 v170, v230
    v_permlane16_swap_b32 v171, v231
    v_max_f32 v168, v168, v228
    v_max_f32 v169, v169, v229
    v_max_f32 v170, v170, v230
    v_max_f32 v171, v171, v231
    v_and_b32 v236, 15, v227
    s_lshl_b32 s38, s24, 6
    v_add_u32 v236, s38, v236
    v_mov_b32 v237, 0xff800000
    v_sub_f32 v238, 0, v168
    v_mov_b32 v152, v238
    v_mov_b32 v153, v238
    v_mov_b32 v154, v238
    v_mov_b32 v155, v238
    v_sub_f32 v238, 0, v169
    v_mov_b32 v156, v238
    v_mov_b32 v157, v238
    v_mov_b32 v158, v238
    v_mov_b32 v159, v238
    v_sub_f32 v238, 0, v170
    v_mov_b32 v160, v238
    v_mov_b32 v161, v238
    v_mov_b32 v162, v238
    v_mov_b32 v163, v238
    v_sub_f32 v238, 0, v171
    v_cmp_gt_u32 vcc, 192, v236
    s_nop 1
    v_cndmask_b32 v238, v237, v238, vcc
    v_mov_b32 v164, v238
    v_mov_b32 v165, v238
    v_mov_b32 v166, v238
    v_mov_b32 v167, v238
    s_barrier
    s_add_u32 s27, s34, s60
    s_add_u32 m0, s35, 98304
    s_nop 0
    buffer_load_dwordx4 v196, s[12:15], s27 offen nt lds
    buffer_load_dwordx4 v197, s[12:15], s27 offen offset:1024 nt lds
    buffer_load_dwordx4 v198, s[16:19], s27 offen offset:2048 nt lds
    buffer_load_dwordx4 v199, s[16:19], s27 offen offset:3072 nt lds
    s_add_u32 s27, s27, 8192
    s_add_u32 m0, s35, 114688
    s_nop 0
    buffer_load_dwordx4 v196, s[12:15], s27 offen nt lds
    buffer_load_dwordx4 v197, s[12:15], s27 offen offset:1024 nt lds
    buffer_load_dwordx4 v198, s[16:19], s27 offen offset:2048 nt lds
    buffer_load_dwordx4 v199, s[16:19], s27 offen offset:3072 nt lds
    s_add_u32 s27, s27, 8192
    s_add_u32 m0, s35, 0
    s_nop 0
    buffer_load_dwordx4 v196, s[12:15], s27 offen nt lds
    buffer_load_dwordx4 v197, s[12:15], s27 offen offset:1024 nt lds
    buffer_load_dwordx4 v198, s[16:19], s27 offen offset:2048 nt lds
    buffer_load_dwordx4 v199, s[16:19], s27 offen offset:3072 nt lds
    s_add_u32 s27, s27, 8192
    s_add_u32 m0, s35, 16384
    s_nop 0
    buffer_load_dwordx4 v196, s[12:15], s27 offen nt lds
    buffer_load_dwordx4 v197, s[12:15], s27 offen offset:1024 nt lds
    buffer_load_dwordx4 v198, s[16:19], s27 offen offset:2048 nt lds
    buffer_load_dwordx4 v199, s[16:19], s27 offen offset:3072 nt lds
    s_add_u32 s27, s27, 8192
    s_add_u32 m0, s35, 32768
    s_nop 0
    buffer_load_dwordx4 v196, s[12:15], s27 offen nt lds
    buffer_load_dwordx4 v197, s[12:15], s27 offen offset:1024 nt lds
    buffer_load_dwordx4 v198, s[16:19], s27 offen offset:2048 nt lds
    buffer_load_dwordx4 v199, s[16:19], s27 offen offset:3072 nt lds
    s_add_u32 s27, s27, 8192
    s_add_u32 m0, s35, 49152
    s_nop 0
    buffer_load_dwordx4 v196, s[12:15], s27 offen nt lds
    buffer_load_dwordx4 v197, s[12:15], s27 offen offset:1024 nt lds
    buffer_load_dwordx4 v198, s[16:19], s27 offen offset:2048 nt lds
    buffer_load_dwordx4 v199, s[16:19], s27 offen offset:3072 nt lds
    s_add_u32 s27, s27, 8192
    s_add_u32 m0, s35, 65536
    s_nop 0
    buffer_load_dwordx4 v196, s[12:15], s27 offen nt lds
    buffer_load_dwordx4 v197, s[12:15], s27 offen offset:1024 nt lds
    buffer_load_dwordx4 v198, s[16:19], s27 offen offset:2048 nt lds
    buffer_load_dwordx4 v199, s[16:19], s27 offen offset:3072 nt lds
    s_add_u32 s27, s27, 8192
    s_add_u32 m0, s35, 81920
    s_nop 0
    buffer_load_dwordx4 v196, s[12:15], s27 offen nt lds
    buffer_load_dwordx4 v197, s[12:15], s27 offen offset:1024 nt lds
    buffer_load_dwordx4 v198, s[16:19], s27 offen offset:2048 nt lds
    buffer_load_dwordx4 v199, s[16:19], s27 offen offset:3072 nt lds
    s_add_u32 s27, s27, 8192
    s_and_b32 s27, s27, 0x7ffff
    s_waitcnt vmcnt(28)
    s_barrier
    ds_read_b128 a[64:67], v176 offset:32768
    ds_read_b128 a[68:71], v177 offset:32768
    ds_read_b128 a[72:75], v178 offset:32768
    ds_read_b128 a[76:79], v179 offset:32768
    ds_read_b128 a[80:83], v176 offset:40960
    ds_read_b128 a[84:87], v177 offset:40960
    ds_read_b128 a[88:91], v178 offset:40960
    ds_read_b128 a[92:95], v179 offset:40960
    v_mov_b32 v144, 0
    v_mov_b32 v145, 0
    v_mov_b32 v146, 0
    v_mov_b32 v147, 0
    v_mov_b32 v0, 0
    v_mov_b32 v1, 0
    v_mov_b32 v2, 0
    v_mov_b32 v3, 0
    v_mov_b32 v4, 0
    v_mov_b32 v5, 0
    v_mov_b32 v6, 0
    v_mov_b32 v7, 0
    v_mov_b32 v8, 0
    v_mov_b32 v9, 0
    v_mov_b32 v10, 0
    v_mov_b32 v11, 0
    v_mov_b32 v12, 0
    v_mov_b32 v13, 0
    v_mov_b32 v14, 0
    v_mov_b32 v15, 0
    v_mov_b32 v16, 0
    v_mov_b32 v17, 0
    v_mov_b32 v18, 0
    v_mov_b32 v19, 0
    v_mov_b32 v20, 0
    v_mov_b32 v21, 0
    v_mov_b32 v22, 0
    v_mov_b32 v23, 0
    v_mov_b32 v24, 0
    v_mov_b32 v25, 0
    v_mov_b32 v26, 0
    v_mov_b32 v27, 0
    v_mov_b32 v28, 0
    v_mov_b32 v29, 0
    v_mov_b32 v30, 0
    v_mov_b32 v31, 0
    v_mov_b32 v32, 0
    v_mov_b32 v33, 0
    v_mov_b32 v34, 0
    v_mov_b32 v35, 0
    v_mov_b32 v36, 0
    v_mov_b32 v37, 0
    v_mov_b32 v38, 0
    v_mov_b32 v39, 0
    v_mov_b32 v40, 0
    v_mov_b32 v41, 0
    v_mov_b32 v42, 0
    v_mov_b32 v43, 0
    v_mov_b32 v44, 0
    v_mov_b32 v45, 0
    v_mov_b32 v46, 0
    v_mov_b32 v47, 0
    v_mov_b32 v48, 0
    v_mov_b32 v49, 0
    v_mov_b32 v50, 0
    v_mov_b32 v51, 0
    v_mov_b32 v52, 0
    v_mov_b32 v53, 0
    v_mov_b32 v54, 0
    v_mov_b32 v55, 0
    v_mov_b32 v56, 0
    v_mov_b32 v57, 0
    v_mov_b32 v58, 0
    v_mov_b32 v59, 0
    v_mov_b32 v60, 0
    v_mov_b32 v61, 0
    v_mov_b32 v62, 0
    v_mov_b32 v63, 0
    v_mov_b32 v64, 0
    v_mov_b32 v65, 0
    v_mov_b32 v66, 0
    v_mov_b32 v67, 0
    v_mov_b32 v68, 0
    v_mov_b32 v69, 0
    v_mov_b32 v70, 0
    v_mov_b32 v71, 0
    v_mov_b32 v72, 0
    v_mov_b32 v73, 0
    v_mov_b32 v74, 0
    v_mov_b32 v75, 0
    v_mov_b32 v76, 0
    v_mov_b32 v77, 0
    v_mov_b32 v78, 0
    v_mov_b32 v79, 0
    v_mov_b32 v80, 0
    v_mov_b32 v81, 0
    v_mov_b32 v82, 0
    v_mov_b32 v83, 0
    v_mov_b32 v84, 0
    v_mov_b32 v85, 0
    v_mov_b32 v86, 0
    v_mov_b32 v87, 0
    v_mov_b32 v88, 0
    v_mov_b32 v89, 0
    v_mov_b32 v90, 0
    v_mov_b32 v91, 0
    v_mov_b32 v92, 0
    v_mov_b32 v93, 0
    v_mov_b32 v94, 0
    v_mov_b32 v95, 0
    v_mov_b32 v96, 0
    v_mov_b32 v97, 0
    v_mov_b32 v98, 0
    v_mov_b32 v99, 0
    v_mov_b32 v100, 0
    v_mov_b32 v101, 0
    v_mov_b32 v102, 0
    v_mov_b32 v103, 0
    v_mov_b32 v104, 0
    v_mov_b32 v105, 0
    v_mov_b32 v106, 0
    v_mov_b32 v107, 0
    v_mov_b32 v108, 0
    v_mov_b32 v109, 0
    v_mov_b32 v110, 0
    v_mov_b32 v111, 0
    v_mov_b32 v112, 0
    v_mov_b32 v113, 0
    v_mov_b32 v114, 0
    v_mov_b32 v115, 0
    v_mov_b32 v116, 0
    v_mov_b32 v117, 0
    v_mov_b32 v118, 0
    v_mov_b32 v119, 0
    v_mov_b32 v120, 0
    v_mov_b32 v121, 0
    v_mov_b32 v122, 0
    v_mov_b32 v123, 0
    v_mov_b32 v124, 0
    v_mov_b32 v125, 0
    v_mov_b32 v126, 0
    v_mov_b32 v127, 0
    s_branch L_attn_go
.section .rodata,"a"
.p2align 6
.amdhsa_kernel standalone__mha_block_cached__near_ridge_kernel
  .amdhsa_next_free_vgpr 512
  .amdhsa_next_free_sgpr 102
  .amdhsa_accum_offset 256
  .amdhsa_group_segment_fixed_size 0
  .amdhsa_kernarg_size 64
  .amdhsa_user_sgpr_count 2
  .amdhsa_user_sgpr_kernarg_segment_ptr 1
  .amdhsa_system_sgpr_workgroup_id_x 1
.end_amdhsa_kernel
```
